```python
import torch

def _softmax(x, axis=-1):
    return torch.softmax(x, dim=axis)

def _gelu(x):
    return torch.nn.functional.gelu(x, approximate='tanh')

def _silu(x):
    return torch.nn.functional.silu(x)

def _sigmoid(x):
    return torch.sigmoid(x)

def _layernorm(x, axis=-1, eps=1e-05):
    m = x.mean(dim=axis, keepdim=True)
    v = x.var(dim=axis, keepdim=True, unbiased=False)
    return (x - m) / torch.sqrt(v + eps)

def _scatter_add(tgt, idx, src, axis=0):
    return tgt.clone().index_add_(axis, idx, src)

def _segment_sum(src, seg, n):
    out = torch.zeros((n,) + src.shape[1:], dtype=src.dtype)
    return out.index_add_(0, seg, src)

def _pad(x, pw):
    flat = tuple((v for pair in reversed(pw) for v in pair))
    return torch.nn.functional.pad(x, flat)
kernel_name = 'gated_mix__memory_aug_recurrent_mem_tr__sliding_block__prompt'

def setup_inputs():

    _w = lambda a: (lambda t: t.to(torch.bfloat16) if t.is_floating_point() else t)(torch.as_tensor(a))

    def _A_setup():
        B, S, Dm = (1, 2048, 512)
        H, Dh = (32, 128)
        M, seg = (8, 32)
        seg = min(seg, S)
        S = S // seg * seg
        return {'x': _w((lambda *s: torch.randn(*s, dtype=torch.bfloat16) * 0.05)(B, S, Dm)), 'mem0': _w((lambda *s: torch.randn(*s, dtype=torch.bfloat16) * 1.6)(B, M, Dm)), 'Wq': _w((lambda *s: torch.randn(*s, dtype=torch.bfloat16) * 0.8)(Dm, H, Dh) * Dm ** (-0.5)), 'Wk': _w((lambda *s: torch.randn(*s, dtype=torch.bfloat16) * 0.8)(Dm, H, Dh) * Dm ** (-0.5)), 'Wv': _w((lambda *s: torch.randn(*s, dtype=torch.bfloat16) * 1.6)(Dm, H, Dh) * Dm ** (-0.5)), 'Wo': _w((lambda *s: torch.randn(*s, dtype=torch.bfloat16) * 1.6)(H, Dh, Dm) * (H * Dh) ** (-0.5)), 'seg_len': seg}
    _A_in = _A_setup()

    def _B_setup():
        B, S, D = (1, 2048, 512)
        return {'x': _w((lambda *s: torch.randn(*s, dtype=torch.bfloat16) * 0.05)(B, S, D)), 'wqkv': _w((lambda *s: torch.randn(*s, dtype=torch.bfloat16) * 1.6)(D, 3 * D)), 'wo': _w((lambda *s: torch.randn(*s, dtype=torch.bfloat16) * 0.05)(D, D))}
    _B_in = _B_setup()
    return {'A_x': _A_in['x'], 'A_mem0': _A_in['mem0'], 'A_Wq': _A_in['Wq'], 'A_Wk': _A_in['Wk'], 'A_Wv': _A_in['Wv'], 'A_Wo': _A_in['Wo'], 'A_seg_len': _A_in['seg_len'], 'B_x': _B_in['x'], 'B_wqkv': _B_in['wqkv'], 'B_wo': _B_in['wo'], 'gate_w': _w((lambda *s: torch.randn(*s, dtype=torch.bfloat16) * 0.05)(512) * 16.0)}

def reference(A_x, A_mem0, A_Wq, A_Wk, A_Wv, A_Wo, A_seg_len, B_x, B_wqkv, B_wo, gate_w):

    def _A_ref(x, mem0, Wq, Wk, Wv, Wo, seg_len):
        B, S, Dm = x.shape
        H, Dh = (Wq.shape[1], Wq.shape[2])
        M = mem0.shape[1]
        scale = Dh ** (-0.5)
        n_seg = S // seg_len
        L = M + seg_len
        idx = torch.arange(L)
        mask = (idx[:, None] < M) | (idx[:, None] >= idx[None, :])
        mem = mem0
        outs = []
        for s in range(n_seg):
            xs = x[:, s * seg_len:(s + 1) * seg_len, :].clone()
            h = torch.concatenate([mem, xs], axis=1)
            q = torch.einsum('btd,dhe->bhte', h, Wq)
            k = torch.einsum('btd,dhe->bhte', h, Wk)
            v = torch.einsum('btd,dhe->bhte', h, Wv)
            scores = torch.einsum('bhqe,bhke->bhqk', q, k) * scale
            scores = torch.where(mask[None, None], scores, -1000000000.0)
            p = _softmax(scores, axis=-1)
            o = torch.einsum('bhqk,bhke->bhqe', p, v)
            o = torch.einsum('bhte,hed->btd', o, Wo)
            mem = o[:, :M, :].clone()
            outs.append(o[:, M:, :])
        return torch.concatenate(outs, axis=1)

    def _B_ref(x, wqkv, wo):
        B, S, D = x.shape
        H = 32
        Dh = D // H
        W = 256
        qkv = (lambda x, *d: x.permute(*d))((x @ wqkv).reshape(B, S, 3, H, Dh), 2, 0, 3, 1, 4)
        q, k, v = (qkv[0], qkv[1], qkv[2])
        scores = torch.einsum('bhqd,bhkd->bhqk', q, k) * Dh ** (-0.5)
        idx = torch.arange(S)
        mask = (idx[:, None] - idx[None, :] >= 0) & (idx[:, None] - idx[None, :] < W)
        scores = torch.where(mask[None, None], scores, -1000000000.0)
        p = _softmax(scores, axis=-1)
        o = torch.einsum('bhqk,bhkd->bhqd', p, v)
        return (lambda x, *d: x.permute(*d))(o, 0, 2, 1, 3).reshape(B, S, D) @ wo
    x = A_x
    g = _sigmoid((x * gate_w).sum(-1, keepdims=True))
    a = _A_ref(x, A_mem0, A_Wq, A_Wk, A_Wv, A_Wo, A_seg_len)
    b = _B_ref(x, B_wqkv, B_wo)
    return g * a + (1 - g) * b
```

```asm
; @launch grid=(256,1,1) block=(256,1,1) lds=163840
.amdgcn_target "amdgcn-amd-amdhsa--gfx950"
.text
.globl gated_mix__memory_aug_recurrent_mem_tr__sliding_block__prompt_kernel
.p2align 8
.type gated_mix__memory_aug_recurrent_mem_tr__sliding_block__prompt_kernel,@function
gated_mix__memory_aug_recurrent_mem_tr__sliding_block__prompt_kernel:
    s_cmp_ge_u32 s2, 256
    s_cbranch_scc1 L_END
    s_load_dwordx2 s[4:5], s[0:1], 0
    s_load_dwordx2 s[8:9], s[0:1], 8
    s_load_dwordx2 s[12:13], s[0:1], 16
    s_load_dwordx2 s[16:17], s[0:1], 24
    s_load_dwordx2 s[20:21], s[0:1], 32
    s_load_dwordx2 s[24:25], s[0:1], 40
    s_load_dwordx2 s[28:29], s[0:1], 64
    s_load_dwordx2 s[32:33], s[0:1], 72
    s_load_dwordx2 s[36:37], s[0:1], 80
    s_load_dwordx2 s[40:41], s[0:1], 88
    s_load_dwordx2 s[44:45], s[0:1], 96
    s_load_dwordx2 s[48:49], s[0:1], 104
    s_getreg_b32 s55, hwreg(HW_REG_XCC_ID, 0, 4)
    s_and_b32 s55, s55, 7
    v_lshrrev_b32 v1, 6, v0
    v_and_b32 v0, 63, v0
    v_readfirstlane_b32 s52, v1
    s_mov_b32 s6, 2097152
    s_mov_b32 s7, 0x00020000
    s_mov_b32 s10, 8192
    s_mov_b32 s11, 0x00020000
    s_mov_b32 s14, 4194304
    s_mov_b32 s15, 0x00020000
    s_mov_b32 s18, 4194304
    s_mov_b32 s19, 0x00020000
    s_mov_b32 s22, 4194304
    s_mov_b32 s23, 0x00020000
    s_mov_b32 s26, 4194304
    s_mov_b32 s27, 0x00020000
    s_mov_b32 s30, 1572864
    s_mov_b32 s31, 0x00020000
    s_mov_b32 s34, 524288
    s_mov_b32 s35, 0x00020000
    s_mov_b32 s38, 1024
    s_mov_b32 s39, 0x00020000
    s_mov_b32 s42, 2097152
    s_mov_b32 s43, 0x00020000
    s_mov_b32 s46, 256
    s_mov_b32 s47, 0x00020000
    s_mov_b32 s50, 268435456
    s_mov_b32 s51, 0x00020000
    s_waitcnt lgkmcnt(0)
    s_cmp_eq_u32 s52, 0
    s_cbranch_scc1 L_ELECT
    s_cmp_lg_u32 s52, 3
    s_cbranch_scc1 L_NOZERO
    s_mov_b64 exec, 0xffffffff
    s_lshl_b32 s3, s2, 7
    v_lshlrev_b32 v3, 2, v0
    v_mov_b32 v4, 0
    buffer_store_dword v4, v3, s[48:51], s3 offen sc1
    s_mov_b64 exec, -1
L_NOZERO:
    s_getpc_b64 s[60:61]
L_CPF_PC:
    s_sub_u32 s62, s52, 1
    s_lshl_b32 s62, s62, 13
    v_lshlrev_b32 v3, 7, v0
    v_add_u32 v3, s62, v3
    s_mov_b32 s62, L_CODE_END-L_CPF_PC-4
    v_min_u32 v4, s62, v3
    global_load_dword v254, v4, s[60:61]
    v_add_u32 v3, 24576, v3
    v_min_u32 v4, s62, v3
    global_load_dword v254, v4, s[60:61]
    v_add_u32 v3, 24576, v3
    v_min_u32 v4, s62, v3
    global_load_dword v254, v4, s[60:61]
    v_add_u32 v3, 24576, v3
    v_min_u32 v4, s62, v3
    global_load_dword v254, v4, s[60:61]
    v_add_u32 v3, 24576, v3
    s_branch L_ELECTED
.p2align 5
L_ELECT:
    s_mov_b64 exec, 1
    s_lshl_b32 s3, s55, 2
    s_cmp_eq_u32 s55, 1
    s_cselect_b32 s3, 224, s3
    v_mov_b32 v1, s3
    v_mov_b32 v2, 1
    buffer_atomic_add v2, v1, s[44:47], 0 offen sc0
    s_mov_b64 exec, -1
    v_lshlrev_b32 v3, 2, v0
    s_mov_b64 exec, 1
    s_waitcnt vmcnt(0)
    v_readfirstlane_b32 s58, v2
    s_lshl_b32 s59, s55, 5
    s_add_u32 s59, s59, s58
    s_cmp_lt_u32 s58, 32
    s_cbranch_scc1 L_SLOT_OK
    v_mov_b32 v1, 32
    v_mov_b32 v2, 1
    buffer_atomic_add v2, v1, s[44:47], 0 offen sc0
    s_waitcnt vmcnt(0)
    v_readfirstlane_b32 s58, v2
    s_mov_b32 s56, 0
L_OV_POLL:
    s_mov_b64 exec, -1
    buffer_load_dword v5, v3, s[44:47], 0 offen sc1
    s_waitcnt vmcnt(0)
    s_mov_b32 s60, 0
    v_readlane_b32 s64, v5, 0
    v_readlane_b32 s65, v5, 56
    v_readlane_b32 s66, v5, 2
    v_readlane_b32 s67, v5, 3
    v_readlane_b32 s68, v5, 4
    v_readlane_b32 s69, v5, 5
    v_readlane_b32 s70, v5, 6
    v_readlane_b32 s71, v5, 7
    s_add_u32 s60, s60, s64
    s_add_u32 s60, s60, s65
    s_add_u32 s60, s60, s66
    s_add_u32 s60, s60, s67
    s_add_u32 s60, s60, s68
    s_add_u32 s60, s60, s69
    s_add_u32 s60, s60, s70
    s_add_u32 s60, s60, s71
    s_cmp_eq_u32 s60, 256
    s_cbranch_scc1 L_OV_ALL
    s_sleep 4
    s_add_u32 s56, s56, 1
    s_cmp_gt_u32 s56, 60000
    s_cbranch_scc1 L_TIMEOUT_0
    s_branch L_OV_POLL
.p2align 5
L_OV_ALL:
    s_mov_b32 s59, 255
    s_min_u32 s61, s64, 32
    s_sub_u32 s62, 32, s61
    s_cmp_lt_u32 s58, s62
    s_cbranch_scc0 L_OV_N0
    s_add_u32 s59, s61, s58
    s_add_u32 s59, s59, 0
    s_mov_b32 s58, 0x40000000
L_OV_N0:
    s_sub_u32 s58, s58, s62
    s_min_u32 s61, s65, 32
    s_sub_u32 s62, 32, s61
    s_cmp_lt_u32 s58, s62
    s_cbranch_scc0 L_OV_N1
    s_add_u32 s59, s61, s58
    s_add_u32 s59, s59, 32
    s_mov_b32 s58, 0x40000000
L_OV_N1:
    s_sub_u32 s58, s58, s62
    s_min_u32 s61, s66, 32
    s_sub_u32 s62, 32, s61
    s_cmp_lt_u32 s58, s62
    s_cbranch_scc0 L_OV_N2
    s_add_u32 s59, s61, s58
    s_add_u32 s59, s59, 64
    s_mov_b32 s58, 0x40000000
L_OV_N2:
    s_sub_u32 s58, s58, s62
    s_min_u32 s61, s67, 32
    s_sub_u32 s62, 32, s61
    s_cmp_lt_u32 s58, s62
    s_cbranch_scc0 L_OV_N3
    s_add_u32 s59, s61, s58
    s_add_u32 s59, s59, 96
    s_mov_b32 s58, 0x40000000
L_OV_N3:
    s_sub_u32 s58, s58, s62
    s_min_u32 s61, s68, 32
    s_sub_u32 s62, 32, s61
    s_cmp_lt_u32 s58, s62
    s_cbranch_scc0 L_OV_N4
    s_add_u32 s59, s61, s58
    s_add_u32 s59, s59, 128
    s_mov_b32 s58, 0x40000000
L_OV_N4:
    s_sub_u32 s58, s58, s62
    s_min_u32 s61, s69, 32
    s_sub_u32 s62, 32, s61
    s_cmp_lt_u32 s58, s62
    s_cbranch_scc0 L_OV_N5
    s_add_u32 s59, s61, s58
    s_add_u32 s59, s59, 160
    s_mov_b32 s58, 0x40000000
L_OV_N5:
    s_sub_u32 s58, s58, s62
    s_min_u32 s61, s70, 32
    s_sub_u32 s62, 32, s61
    s_cmp_lt_u32 s58, s62
    s_cbranch_scc0 L_OV_N6
    s_add_u32 s59, s61, s58
    s_add_u32 s59, s59, 192
    s_mov_b32 s58, 0x40000000
L_OV_N6:
    s_sub_u32 s58, s58, s62
    s_min_u32 s61, s71, 32
    s_sub_u32 s62, 32, s61
    s_cmp_lt_u32 s58, s62
    s_cbranch_scc0 L_OV_N7
    s_add_u32 s59, s61, s58
    s_add_u32 s59, s59, 224
    s_mov_b32 s58, 0x40000000
L_OV_N7:
    s_sub_u32 s58, s58, s62
    s_mov_b64 exec, 1
L_SLOT_OK:
    v_mov_b32 v1, 0
    v_mov_b32 v2, s59
    ds_write_b32 v1, v2
    s_waitcnt lgkmcnt(0)
    s_mov_b64 exec, -1
L_ELECTED:
    s_barrier
    v_mov_b32 v1, 0
    ds_read_b32 v2, v1
    s_waitcnt lgkmcnt(0)
    v_readfirstlane_b32 s59, v2
    s_barrier
    s_add_u32 s53, s59, 0
    s_and_b32 s53, s53, 31
    s_lshr_b32 s58, s59, 5
    s_mov_b32 s55, s58
    s_mov_b32 s54, 0
    s_cmp_eq_u32 s58, 1
    s_cbranch_scc1 L_JMP_R
    s_waitcnt vmcnt(0)
    s_cmp_lg_u32 s52, 3
    s_cbranch_scc1 L_SIG_1
    s_mov_b64 exec, 1
    v_mov_b32 v3, 48
    v_mov_b32 v4, 1
    buffer_atomic_add v4, v3, s[44:47], 0 offen
    s_mov_b64 exec, -1
L_SIG_1:
    s_mov_b32 s54, 0
    s_cmp_eq_u32 s58, 0
    s_cbranch_scc1 L_JMP_INI
    s_mov_b32 s54, 0
    s_cmp_eq_u32 s58, 1
    s_cbranch_scc1 L_JMP_R
    s_mov_b32 s54, 0
    s_cmp_eq_u32 s58, 2
    s_cbranch_scc1 L_JMP_KV
    s_mov_b32 s54, 1
    s_cmp_eq_u32 s58, 3
    s_cbranch_scc1 L_JMP_KV
    s_mov_b32 s54, 0
    s_cmp_eq_u32 s58, 4
    s_cbranch_scc1 L_JMP_B
    s_mov_b32 s54, 1
    s_cmp_eq_u32 s58, 5
    s_cbranch_scc1 L_JMP_B
    s_mov_b32 s54, 2
    s_cmp_eq_u32 s58, 6
    s_cbranch_scc1 L_JMP_KV
    s_mov_b32 s54, 3
    s_cmp_eq_u32 s58, 7
    s_cbranch_scc1 L_JMP_KV
L_END:
    s_endpgm
.p2align 5
L_JMP_R:
    s_branch L_ROLE_R
.p2align 5
L_JMP_KV:
    s_branch L_ROLE_KV
.p2align 5
L_JMP_B:
    s_branch L_ROLE_B
.p2align 5
L_JMP_INI:
    s_branch L_ROLE_INI
.p2align 5
L_ROLE_KV:
    s_sub_u32 s65, 67, s54
    s_lshr_b32 s65, s65, 2
    v_lshlrev_b32 v4, 4, v0
    s_lshl_b32 s61, s52, 3
    s_add_u32 s62, s61, 0
    s_and_b32 s3, s62, 15
    s_lshl_b32 s3, s3, 4
    v_xor_b32 v8, s3, v4
    s_lshl_b32 s3, s62, 10
    v_add_u32 v8, s3, v8
    s_add_u32 s62, s61, 1
    s_and_b32 s3, s62, 15
    s_lshl_b32 s3, s3, 4
    v_xor_b32 v9, s3, v4
    s_lshl_b32 s3, s62, 10
    v_add_u32 v9, s3, v9
    s_add_u32 s62, s61, 2
    s_and_b32 s3, s62, 15
    s_lshl_b32 s3, s3, 4
    v_xor_b32 v10, s3, v4
    s_lshl_b32 s3, s62, 10
    v_add_u32 v10, s3, v10
    s_add_u32 s62, s61, 3
    s_and_b32 s3, s62, 15
    s_lshl_b32 s3, s3, 4
    v_xor_b32 v11, s3, v4
    s_lshl_b32 s3, s62, 10
    v_add_u32 v11, s3, v11
    s_add_u32 s62, s61, 4
    s_and_b32 s3, s62, 15
    s_lshl_b32 s3, s3, 4
    v_xor_b32 v12, s3, v4
    s_lshl_b32 s3, s62, 10
    v_add_u32 v12, s3, v12
    s_add_u32 s62, s61, 5
    s_and_b32 s3, s62, 15
    s_lshl_b32 s3, s3, 4
    v_xor_b32 v13, s3, v4
    s_lshl_b32 s3, s62, 10
    v_add_u32 v13, s3, v13
    s_add_u32 s62, s61, 6
    s_and_b32 s3, s62, 15
    s_lshl_b32 s3, s3, 4
    v_xor_b32 v14, s3, v4
    s_lshl_b32 s3, s62, 10
    v_add_u32 v14, s3, v14
    s_add_u32 s62, s61, 7
    s_and_b32 s3, s62, 15
    s_lshl_b32 s3, s3, 4
    v_xor_b32 v15, s3, v4
    s_lshl_b32 s3, s62, 10
    v_add_u32 v15, s3, v15
    s_mov_b32 s66, s54
    s_lshl_b32 s70, s66, 15
    s_lshl_b32 s3, s52, 13
    s_add_u32 s3, s3, 0
    s_add_u32 m0, s3, 0
    s_nop 0
    buffer_load_dwordx4 v8, s[4:7], s70 offen lds
    s_add_u32 m0, s3, 1024
    s_nop 0
    buffer_load_dwordx4 v9, s[4:7], s70 offen lds
    s_add_u32 m0, s3, 2048
    s_nop 0
    buffer_load_dwordx4 v10, s[4:7], s70 offen lds
    s_add_u32 m0, s3, 3072
    s_nop 0
    buffer_load_dwordx4 v11, s[4:7], s70 offen lds
    s_add_u32 m0, s3, 4096
    s_nop 0
    buffer_load_dwordx4 v12, s[4:7], s70 offen lds
    s_add_u32 m0, s3, 5120
    s_nop 0
    buffer_load_dwordx4 v13, s[4:7], s70 offen lds
    s_add_u32 m0, s3, 6144
    s_nop 0
    buffer_load_dwordx4 v14, s[4:7], s70 offen lds
    s_add_u32 m0, s3, 7168
    s_nop 0
    buffer_load_dwordx4 v15, s[4:7], s70 offen lds
    s_add_u32 s61, s54, 4
    s_lshl_b32 s70, s61, 15
    s_lshl_b32 s3, s52, 13
    s_add_u32 s3, s3, 32768
    s_add_u32 m0, s3, 0
    s_nop 0
    buffer_load_dwordx4 v8, s[4:7], s70 offen lds
    s_add_u32 m0, s3, 1024
    s_nop 0
    buffer_load_dwordx4 v9, s[4:7], s70 offen lds
    s_add_u32 m0, s3, 2048
    s_nop 0
    buffer_load_dwordx4 v10, s[4:7], s70 offen lds
    s_add_u32 m0, s3, 3072
    s_nop 0
    buffer_load_dwordx4 v11, s[4:7], s70 offen lds
    s_add_u32 m0, s3, 4096
    s_nop 0
    buffer_load_dwordx4 v12, s[4:7], s70 offen lds
    s_add_u32 m0, s3, 5120
    s_nop 0
    buffer_load_dwordx4 v13, s[4:7], s70 offen lds
    s_add_u32 m0, s3, 6144
    s_nop 0
    buffer_load_dwordx4 v14, s[4:7], s70 offen lds
    s_add_u32 m0, s3, 7168
    s_nop 0
    buffer_load_dwordx4 v15, s[4:7], s70 offen lds
    v_bfe_u32 v3, v0, 5, 1
    v_mul_u32_u24 v3, 16, v3
    v_bfe_u32 v6, v0, 0, 4
    v_mul_u32_u24 v6, 16, v6
    v_bfe_u32 v7, v0, 0, 5
    v_mul_u32_u24 v7, 1024, v7
    v_add_u32 v5, 0, v3
    v_xor_b32 v5, v5, v6
    v_add_u32 v16, v5, v7
    v_add_u32 v5, 32, v3
    v_xor_b32 v5, v5, v6
    v_add_u32 v17, v5, v7
    v_add_u32 v5, 64, v3
    v_xor_b32 v5, v5, v6
    v_add_u32 v18, v5, v7
    v_add_u32 v5, 96, v3
    v_xor_b32 v5, v5, v6
    v_add_u32 v19, v5, v7
    v_add_u32 v5, 128, v3
    v_xor_b32 v5, v5, v6
    v_add_u32 v20, v5, v7
    v_add_u32 v5, 160, v3
    v_xor_b32 v5, v5, v6
    v_add_u32 v21, v5, v7
    v_add_u32 v5, 192, v3
    v_xor_b32 v5, v5, v6
    v_add_u32 v22, v5, v7
    v_add_u32 v5, 224, v3
    v_xor_b32 v5, v5, v6
    v_add_u32 v23, v5, v7
    s_lshl_b32 s60, s52, 12
    v_bfe_u32 v1, v0, 0, 4
    v_mul_u32_u24 v1, 16, v1
    v_bfe_u32 v5, v0, 4, 2
    v_mul_u32_u24 v5, 8192, v5
    v_add_u32 v1, v1, v5
    v_lshlrev_b32 v5, 2, v0
    v_and_b32 v5, 0xc0, v5
    v_xor_b32 v1, v1, v5
    v_bfe_u32 v2, v0, 0, 2
    v_mul_u32_u24 v2, 8, v2
    v_bfe_u32 v5, v0, 2, 2
    v_mul_u32_u24 v5, 256, v5
    v_add_u32 v2, v2, v5
    v_bfe_u32 v5, v0, 4, 1
    v_mul_u32_u24 v5, 32, v5
    v_add_u32 v2, v2, v5
    v_bfe_u32 v5, v0, 5, 1
    v_mul_u32_u24 v5, 2048, v5
    v_add_u32 v2, v2, v5
    s_lshl_b32 s3, s52, 6
    v_add_u32 v2, s3, v2
    v_lshlrev_b32 v5, 4, v0
    v_and_b32 v5, 0xc0, v5
    v_xor_b32 v2, v2, v5
    s_lshl_b32 s63, s53, 8
    s_lshl_b32 s3, s52, 17
    s_add_u32 s63, s63, s3
    s_add_u32 m0, s60, 65536
    s_add_u32 s62, s63, 0
    buffer_load_dwordx4 v1, s[16:19], s62 offen lds
    s_add_u32 m0, s60, 66560
    s_add_u32 s62, s63, 32768
    buffer_load_dwordx4 v1, s[16:19], s62 offen lds
    s_add_u32 m0, s60, 67584
    s_add_u32 s62, s63, 65536
    buffer_load_dwordx4 v1, s[16:19], s62 offen lds
    s_add_u32 m0, s60, 68608
    s_add_u32 s62, s63, 98304
    buffer_load_dwordx4 v1, s[16:19], s62 offen lds
    s_add_u32 m0, s60, 81920
    s_add_u32 s62, s63, 0
    buffer_load_dwordx4 v1, s[20:23], s62 offen lds
    s_add_u32 m0, s60, 82944
    s_add_u32 s62, s63, 32768
    buffer_load_dwordx4 v1, s[20:23], s62 offen lds
    s_add_u32 m0, s60, 83968
    s_add_u32 s62, s63, 65536
    buffer_load_dwordx4 v1, s[20:23], s62 offen lds
    s_add_u32 m0, s60, 84992
    s_add_u32 s62, s63, 98304
    buffer_load_dwordx4 v1, s[20:23], s62 offen lds
    s_add_u32 m0, s60, 98304
    s_add_u32 s62, s63, 524288
    buffer_load_dwordx4 v1, s[16:19], s62 offen lds
    s_add_u32 m0, s60, 99328
    s_add_u32 s62, s63, 557056
    buffer_load_dwordx4 v1, s[16:19], s62 offen lds
    s_add_u32 m0, s60, 100352
    s_add_u32 s62, s63, 589824
    buffer_load_dwordx4 v1, s[16:19], s62 offen lds
    s_add_u32 m0, s60, 101376
    s_add_u32 s62, s63, 622592
    buffer_load_dwordx4 v1, s[16:19], s62 offen lds
    s_add_u32 m0, s60, 114688
    s_add_u32 s62, s63, 524288
    buffer_load_dwordx4 v1, s[20:23], s62 offen lds
    s_add_u32 m0, s60, 115712
    s_add_u32 s62, s63, 557056
    buffer_load_dwordx4 v1, s[20:23], s62 offen lds
    s_add_u32 m0, s60, 116736
    s_add_u32 s62, s63, 589824
    buffer_load_dwordx4 v1, s[20:23], s62 offen lds
    s_add_u32 m0, s60, 117760
    s_add_u32 s62, s63, 622592
    buffer_load_dwordx4 v1, s[20:23], s62 offen lds
    s_add_u32 m0, s60, 131072
    s_add_u32 s62, s63, 1048576
    buffer_load_dwordx4 v1, s[16:19], s62 offen lds
    s_add_u32 m0, s60, 132096
    s_add_u32 s62, s63, 1081344
    buffer_load_dwordx4 v1, s[16:19], s62 offen lds
    s_add_u32 m0, s60, 133120
    s_add_u32 s62, s63, 1114112
    buffer_load_dwordx4 v1, s[16:19], s62 offen lds
    s_add_u32 m0, s60, 134144
    s_add_u32 s62, s63, 1146880
    buffer_load_dwordx4 v1, s[16:19], s62 offen lds
    s_add_u32 m0, s60, 147456
    s_add_u32 s62, s63, 1048576
    buffer_load_dwordx4 v1, s[20:23], s62 offen lds
    s_add_u32 m0, s60, 148480
    s_add_u32 s62, s63, 1081344
    buffer_load_dwordx4 v1, s[20:23], s62 offen lds
    s_add_u32 m0, s60, 149504
    s_add_u32 s62, s63, 1114112
    buffer_load_dwordx4 v1, s[20:23], s62 offen lds
    s_add_u32 m0, s60, 150528
    s_add_u32 s62, s63, 1146880
    buffer_load_dwordx4 v1, s[20:23], s62 offen lds
    s_waitcnt vmcnt(20)
    s_barrier
    v_add_u32 v5, 65536, v2
    ds_read_b64_tr_b16 a[0:1], v5 offset:0
    ds_read_b64_tr_b16 a[2:3], v5 offset:1024
    ds_read_b64_tr_b16 a[4:5], v5 offset:4096
    ds_read_b64_tr_b16 a[6:7], v5 offset:5120
    ds_read_b64_tr_b16 a[8:9], v5 offset:8192
    ds_read_b64_tr_b16 a[10:11], v5 offset:9216
    ds_read_b64_tr_b16 a[12:13], v5 offset:12288
    ds_read_b64_tr_b16 a[14:15], v5 offset:13312
    s_waitcnt lgkmcnt(0)
    s_waitcnt vmcnt(16)
    s_barrier
    s_add_u32 m0, s60, 65536
    s_add_u32 s62, s63, 1572864
    buffer_load_dwordx4 v1, s[16:19], s62 offen lds
    s_add_u32 m0, s60, 66560
    s_add_u32 s62, s63, 1605632
    buffer_load_dwordx4 v1, s[16:19], s62 offen lds
    s_add_u32 m0, s60, 67584
    s_add_u32 s62, s63, 1638400
    buffer_load_dwordx4 v1, s[16:19], s62 offen lds
    s_add_u32 m0, s60, 68608
    s_add_u32 s62, s63, 1671168
    buffer_load_dwordx4 v1, s[16:19], s62 offen lds
    v_add_u32 v5, 81920, v2
    ds_read_b64_tr_b16 a[128:129], v5 offset:0
    ds_read_b64_tr_b16 a[130:131], v5 offset:1024
    ds_read_b64_tr_b16 a[132:133], v5 offset:4096
    ds_read_b64_tr_b16 a[134:135], v5 offset:5120
    ds_read_b64_tr_b16 a[136:137], v5 offset:8192
    ds_read_b64_tr_b16 a[138:139], v5 offset:9216
    ds_read_b64_tr_b16 a[140:141], v5 offset:12288
    ds_read_b64_tr_b16 a[142:143], v5 offset:13312
    s_waitcnt lgkmcnt(0)
    s_waitcnt vmcnt(16)
    s_barrier
    s_add_u32 m0, s60, 81920
    s_add_u32 s62, s63, 1572864
    buffer_load_dwordx4 v1, s[20:23], s62 offen lds
    s_add_u32 m0, s60, 82944
    s_add_u32 s62, s63, 1605632
    buffer_load_dwordx4 v1, s[20:23], s62 offen lds
    s_add_u32 m0, s60, 83968
    s_add_u32 s62, s63, 1638400
    buffer_load_dwordx4 v1, s[20:23], s62 offen lds
    s_add_u32 m0, s60, 84992
    s_add_u32 s62, s63, 1671168
    buffer_load_dwordx4 v1, s[20:23], s62 offen lds
    v_add_u32 v5, 98304, v2
    ds_read_b64_tr_b16 a[16:17], v5 offset:0
    ds_read_b64_tr_b16 a[18:19], v5 offset:1024
    ds_read_b64_tr_b16 a[20:21], v5 offset:4096
    ds_read_b64_tr_b16 a[22:23], v5 offset:5120
    ds_read_b64_tr_b16 a[24:25], v5 offset:8192
    ds_read_b64_tr_b16 a[26:27], v5 offset:9216
    ds_read_b64_tr_b16 a[28:29], v5 offset:12288
    ds_read_b64_tr_b16 a[30:31], v5 offset:13312
    s_waitcnt lgkmcnt(0)
    s_waitcnt vmcnt(16)
    s_barrier
    s_add_u32 m0, s60, 98304
    s_add_u32 s62, s63, 2097152
    buffer_load_dwordx4 v1, s[16:19], s62 offen lds
    s_add_u32 m0, s60, 99328
    s_add_u32 s62, s63, 2129920
    buffer_load_dwordx4 v1, s[16:19], s62 offen lds
    s_add_u32 m0, s60, 100352
    s_add_u32 s62, s63, 2162688
    buffer_load_dwordx4 v1, s[16:19], s62 offen lds
    s_add_u32 m0, s60, 101376
    s_add_u32 s62, s63, 2195456
    buffer_load_dwordx4 v1, s[16:19], s62 offen lds
    v_add_u32 v5, 114688, v2
    ds_read_b64_tr_b16 a[144:145], v5 offset:0
    ds_read_b64_tr_b16 a[146:147], v5 offset:1024
    ds_read_b64_tr_b16 a[148:149], v5 offset:4096
    ds_read_b64_tr_b16 a[150:151], v5 offset:5120
    ds_read_b64_tr_b16 a[152:153], v5 offset:8192
    ds_read_b64_tr_b16 a[154:155], v5 offset:9216
    ds_read_b64_tr_b16 a[156:157], v5 offset:12288
    ds_read_b64_tr_b16 a[158:159], v5 offset:13312
    s_waitcnt lgkmcnt(0)
    s_waitcnt vmcnt(16)
    s_barrier
    s_add_u32 m0, s60, 114688
    s_add_u32 s62, s63, 2097152
    buffer_load_dwordx4 v1, s[20:23], s62 offen lds
    s_add_u32 m0, s60, 115712
    s_add_u32 s62, s63, 2129920
    buffer_load_dwordx4 v1, s[20:23], s62 offen lds
    s_add_u32 m0, s60, 116736
    s_add_u32 s62, s63, 2162688
    buffer_load_dwordx4 v1, s[20:23], s62 offen lds
    s_add_u32 m0, s60, 117760
    s_add_u32 s62, s63, 2195456
    buffer_load_dwordx4 v1, s[20:23], s62 offen lds
    v_add_u32 v5, 131072, v2
    ds_read_b64_tr_b16 a[32:33], v5 offset:0
    ds_read_b64_tr_b16 a[34:35], v5 offset:1024
    ds_read_b64_tr_b16 a[36:37], v5 offset:4096
    ds_read_b64_tr_b16 a[38:39], v5 offset:5120
    ds_read_b64_tr_b16 a[40:41], v5 offset:8192
    ds_read_b64_tr_b16 a[42:43], v5 offset:9216
    ds_read_b64_tr_b16 a[44:45], v5 offset:12288
    ds_read_b64_tr_b16 a[46:47], v5 offset:13312
    s_waitcnt lgkmcnt(0)
    s_waitcnt vmcnt(16)
    s_barrier
    s_add_u32 m0, s60, 131072
    s_add_u32 s62, s63, 2621440
    buffer_load_dwordx4 v1, s[16:19], s62 offen lds
    s_add_u32 m0, s60, 132096
    s_add_u32 s62, s63, 2654208
    buffer_load_dwordx4 v1, s[16:19], s62 offen lds
    s_add_u32 m0, s60, 133120
    s_add_u32 s62, s63, 2686976
    buffer_load_dwordx4 v1, s[16:19], s62 offen lds
    s_add_u32 m0, s60, 134144
    s_add_u32 s62, s63, 2719744
    buffer_load_dwordx4 v1, s[16:19], s62 offen lds
    v_add_u32 v5, 147456, v2
    ds_read_b64_tr_b16 a[160:161], v5 offset:0
    ds_read_b64_tr_b16 a[162:163], v5 offset:1024
    ds_read_b64_tr_b16 a[164:165], v5 offset:4096
    ds_read_b64_tr_b16 a[166:167], v5 offset:5120
    ds_read_b64_tr_b16 a[168:169], v5 offset:8192
    ds_read_b64_tr_b16 a[170:171], v5 offset:9216
    ds_read_b64_tr_b16 a[172:173], v5 offset:12288
    ds_read_b64_tr_b16 a[174:175], v5 offset:13312
    s_waitcnt lgkmcnt(0)
    s_waitcnt vmcnt(16)
    s_barrier
    s_add_u32 m0, s60, 147456
    s_add_u32 s62, s63, 2621440
    buffer_load_dwordx4 v1, s[20:23], s62 offen lds
    s_add_u32 m0, s60, 148480
    s_add_u32 s62, s63, 2654208
    buffer_load_dwordx4 v1, s[20:23], s62 offen lds
    s_add_u32 m0, s60, 149504
    s_add_u32 s62, s63, 2686976
    buffer_load_dwordx4 v1, s[20:23], s62 offen lds
    s_add_u32 m0, s60, 150528
    s_add_u32 s62, s63, 2719744
    buffer_load_dwordx4 v1, s[20:23], s62 offen lds
    v_add_u32 v5, 65536, v2
    ds_read_b64_tr_b16 a[48:49], v5 offset:0
    ds_read_b64_tr_b16 a[50:51], v5 offset:1024
    ds_read_b64_tr_b16 a[52:53], v5 offset:4096
    ds_read_b64_tr_b16 a[54:55], v5 offset:5120
    ds_read_b64_tr_b16 a[56:57], v5 offset:8192
    ds_read_b64_tr_b16 a[58:59], v5 offset:9216
    ds_read_b64_tr_b16 a[60:61], v5 offset:12288
    ds_read_b64_tr_b16 a[62:63], v5 offset:13312
    s_waitcnt lgkmcnt(0)
    s_waitcnt vmcnt(16)
    s_barrier
    s_add_u32 m0, s60, 65536
    s_add_u32 s62, s63, 3145728
    buffer_load_dwordx4 v1, s[16:19], s62 offen lds
    s_add_u32 m0, s60, 66560
    s_add_u32 s62, s63, 3178496
    buffer_load_dwordx4 v1, s[16:19], s62 offen lds
    s_add_u32 m0, s60, 67584
    s_add_u32 s62, s63, 3211264
    buffer_load_dwordx4 v1, s[16:19], s62 offen lds
    s_add_u32 m0, s60, 68608
    s_add_u32 s62, s63, 3244032
    buffer_load_dwordx4 v1, s[16:19], s62 offen lds
    v_add_u32 v5, 81920, v2
    ds_read_b64_tr_b16 a[176:177], v5 offset:0
    ds_read_b64_tr_b16 a[178:179], v5 offset:1024
    ds_read_b64_tr_b16 a[180:181], v5 offset:4096
    ds_read_b64_tr_b16 a[182:183], v5 offset:5120
    ds_read_b64_tr_b16 a[184:185], v5 offset:8192
    ds_read_b64_tr_b16 a[186:187], v5 offset:9216
    ds_read_b64_tr_b16 a[188:189], v5 offset:12288
    ds_read_b64_tr_b16 a[190:191], v5 offset:13312
    s_waitcnt lgkmcnt(0)
    s_waitcnt vmcnt(16)
    s_barrier
    s_add_u32 m0, s60, 81920
    s_add_u32 s62, s63, 3145728
    buffer_load_dwordx4 v1, s[20:23], s62 offen lds
    s_add_u32 m0, s60, 82944
    s_add_u32 s62, s63, 3178496
    buffer_load_dwordx4 v1, s[20:23], s62 offen lds
    s_add_u32 m0, s60, 83968
    s_add_u32 s62, s63, 3211264
    buffer_load_dwordx4 v1, s[20:23], s62 offen lds
    s_add_u32 m0, s60, 84992
    s_add_u32 s62, s63, 3244032
    buffer_load_dwordx4 v1, s[20:23], s62 offen lds
    v_add_u32 v5, 98304, v2
    ds_read_b64_tr_b16 a[64:65], v5 offset:0
    ds_read_b64_tr_b16 a[66:67], v5 offset:1024
    ds_read_b64_tr_b16 a[68:69], v5 offset:4096
    ds_read_b64_tr_b16 a[70:71], v5 offset:5120
    ds_read_b64_tr_b16 a[72:73], v5 offset:8192
    ds_read_b64_tr_b16 a[74:75], v5 offset:9216
    ds_read_b64_tr_b16 a[76:77], v5 offset:12288
    ds_read_b64_tr_b16 a[78:79], v5 offset:13312
    s_waitcnt lgkmcnt(0)
    s_waitcnt vmcnt(16)
    s_barrier
    s_add_u32 m0, s60, 98304
    s_add_u32 s62, s63, 3670016
    buffer_load_dwordx4 v1, s[16:19], s62 offen lds
    s_add_u32 m0, s60, 99328
    s_add_u32 s62, s63, 3702784
    buffer_load_dwordx4 v1, s[16:19], s62 offen lds
    s_add_u32 m0, s60, 100352
    s_add_u32 s62, s63, 3735552
    buffer_load_dwordx4 v1, s[16:19], s62 offen lds
    s_add_u32 m0, s60, 101376
    s_add_u32 s62, s63, 3768320
    buffer_load_dwordx4 v1, s[16:19], s62 offen lds
    v_add_u32 v5, 114688, v2
    ds_read_b64_tr_b16 a[192:193], v5 offset:0
    ds_read_b64_tr_b16 a[194:195], v5 offset:1024
    ds_read_b64_tr_b16 a[196:197], v5 offset:4096
    ds_read_b64_tr_b16 a[198:199], v5 offset:5120
    ds_read_b64_tr_b16 a[200:201], v5 offset:8192
    ds_read_b64_tr_b16 a[202:203], v5 offset:9216
    ds_read_b64_tr_b16 a[204:205], v5 offset:12288
    ds_read_b64_tr_b16 a[206:207], v5 offset:13312
    s_waitcnt lgkmcnt(0)
    s_waitcnt vmcnt(16)
    s_barrier
    s_add_u32 m0, s60, 114688
    s_add_u32 s62, s63, 3670016
    buffer_load_dwordx4 v1, s[20:23], s62 offen lds
    s_add_u32 m0, s60, 115712
    s_add_u32 s62, s63, 3702784
    buffer_load_dwordx4 v1, s[20:23], s62 offen lds
    s_add_u32 m0, s60, 116736
    s_add_u32 s62, s63, 3735552
    buffer_load_dwordx4 v1, s[20:23], s62 offen lds
    s_add_u32 m0, s60, 117760
    s_add_u32 s62, s63, 3768320
    buffer_load_dwordx4 v1, s[20:23], s62 offen lds
    v_add_u32 v5, 131072, v2
    ds_read_b64_tr_b16 a[80:81], v5 offset:0
    ds_read_b64_tr_b16 a[82:83], v5 offset:1024
    ds_read_b64_tr_b16 a[84:85], v5 offset:4096
    ds_read_b64_tr_b16 a[86:87], v5 offset:5120
    ds_read_b64_tr_b16 a[88:89], v5 offset:8192
    ds_read_b64_tr_b16 a[90:91], v5 offset:9216
    ds_read_b64_tr_b16 a[92:93], v5 offset:12288
    ds_read_b64_tr_b16 a[94:95], v5 offset:13312
    s_waitcnt lgkmcnt(0)
    s_waitcnt vmcnt(16)
    s_barrier
    v_add_u32 v5, 147456, v2
    ds_read_b64_tr_b16 a[208:209], v5 offset:0
    ds_read_b64_tr_b16 a[210:211], v5 offset:1024
    ds_read_b64_tr_b16 a[212:213], v5 offset:4096
    ds_read_b64_tr_b16 a[214:215], v5 offset:5120
    ds_read_b64_tr_b16 a[216:217], v5 offset:8192
    ds_read_b64_tr_b16 a[218:219], v5 offset:9216
    ds_read_b64_tr_b16 a[220:221], v5 offset:12288
    ds_read_b64_tr_b16 a[222:223], v5 offset:13312
    s_waitcnt lgkmcnt(0)
    s_waitcnt vmcnt(12)
    s_barrier
    v_add_u32 v5, 65536, v2
    ds_read_b64_tr_b16 a[96:97], v5 offset:0
    ds_read_b64_tr_b16 a[98:99], v5 offset:1024
    ds_read_b64_tr_b16 a[100:101], v5 offset:4096
    ds_read_b64_tr_b16 a[102:103], v5 offset:5120
    ds_read_b64_tr_b16 a[104:105], v5 offset:8192
    ds_read_b64_tr_b16 a[106:107], v5 offset:9216
    ds_read_b64_tr_b16 a[108:109], v5 offset:12288
    ds_read_b64_tr_b16 a[110:111], v5 offset:13312
    s_waitcnt lgkmcnt(0)
    s_waitcnt vmcnt(8)
    s_barrier
    v_add_u32 v5, 81920, v2
    ds_read_b64_tr_b16 a[224:225], v5 offset:0
    ds_read_b64_tr_b16 a[226:227], v5 offset:1024
    ds_read_b64_tr_b16 a[228:229], v5 offset:4096
    ds_read_b64_tr_b16 a[230:231], v5 offset:5120
    ds_read_b64_tr_b16 a[232:233], v5 offset:8192
    ds_read_b64_tr_b16 a[234:235], v5 offset:9216
    ds_read_b64_tr_b16 a[236:237], v5 offset:12288
    ds_read_b64_tr_b16 a[238:239], v5 offset:13312
    s_waitcnt lgkmcnt(0)
    s_waitcnt vmcnt(4)
    s_barrier
    v_add_u32 v5, 98304, v2
    ds_read_b64_tr_b16 a[112:113], v5 offset:0
    ds_read_b64_tr_b16 a[114:115], v5 offset:1024
    ds_read_b64_tr_b16 a[116:117], v5 offset:4096
    ds_read_b64_tr_b16 a[118:119], v5 offset:5120
    ds_read_b64_tr_b16 a[120:121], v5 offset:8192
    ds_read_b64_tr_b16 a[122:123], v5 offset:9216
    ds_read_b64_tr_b16 a[124:125], v5 offset:12288
    ds_read_b64_tr_b16 a[126:127], v5 offset:13312
    s_waitcnt lgkmcnt(0)
    s_waitcnt vmcnt(0)
    s_barrier
    v_add_u32 v5, 114688, v2
    ds_read_b64_tr_b16 a[240:241], v5 offset:0
    ds_read_b64_tr_b16 a[242:243], v5 offset:1024
    ds_read_b64_tr_b16 a[244:245], v5 offset:4096
    ds_read_b64_tr_b16 a[246:247], v5 offset:5120
    ds_read_b64_tr_b16 a[248:249], v5 offset:8192
    ds_read_b64_tr_b16 a[250:251], v5 offset:9216
    ds_read_b64_tr_b16 a[252:253], v5 offset:12288
    ds_read_b64_tr_b16 a[254:255], v5 offset:13312
    s_waitcnt lgkmcnt(0)
    s_barrier
    s_cmp_lg_u32 s52, 0
    s_cbranch_scc1 L_WD_2
    v_mov_b32 v6, 48
    s_mov_b32 s56, 0
L_poll_3:
    buffer_load_dword v5, v6, s[44:47], 0 offen sc1
    s_waitcnt vmcnt(0)
    v_readfirstlane_b32 s58, v5
    s_nop 0
    s_cmp_ge_u32 s58, 256
    s_cbranch_scc1 L_polled_4
    s_sleep 40
    s_add_u32 s56, s56, 1
    s_cmp_gt_u32 s56, 60000
    s_cbranch_scc1 L_TIMEOUT_1
    s_branch L_poll_3
.p2align 5
L_polled_4:
.p2align 5
L_WD_2:
    s_waitcnt vmcnt(0)
    s_barrier
    s_barrier
    s_add_u32 s61, s54, 8
    s_lshl_b32 s70, s61, 15
    s_lshl_b32 s3, s52, 13
    s_add_u32 s3, s3, 65536
    s_add_u32 m0, s3, 0
    s_nop 0
    buffer_load_dwordx4 v8, s[4:7], s70 offen lds
    s_add_u32 m0, s3, 1024
    s_nop 0
    buffer_load_dwordx4 v9, s[4:7], s70 offen lds
    s_add_u32 m0, s3, 2048
    s_nop 0
    buffer_load_dwordx4 v10, s[4:7], s70 offen lds
    s_add_u32 m0, s3, 3072
    s_nop 0
    buffer_load_dwordx4 v11, s[4:7], s70 offen lds
    s_add_u32 m0, s3, 4096
    s_nop 0
    buffer_load_dwordx4 v12, s[4:7], s70 offen lds
    s_add_u32 m0, s3, 5120
    s_nop 0
    buffer_load_dwordx4 v13, s[4:7], s70 offen lds
    s_add_u32 m0, s3, 6144
    s_nop 0
    buffer_load_dwordx4 v14, s[4:7], s70 offen lds
    s_add_u32 m0, s3, 7168
    s_nop 0
    buffer_load_dwordx4 v15, s[4:7], s70 offen lds
    s_mul_i32 s69, s54, 4096
    s_lshl_b32 s3, s53, 7
    s_add_u32 s69, s69, s3
    s_add_u32 s69, s69, 0
    s_mov_b32 s64, 0
    s_mov_b32 s67, 0
    v_mov_b32 v7, 0
    v_bfe_u32 v6, v0, 0, 3
    v_mul_u32_u24 v6, 16, v6
    v_bfe_u32 v5, v0, 3, 1
    v_mul_u32_u24 v5, 256, v5
    v_add_u32 v6, v6, v5
    v_bfe_u32 v5, v0, 4, 1
    v_mul_u32_u24 v5, 128, v5
    v_add_u32 v6, v6, v5
    v_bfe_u32 v5, v0, 5, 1
    v_mul_u32_u24 v5, 512, v5
    v_add_u32 v6, v6, v5
    v_mov_b32 v148, 0
    v_mov_b32 v149, 0
    v_mov_b32 v150, 0
    v_mov_b32 v151, 0
    s_lshl_b32 s74, s54, 22
    s_add_u32 s74, s74, 67108864
    s_lshl_b32 s3, s52, 20
    s_add_u32 s74, s74, s3
    s_lshl_b32 s3, s53, 15
    s_add_u32 s74, s74, s3
    s_waitcnt vmcnt(8)
    s_barrier
    v_add_u32 v24, s67, v16
    v_add_u32 v25, s67, v17
    v_add_u32 v26, s67, v18
    v_add_u32 v27, s67, v19
    v_add_u32 v28, s67, v20
    v_add_u32 v29, s67, v21
    v_add_u32 v30, s67, v22
    v_add_u32 v31, s67, v23
    ds_read_b128 v[32:35], v24 offset:0
    ds_read_b128 v[36:39], v25 offset:0
    ds_read_b128 v[40:43], v26 offset:0
    ds_read_b128 v[44:47], v27 offset:0
    ds_read_b128 v[48:51], v28 offset:0
    ds_read_b128 v[52:55], v29 offset:0
    ds_read_b128 v[56:59], v30 offset:0
    s_add_u32 s61, s66, 12
    s_lshl_b32 s70, s61, 15
    s_add_u32 s62, s67, 98304
    s_and_b32 s62, s62, 0x1ffff
    s_lshl_b32 s71, s52, 13
    s_add_u32 s71, s71, s62
    s_waitcnt lgkmcnt(6)
    v_mfma_f32_32x32x16_bf16 v[64:79], a[0:3], v[32:35], 0
    ds_read_b128 v[60:63], v31 offset:0
    v_mfma_f32_32x32x16_bf16 v[80:95], v[32:35], a[128:131], 0
    s_waitcnt lgkmcnt(6)
    v_mfma_f32_32x32x16_bf16 v[64:79], a[4:7], v[36:39], v[64:79]
    ds_read_b128 v[32:35], v24 offset:256
    v_mfma_f32_32x32x16_bf16 v[80:95], v[36:39], a[132:135], v[80:95]
    s_waitcnt lgkmcnt(6)
    v_mfma_f32_32x32x16_bf16 v[64:79], a[8:11], v[40:43], v[64:79]
    ds_read_b128 v[36:39], v25 offset:256
    v_mfma_f32_32x32x16_bf16 v[80:95], v[40:43], a[136:139], v[80:95]
    s_waitcnt lgkmcnt(6)
    v_mfma_f32_32x32x16_bf16 v[64:79], a[12:15], v[44:47], v[64:79]
    ds_read_b128 v[40:43], v26 offset:256
    v_mfma_f32_32x32x16_bf16 v[80:95], v[44:47], a[140:143], v[80:95]
    s_waitcnt lgkmcnt(6)
    v_mfma_f32_32x32x16_bf16 v[64:79], a[16:19], v[48:51], v[64:79]
    ds_read_b128 v[44:47], v27 offset:256
    v_mfma_f32_32x32x16_bf16 v[80:95], v[48:51], a[144:147], v[80:95]
    s_waitcnt lgkmcnt(6)
    v_mfma_f32_32x32x16_bf16 v[64:79], a[20:23], v[52:55], v[64:79]
    ds_read_b128 v[48:51], v28 offset:256
    v_mfma_f32_32x32x16_bf16 v[80:95], v[52:55], a[148:151], v[80:95]
    s_waitcnt lgkmcnt(6)
    v_mfma_f32_32x32x16_bf16 v[64:79], a[24:27], v[56:59], v[64:79]
    ds_read_b128 v[52:55], v29 offset:256
    v_mfma_f32_32x32x16_bf16 v[80:95], v[56:59], a[152:155], v[80:95]
    s_waitcnt lgkmcnt(6)
    v_mfma_f32_32x32x16_bf16 v[64:79], a[28:31], v[60:63], v[64:79]
    ds_read_b128 v[56:59], v30 offset:256
    v_mfma_f32_32x32x16_bf16 v[80:95], v[60:63], a[156:159], v[80:95]
    s_waitcnt lgkmcnt(6)
    v_mfma_f32_32x32x16_bf16 v[64:79], a[32:35], v[32:35], v[64:79]
    ds_read_b128 v[60:63], v31 offset:256
    v_mfma_f32_32x32x16_bf16 v[80:95], v[32:35], a[160:163], v[80:95]
    s_waitcnt lgkmcnt(6)
    v_mfma_f32_32x32x16_bf16 v[64:79], a[36:39], v[36:39], v[64:79]
    ds_read_b128 v[32:35], v24 offset:512
    v_mfma_f32_32x32x16_bf16 v[80:95], v[36:39], a[164:167], v[80:95]
    s_waitcnt lgkmcnt(6)
    v_mfma_f32_32x32x16_bf16 v[64:79], a[40:43], v[40:43], v[64:79]
    ds_read_b128 v[36:39], v25 offset:512
    v_mfma_f32_32x32x16_bf16 v[80:95], v[40:43], a[168:171], v[80:95]
    s_waitcnt lgkmcnt(6)
    v_mfma_f32_32x32x16_bf16 v[64:79], a[44:47], v[44:47], v[64:79]
    ds_read_b128 v[40:43], v26 offset:512
    v_mfma_f32_32x32x16_bf16 v[80:95], v[44:47], a[172:175], v[80:95]
    s_waitcnt lgkmcnt(6)
    v_mfma_f32_32x32x16_bf16 v[64:79], a[48:51], v[48:51], v[64:79]
    ds_read_b128 v[44:47], v27 offset:512
    v_mfma_f32_32x32x16_bf16 v[80:95], v[48:51], a[176:179], v[80:95]
    s_add_u32 m0, s71, 0
    s_nop 0
    buffer_load_dwordx4 v8, s[4:7], s70 offen lds
    s_waitcnt lgkmcnt(6)
    v_mfma_f32_32x32x16_bf16 v[64:79], a[52:55], v[52:55], v[64:79]
    ds_read_b128 v[48:51], v28 offset:512
    v_mfma_f32_32x32x16_bf16 v[80:95], v[52:55], a[180:183], v[80:95]
    s_waitcnt lgkmcnt(6)
    v_mfma_f32_32x32x16_bf16 v[64:79], a[56:59], v[56:59], v[64:79]
    ds_read_b128 v[52:55], v29 offset:512
    v_mfma_f32_32x32x16_bf16 v[80:95], v[56:59], a[184:187], v[80:95]
    s_add_u32 m0, s71, 1024
    s_nop 0
    buffer_load_dwordx4 v9, s[4:7], s70 offen lds
    s_waitcnt lgkmcnt(6)
    v_mfma_f32_32x32x16_bf16 v[64:79], a[60:63], v[60:63], v[64:79]
    ds_read_b128 v[56:59], v30 offset:512
    v_mfma_f32_32x32x16_bf16 v[80:95], v[60:63], a[188:191], v[80:95]
    s_waitcnt lgkmcnt(6)
    v_mfma_f32_32x32x16_bf16 v[64:79], a[64:67], v[32:35], v[64:79]
    ds_read_b128 v[60:63], v31 offset:512
    v_mfma_f32_32x32x16_bf16 v[80:95], v[32:35], a[192:195], v[80:95]
    s_add_u32 m0, s71, 2048
    s_nop 0
    buffer_load_dwordx4 v10, s[4:7], s70 offen lds
    s_waitcnt lgkmcnt(6)
    v_mfma_f32_32x32x16_bf16 v[64:79], a[68:71], v[36:39], v[64:79]
    ds_read_b128 v[32:35], v24 offset:768
    v_mfma_f32_32x32x16_bf16 v[80:95], v[36:39], a[196:199], v[80:95]
    s_waitcnt lgkmcnt(6)
    v_mfma_f32_32x32x16_bf16 v[64:79], a[72:75], v[40:43], v[64:79]
    ds_read_b128 v[36:39], v25 offset:768
    v_mfma_f32_32x32x16_bf16 v[80:95], v[40:43], a[200:203], v[80:95]
    s_add_u32 m0, s71, 3072
    s_nop 0
    buffer_load_dwordx4 v11, s[4:7], s70 offen lds
    s_waitcnt lgkmcnt(6)
    v_mfma_f32_32x32x16_bf16 v[64:79], a[76:79], v[44:47], v[64:79]
    ds_read_b128 v[40:43], v26 offset:768
    v_mfma_f32_32x32x16_bf16 v[80:95], v[44:47], a[204:207], v[80:95]
    s_waitcnt lgkmcnt(6)
    v_mfma_f32_32x32x16_bf16 v[64:79], a[80:83], v[48:51], v[64:79]
    ds_read_b128 v[44:47], v27 offset:768
    v_mfma_f32_32x32x16_bf16 v[80:95], v[48:51], a[208:211], v[80:95]
    s_add_u32 m0, s71, 4096
    s_nop 0
    buffer_load_dwordx4 v12, s[4:7], s70 offen lds
    s_waitcnt lgkmcnt(6)
    v_mfma_f32_32x32x16_bf16 v[64:79], a[84:87], v[52:55], v[64:79]
    ds_read_b128 v[48:51], v28 offset:768
    v_mfma_f32_32x32x16_bf16 v[80:95], v[52:55], a[212:215], v[80:95]
    s_waitcnt lgkmcnt(6)
    v_mfma_f32_32x32x16_bf16 v[64:79], a[88:91], v[56:59], v[64:79]
    ds_read_b128 v[52:55], v29 offset:768
    v_mfma_f32_32x32x16_bf16 v[80:95], v[56:59], a[216:219], v[80:95]
    s_add_u32 m0, s71, 5120
    s_nop 0
    buffer_load_dwordx4 v13, s[4:7], s70 offen lds
    s_waitcnt lgkmcnt(6)
    v_mfma_f32_32x32x16_bf16 v[64:79], a[92:95], v[60:63], v[64:79]
    ds_read_b128 v[56:59], v30 offset:768
    v_mfma_f32_32x32x16_bf16 v[80:95], v[60:63], a[220:223], v[80:95]
    s_waitcnt lgkmcnt(6)
    v_mfma_f32_32x32x16_bf16 v[64:79], a[96:99], v[32:35], v[64:79]
    ds_read_b128 v[60:63], v31 offset:768
    v_mfma_f32_32x32x16_bf16 v[80:95], v[32:35], a[224:227], v[80:95]
    s_add_u32 m0, s71, 6144
    s_nop 0
    buffer_load_dwordx4 v14, s[4:7], s70 offen lds
    s_waitcnt lgkmcnt(6)
    v_mfma_f32_32x32x16_bf16 v[64:79], a[100:103], v[36:39], v[64:79]
    v_mfma_f32_32x32x16_bf16 v[80:95], v[36:39], a[228:231], v[80:95]
    s_waitcnt lgkmcnt(5)
    v_mfma_f32_32x32x16_bf16 v[64:79], a[104:107], v[40:43], v[64:79]
    v_mfma_f32_32x32x16_bf16 v[80:95], v[40:43], a[232:235], v[80:95]
    s_add_u32 m0, s71, 7168
    s_nop 0
    buffer_load_dwordx4 v15, s[4:7], s70 offen lds
    s_waitcnt lgkmcnt(4)
    v_mfma_f32_32x32x16_bf16 v[64:79], a[108:111], v[44:47], v[64:79]
    v_mfma_f32_32x32x16_bf16 v[80:95], v[44:47], a[236:239], v[80:95]
    s_waitcnt lgkmcnt(3)
    v_mfma_f32_32x32x16_bf16 v[64:79], a[112:115], v[48:51], v[64:79]
    v_mfma_f32_32x32x16_bf16 v[80:95], v[48:51], a[240:243], v[80:95]
    s_waitcnt lgkmcnt(2)
    v_mfma_f32_32x32x16_bf16 v[64:79], a[116:119], v[52:55], v[64:79]
    v_mfma_f32_32x32x16_bf16 v[80:95], v[52:55], a[244:247], v[80:95]
    s_waitcnt lgkmcnt(1)
    v_mfma_f32_32x32x16_bf16 v[64:79], a[120:123], v[56:59], v[64:79]
    v_mfma_f32_32x32x16_bf16 v[80:95], v[56:59], a[248:251], v[80:95]
    s_waitcnt lgkmcnt(0)
    v_mfma_f32_32x32x16_bf16 v[64:79], a[124:127], v[60:63], v[64:79]
    v_mfma_f32_32x32x16_bf16 v[80:95], v[60:63], a[252:255], v[80:95]
    s_lshl_b32 s68, s66, 5
    s_add_u32 s68, s68, s53
    s_lshl_b32 s68, s68, 13
    s_lshl_b32 s3, s52, 11
    s_add_u32 s68, s68, s3
    s_add_u32 s72, s68, 16777216
    s_add_u32 s73, s68, 33554432
    s_add_u32 s64, s64, 1
    s_add_u32 s66, s66, 4
    s_add_u32 s67, s67, 32768
    s_and_b32 s67, s67, 0x1ffff
    v_cvt_pk_bf16_f32 v128, v64, v65
    v_cvt_pk_bf16_f32 v129, v66, v67
    v_cvt_pk_bf16_f32 v130, v68, v69
    v_cvt_pk_bf16_f32 v131, v70, v71
    v_cvt_pk_bf16_f32 v132, v72, v73
    v_cvt_pk_bf16_f32 v133, v74, v75
    v_cvt_pk_bf16_f32 v134, v76, v77
    v_cvt_pk_bf16_f32 v135, v78, v79
    v_cvt_pk_bf16_f32 v136, v80, v81
    v_cvt_pk_bf16_f32 v137, v82, v83
    v_cvt_pk_bf16_f32 v138, v84, v85
    v_cvt_pk_bf16_f32 v139, v86, v87
    v_cvt_pk_bf16_f32 v140, v88, v89
    v_cvt_pk_bf16_f32 v141, v90, v91
    v_cvt_pk_bf16_f32 v142, v92, v93
    v_cvt_pk_bf16_f32 v143, v94, v95
    buffer_store_dwordx4 v[128:131], v6, s[48:51], s72 offen offset:0 sc1
    buffer_store_dwordx4 v[132:135], v6, s[48:51], s72 offen offset:1024 sc1
    buffer_store_dwordx4 v[136:139], v4, s[48:51], s73 offen offset:0 sc1
    buffer_store_dwordx4 v[140:143], v4, s[48:51], s73 offen offset:1024 sc1
    s_waitcnt vmcnt(0)
    s_barrier
    s_cmp_lg_u32 s52, 0
    s_cbranch_scc1 L_KV_NF_5
    v_mov_b32 v5, s64
    s_mov_b64 exec, 1
    buffer_store_dword v5, v7, s[48:51], s69 offen sc1
    s_mov_b64 exec, -1
L_KV_NF_5:
    s_waitcnt vmcnt(8)
    s_barrier
    v_add_u32 v24, s67, v16
    v_add_u32 v25, s67, v17
    v_add_u32 v26, s67, v18
    v_add_u32 v27, s67, v19
    v_add_u32 v28, s67, v20
    v_add_u32 v29, s67, v21
    v_add_u32 v30, s67, v22
    v_add_u32 v31, s67, v23
    ds_read_b128 v[32:35], v24 offset:0
    ds_read_b128 v[36:39], v25 offset:0
    ds_read_b128 v[40:43], v26 offset:0
    ds_read_b128 v[44:47], v27 offset:0
    ds_read_b128 v[48:51], v28 offset:0
    ds_read_b128 v[52:55], v29 offset:0
    ds_read_b128 v[56:59], v30 offset:0
    s_add_u32 s61, s66, 12
    s_lshl_b32 s70, s61, 15
    s_add_u32 s62, s67, 98304
    s_and_b32 s62, s62, 0x1ffff
    s_lshl_b32 s71, s52, 13
    s_add_u32 s71, s71, s62
    s_waitcnt lgkmcnt(6)
    v_mfma_f32_32x32x16_bf16 v[96:111], a[0:3], v[32:35], 0
    ds_read_b128 v[60:63], v31 offset:0
    v_mfma_f32_32x32x16_bf16 v[112:127], v[32:35], a[128:131], 0
    s_waitcnt lgkmcnt(6)
    v_mfma_f32_32x32x16_bf16 v[96:111], a[4:7], v[36:39], v[96:111]
    ds_read_b128 v[32:35], v24 offset:256
    v_mfma_f32_32x32x16_bf16 v[112:127], v[36:39], a[132:135], v[112:127]
    s_waitcnt lgkmcnt(6)
    v_mfma_f32_32x32x16_bf16 v[96:111], a[8:11], v[40:43], v[96:111]
    ds_read_b128 v[36:39], v25 offset:256
    v_mfma_f32_32x32x16_bf16 v[112:127], v[40:43], a[136:139], v[112:127]
    s_waitcnt lgkmcnt(6)
    v_mfma_f32_32x32x16_bf16 v[96:111], a[12:15], v[44:47], v[96:111]
    ds_read_b128 v[40:43], v26 offset:256
    v_mfma_f32_32x32x16_bf16 v[112:127], v[44:47], a[140:143], v[112:127]
    s_waitcnt lgkmcnt(6)
    v_mfma_f32_32x32x16_bf16 v[96:111], a[16:19], v[48:51], v[96:111]
    ds_read_b128 v[44:47], v27 offset:256
    v_mfma_f32_32x32x16_bf16 v[112:127], v[48:51], a[144:147], v[112:127]
    s_waitcnt lgkmcnt(6)
    v_mfma_f32_32x32x16_bf16 v[96:111], a[20:23], v[52:55], v[96:111]
    ds_read_b128 v[48:51], v28 offset:256
    v_mfma_f32_32x32x16_bf16 v[112:127], v[52:55], a[148:151], v[112:127]
    s_waitcnt lgkmcnt(6)
    v_mfma_f32_32x32x16_bf16 v[96:111], a[24:27], v[56:59], v[96:111]
    ds_read_b128 v[52:55], v29 offset:256
    v_mfma_f32_32x32x16_bf16 v[112:127], v[56:59], a[152:155], v[112:127]
    s_waitcnt lgkmcnt(6)
    v_mfma_f32_32x32x16_bf16 v[96:111], a[28:31], v[60:63], v[96:111]
    ds_read_b128 v[56:59], v30 offset:256
    v_mfma_f32_32x32x16_bf16 v[112:127], v[60:63], a[156:159], v[112:127]
    s_waitcnt lgkmcnt(6)
    v_mfma_f32_32x32x16_bf16 v[96:111], a[32:35], v[32:35], v[96:111]
    ds_read_b128 v[60:63], v31 offset:256
    v_mfma_f32_32x32x16_bf16 v[112:127], v[32:35], a[160:163], v[112:127]
    s_waitcnt lgkmcnt(6)
    v_mfma_f32_32x32x16_bf16 v[96:111], a[36:39], v[36:39], v[96:111]
    ds_read_b128 v[32:35], v24 offset:512
    v_mfma_f32_32x32x16_bf16 v[112:127], v[36:39], a[164:167], v[112:127]
    s_waitcnt lgkmcnt(6)
    v_mfma_f32_32x32x16_bf16 v[96:111], a[40:43], v[40:43], v[96:111]
    ds_read_b128 v[36:39], v25 offset:512
    v_mfma_f32_32x32x16_bf16 v[112:127], v[40:43], a[168:171], v[112:127]
    s_waitcnt lgkmcnt(6)
    v_mfma_f32_32x32x16_bf16 v[96:111], a[44:47], v[44:47], v[96:111]
    ds_read_b128 v[40:43], v26 offset:512
    v_mfma_f32_32x32x16_bf16 v[112:127], v[44:47], a[172:175], v[112:127]
    s_waitcnt lgkmcnt(6)
    v_mfma_f32_32x32x16_bf16 v[96:111], a[48:51], v[48:51], v[96:111]
    ds_read_b128 v[44:47], v27 offset:512
    v_mfma_f32_32x32x16_bf16 v[112:127], v[48:51], a[176:179], v[112:127]
    s_add_u32 m0, s71, 0
    s_nop 0
    buffer_load_dwordx4 v8, s[4:7], s70 offen lds
    s_waitcnt lgkmcnt(6)
    v_mfma_f32_32x32x16_bf16 v[96:111], a[52:55], v[52:55], v[96:111]
    ds_read_b128 v[48:51], v28 offset:512
    v_mfma_f32_32x32x16_bf16 v[112:127], v[52:55], a[180:183], v[112:127]
    s_waitcnt lgkmcnt(6)
    v_mfma_f32_32x32x16_bf16 v[96:111], a[56:59], v[56:59], v[96:111]
    ds_read_b128 v[52:55], v29 offset:512
    v_mfma_f32_32x32x16_bf16 v[112:127], v[56:59], a[184:187], v[112:127]
    s_add_u32 m0, s71, 1024
    s_nop 0
    buffer_load_dwordx4 v9, s[4:7], s70 offen lds
    s_waitcnt lgkmcnt(6)
    v_mfma_f32_32x32x16_bf16 v[96:111], a[60:63], v[60:63], v[96:111]
    ds_read_b128 v[56:59], v30 offset:512
    v_mfma_f32_32x32x16_bf16 v[112:127], v[60:63], a[188:191], v[112:127]
    s_waitcnt lgkmcnt(6)
    v_mfma_f32_32x32x16_bf16 v[96:111], a[64:67], v[32:35], v[96:111]
    ds_read_b128 v[60:63], v31 offset:512
    v_mfma_f32_32x32x16_bf16 v[112:127], v[32:35], a[192:195], v[112:127]
    s_add_u32 m0, s71, 2048
    s_nop 0
    buffer_load_dwordx4 v10, s[4:7], s70 offen lds
    s_waitcnt lgkmcnt(6)
    v_mfma_f32_32x32x16_bf16 v[96:111], a[68:71], v[36:39], v[96:111]
    ds_read_b128 v[32:35], v24 offset:768
    v_mfma_f32_32x32x16_bf16 v[112:127], v[36:39], a[196:199], v[112:127]
    s_waitcnt lgkmcnt(6)
    v_mfma_f32_32x32x16_bf16 v[96:111], a[72:75], v[40:43], v[96:111]
    ds_read_b128 v[36:39], v25 offset:768
    v_mfma_f32_32x32x16_bf16 v[112:127], v[40:43], a[200:203], v[112:127]
    s_add_u32 m0, s71, 3072
    s_nop 0
    buffer_load_dwordx4 v11, s[4:7], s70 offen lds
    s_waitcnt lgkmcnt(6)
    v_mfma_f32_32x32x16_bf16 v[96:111], a[76:79], v[44:47], v[96:111]
    ds_read_b128 v[40:43], v26 offset:768
    v_mfma_f32_32x32x16_bf16 v[112:127], v[44:47], a[204:207], v[112:127]
    s_waitcnt lgkmcnt(6)
    v_mfma_f32_32x32x16_bf16 v[96:111], a[80:83], v[48:51], v[96:111]
    ds_read_b128 v[44:47], v27 offset:768
    v_mfma_f32_32x32x16_bf16 v[112:127], v[48:51], a[208:211], v[112:127]
    s_add_u32 m0, s71, 4096
    s_nop 0
    buffer_load_dwordx4 v12, s[4:7], s70 offen lds
    s_waitcnt lgkmcnt(6)
    v_mfma_f32_32x32x16_bf16 v[96:111], a[84:87], v[52:55], v[96:111]
    ds_read_b128 v[48:51], v28 offset:768
    v_mfma_f32_32x32x16_bf16 v[112:127], v[52:55], a[212:215], v[112:127]
    s_waitcnt lgkmcnt(6)
    v_mfma_f32_32x32x16_bf16 v[96:111], a[88:91], v[56:59], v[96:111]
    ds_read_b128 v[52:55], v29 offset:768
    v_mfma_f32_32x32x16_bf16 v[112:127], v[56:59], a[216:219], v[112:127]
    s_add_u32 m0, s71, 5120
    s_nop 0
    buffer_load_dwordx4 v13, s[4:7], s70 offen lds
    s_waitcnt lgkmcnt(6)
    v_mfma_f32_32x32x16_bf16 v[96:111], a[92:95], v[60:63], v[96:111]
    ds_read_b128 v[56:59], v30 offset:768
    v_mfma_f32_32x32x16_bf16 v[112:127], v[60:63], a[220:223], v[112:127]
    s_waitcnt lgkmcnt(6)
    v_mfma_f32_32x32x16_bf16 v[96:111], a[96:99], v[32:35], v[96:111]
    ds_read_b128 v[60:63], v31 offset:768
    v_mfma_f32_32x32x16_bf16 v[112:127], v[32:35], a[224:227], v[112:127]
    s_add_u32 m0, s71, 6144
    s_nop 0
    buffer_load_dwordx4 v14, s[4:7], s70 offen lds
    s_waitcnt lgkmcnt(6)
    v_mfma_f32_32x32x16_bf16 v[96:111], a[100:103], v[36:39], v[96:111]
    v_mfma_f32_32x32x16_bf16 v[112:127], v[36:39], a[228:231], v[112:127]
    s_waitcnt lgkmcnt(5)
    v_mfma_f32_32x32x16_bf16 v[96:111], a[104:107], v[40:43], v[96:111]
    v_mfma_f32_32x32x16_bf16 v[112:127], v[40:43], a[232:235], v[112:127]
    s_add_u32 m0, s71, 7168
    s_nop 0
    buffer_load_dwordx4 v15, s[4:7], s70 offen lds
    s_waitcnt lgkmcnt(4)
    v_mfma_f32_32x32x16_bf16 v[96:111], a[108:111], v[44:47], v[96:111]
    v_mfma_f32_32x32x16_bf16 v[112:127], v[44:47], a[236:239], v[112:127]
    s_waitcnt lgkmcnt(3)
    v_mfma_f32_32x32x16_bf16 v[96:111], a[112:115], v[48:51], v[96:111]
    v_mfma_f32_32x32x16_bf16 v[112:127], v[48:51], a[240:243], v[112:127]
    s_waitcnt lgkmcnt(2)
    v_mfma_f32_32x32x16_bf16 v[96:111], a[116:119], v[52:55], v[96:111]
    v_mfma_f32_32x32x16_bf16 v[112:127], v[52:55], a[244:247], v[112:127]
    s_waitcnt lgkmcnt(1)
    v_mfma_f32_32x32x16_bf16 v[96:111], a[120:123], v[56:59], v[96:111]
    v_mfma_f32_32x32x16_bf16 v[112:127], v[56:59], a[248:251], v[112:127]
    s_waitcnt lgkmcnt(0)
    v_mfma_f32_32x32x16_bf16 v[96:111], a[124:127], v[60:63], v[96:111]
    v_mfma_f32_32x32x16_bf16 v[112:127], v[60:63], a[252:255], v[112:127]
    s_lshl_b32 s68, s66, 5
    s_add_u32 s68, s68, s53
    s_lshl_b32 s68, s68, 13
    s_lshl_b32 s3, s52, 11
    s_add_u32 s68, s68, s3
    s_add_u32 s72, s68, 16777216
    s_add_u32 s73, s68, 33554432
    s_add_u32 s64, s64, 1
    s_add_u32 s66, s66, 4
    s_add_u32 s67, s67, 32768
    s_and_b32 s67, s67, 0x1ffff
    s_waitcnt vmcnt(8)
    s_barrier
    s_sub_u32 s61, s64, 1
    s_cmp_lg_u32 s52, 0
    s_cbranch_scc1 L_KV_NF_6
    v_mov_b32 v5, s61
    s_mov_b64 exec, 1
    buffer_store_dword v5, v7, s[48:51], s69 offen sc1
    s_mov_b64 exec, -1
L_KV_NF_6:
    v_add_u32 v24, s67, v16
    v_add_u32 v25, s67, v17
    v_add_u32 v26, s67, v18
    v_add_u32 v27, s67, v19
    v_add_u32 v28, s67, v20
    v_add_u32 v29, s67, v21
    v_add_u32 v30, s67, v22
    v_add_u32 v31, s67, v23
    ds_read_b128 v[32:35], v24 offset:0
    ds_read_b128 v[36:39], v25 offset:0
    ds_read_b128 v[40:43], v26 offset:0
    ds_read_b128 v[44:47], v27 offset:0
    ds_read_b128 v[48:51], v28 offset:0
    ds_read_b128 v[52:55], v29 offset:0
    ds_read_b128 v[56:59], v30 offset:0
    s_add_u32 s61, s66, 12
    s_lshl_b32 s70, s61, 15
    s_add_u32 s62, s67, 98304
    s_and_b32 s62, s62, 0x1ffff
    s_lshl_b32 s71, s52, 13
    s_add_u32 s71, s71, s62
    s_waitcnt lgkmcnt(6)
    v_mfma_f32_32x32x16_bf16 v[64:79], a[0:3], v[32:35], 0
    ds_read_b128 v[60:63], v31 offset:0
    v_cvt_pk_bf16_f32 v128, v96, v97
    v_cvt_pk_bf16_f32 v129, v98, v99
    v_mfma_f32_32x32x16_bf16 v[80:95], v[32:35], a[128:131], 0
    s_waitcnt lgkmcnt(6)
    v_mfma_f32_32x32x16_bf16 v[64:79], a[4:7], v[36:39], v[64:79]
    ds_read_b128 v[32:35], v24 offset:256
    v_cvt_pk_bf16_f32 v130, v100, v101
    v_cvt_pk_bf16_f32 v131, v102, v103
    v_mfma_f32_32x32x16_bf16 v[80:95], v[36:39], a[132:135], v[80:95]
    s_waitcnt lgkmcnt(6)
    v_mfma_f32_32x32x16_bf16 v[64:79], a[8:11], v[40:43], v[64:79]
    ds_read_b128 v[36:39], v25 offset:256
    v_cvt_pk_bf16_f32 v132, v104, v105
    v_cvt_pk_bf16_f32 v133, v106, v107
    v_mfma_f32_32x32x16_bf16 v[80:95], v[40:43], a[136:139], v[80:95]
    buffer_store_dwordx4 v[128:131], v6, s[48:51], s72 offen offset:0 sc1
    s_waitcnt lgkmcnt(6)
    v_mfma_f32_32x32x16_bf16 v[64:79], a[12:15], v[44:47], v[64:79]
    ds_read_b128 v[40:43], v26 offset:256
    v_cvt_pk_bf16_f32 v134, v108, v109
    v_cvt_pk_bf16_f32 v135, v110, v111
    v_mfma_f32_32x32x16_bf16 v[80:95], v[44:47], a[140:143], v[80:95]
    s_waitcnt lgkmcnt(6)
    v_mfma_f32_32x32x16_bf16 v[64:79], a[16:19], v[48:51], v[64:79]
    ds_read_b128 v[44:47], v27 offset:256
    v_cvt_pk_bf16_f32 v136, v112, v113
    v_cvt_pk_bf16_f32 v137, v114, v115
    v_mfma_f32_32x32x16_bf16 v[80:95], v[48:51], a[144:147], v[80:95]
    buffer_store_dwordx4 v[132:135], v6, s[48:51], s72 offen offset:1024 sc1
    s_waitcnt lgkmcnt(6)
    v_mfma_f32_32x32x16_bf16 v[64:79], a[20:23], v[52:55], v[64:79]
    ds_read_b128 v[48:51], v28 offset:256
    v_cvt_pk_bf16_f32 v138, v116, v117
    v_cvt_pk_bf16_f32 v139, v118, v119
    v_mfma_f32_32x32x16_bf16 v[80:95], v[52:55], a[148:151], v[80:95]
    s_waitcnt lgkmcnt(6)
    v_mfma_f32_32x32x16_bf16 v[64:79], a[24:27], v[56:59], v[64:79]
    ds_read_b128 v[52:55], v29 offset:256
    v_cvt_pk_bf16_f32 v140, v120, v121
    v_cvt_pk_bf16_f32 v141, v122, v123
    v_mfma_f32_32x32x16_bf16 v[80:95], v[56:59], a[152:155], v[80:95]
    buffer_store_dwordx4 v[136:139], v4, s[48:51], s73 offen offset:0 sc1
    s_waitcnt lgkmcnt(6)
    v_mfma_f32_32x32x16_bf16 v[64:79], a[28:31], v[60:63], v[64:79]
    ds_read_b128 v[56:59], v30 offset:256
    v_cvt_pk_bf16_f32 v142, v124, v125
    v_cvt_pk_bf16_f32 v143, v126, v127
    v_mfma_f32_32x32x16_bf16 v[80:95], v[60:63], a[156:159], v[80:95]
    s_waitcnt lgkmcnt(6)
    v_mfma_f32_32x32x16_bf16 v[64:79], a[32:35], v[32:35], v[64:79]
    ds_read_b128 v[60:63], v31 offset:256
    v_mfma_f32_32x32x16_bf16 v[80:95], v[32:35], a[160:163], v[80:95]
    buffer_store_dwordx4 v[140:143], v4, s[48:51], s73 offen offset:1024 sc1
    s_waitcnt lgkmcnt(6)
    v_mfma_f32_32x32x16_bf16 v[64:79], a[36:39], v[36:39], v[64:79]
    ds_read_b128 v[32:35], v24 offset:512
    v_mfma_f32_32x32x16_bf16 v[80:95], v[36:39], a[164:167], v[80:95]
    s_waitcnt lgkmcnt(6)
    v_mfma_f32_32x32x16_bf16 v[64:79], a[40:43], v[40:43], v[64:79]
    ds_read_b128 v[36:39], v25 offset:512
    v_mfma_f32_32x32x16_bf16 v[80:95], v[40:43], a[168:171], v[80:95]
    s_cmp_lt_u32 s64, 8
    s_cbranch_scc1 L_KV_RI_7
    buffer_store_dwordx4 v[148:151], v4, s[48:51], s74 offen offset:0 sc1
    buffer_store_dwordx4 v[148:151], v4, s[48:51], s74 offen offset:1024 sc1
    buffer_store_dwordx4 v[148:151], v4, s[48:51], s74 offen offset:2048 sc1
    buffer_store_dwordx4 v[148:151], v4, s[48:51], s74 offen offset:3072 sc1
    s_add_u32 s74, s74, 4096
L_KV_RI_7:
    s_waitcnt lgkmcnt(6)
    v_mfma_f32_32x32x16_bf16 v[64:79], a[44:47], v[44:47], v[64:79]
    ds_read_b128 v[40:43], v26 offset:512
    v_mfma_f32_32x32x16_bf16 v[80:95], v[44:47], a[172:175], v[80:95]
    s_waitcnt lgkmcnt(6)
    v_mfma_f32_32x32x16_bf16 v[64:79], a[48:51], v[48:51], v[64:79]
    ds_read_b128 v[44:47], v27 offset:512
    v_mfma_f32_32x32x16_bf16 v[80:95], v[48:51], a[176:179], v[80:95]
    s_add_u32 m0, s71, 0
    s_nop 0
    buffer_load_dwordx4 v8, s[4:7], s70 offen lds
    s_waitcnt lgkmcnt(6)
    v_mfma_f32_32x32x16_bf16 v[64:79], a[52:55], v[52:55], v[64:79]
    ds_read_b128 v[48:51], v28 offset:512
    v_mfma_f32_32x32x16_bf16 v[80:95], v[52:55], a[180:183], v[80:95]
    s_waitcnt lgkmcnt(6)
    v_mfma_f32_32x32x16_bf16 v[64:79], a[56:59], v[56:59], v[64:79]
    ds_read_b128 v[52:55], v29 offset:512
    v_mfma_f32_32x32x16_bf16 v[80:95], v[56:59], a[184:187], v[80:95]
    s_add_u32 m0, s71, 1024
    s_nop 0
    buffer_load_dwordx4 v9, s[4:7], s70 offen lds
    s_waitcnt lgkmcnt(6)
    v_mfma_f32_32x32x16_bf16 v[64:79], a[60:63], v[60:63], v[64:79]
    ds_read_b128 v[56:59], v30 offset:512
    v_mfma_f32_32x32x16_bf16 v[80:95], v[60:63], a[188:191], v[80:95]
    s_waitcnt lgkmcnt(6)
    v_mfma_f32_32x32x16_bf16 v[64:79], a[64:67], v[32:35], v[64:79]
    ds_read_b128 v[60:63], v31 offset:512
    v_mfma_f32_32x32x16_bf16 v[80:95], v[32:35], a[192:195], v[80:95]
    s_add_u32 m0, s71, 2048
    s_nop 0
    buffer_load_dwordx4 v10, s[4:7], s70 offen lds
    s_waitcnt lgkmcnt(6)
    v_mfma_f32_32x32x16_bf16 v[64:79], a[68:71], v[36:39], v[64:79]
    ds_read_b128 v[32:35], v24 offset:768
    v_mfma_f32_32x32x16_bf16 v[80:95], v[36:39], a[196:199], v[80:95]
    s_waitcnt lgkmcnt(6)
    v_mfma_f32_32x32x16_bf16 v[64:79], a[72:75], v[40:43], v[64:79]
    ds_read_b128 v[36:39], v25 offset:768
    v_mfma_f32_32x32x16_bf16 v[80:95], v[40:43], a[200:203], v[80:95]
    s_add_u32 m0, s71, 3072
    s_nop 0
    buffer_load_dwordx4 v11, s[4:7], s70 offen lds
    s_waitcnt lgkmcnt(6)
    v_mfma_f32_32x32x16_bf16 v[64:79], a[76:79], v[44:47], v[64:79]
    ds_read_b128 v[40:43], v26 offset:768
    v_mfma_f32_32x32x16_bf16 v[80:95], v[44:47], a[204:207], v[80:95]
    s_waitcnt lgkmcnt(6)
    v_mfma_f32_32x32x16_bf16 v[64:79], a[80:83], v[48:51], v[64:79]
    ds_read_b128 v[44:47], v27 offset:768
    v_mfma_f32_32x32x16_bf16 v[80:95], v[48:51], a[208:211], v[80:95]
    s_add_u32 m0, s71, 4096
    s_nop 0
    buffer_load_dwordx4 v12, s[4:7], s70 offen lds
    s_waitcnt lgkmcnt(6)
    v_mfma_f32_32x32x16_bf16 v[64:79], a[84:87], v[52:55], v[64:79]
    ds_read_b128 v[48:51], v28 offset:768
    v_mfma_f32_32x32x16_bf16 v[80:95], v[52:55], a[212:215], v[80:95]
    s_waitcnt lgkmcnt(6)
    v_mfma_f32_32x32x16_bf16 v[64:79], a[88:91], v[56:59], v[64:79]
    ds_read_b128 v[52:55], v29 offset:768
    v_mfma_f32_32x32x16_bf16 v[80:95], v[56:59], a[216:219], v[80:95]
    s_add_u32 m0, s71, 5120
    s_nop 0
    buffer_load_dwordx4 v13, s[4:7], s70 offen lds
    s_waitcnt lgkmcnt(6)
    v_mfma_f32_32x32x16_bf16 v[64:79], a[92:95], v[60:63], v[64:79]
    ds_read_b128 v[56:59], v30 offset:768
    v_mfma_f32_32x32x16_bf16 v[80:95], v[60:63], a[220:223], v[80:95]
    s_waitcnt lgkmcnt(6)
    v_mfma_f32_32x32x16_bf16 v[64:79], a[96:99], v[32:35], v[64:79]
    ds_read_b128 v[60:63], v31 offset:768
    v_mfma_f32_32x32x16_bf16 v[80:95], v[32:35], a[224:227], v[80:95]
    s_add_u32 m0, s71, 6144
    s_nop 0
    buffer_load_dwordx4 v14, s[4:7], s70 offen lds
    s_waitcnt lgkmcnt(6)
    v_mfma_f32_32x32x16_bf16 v[64:79], a[100:103], v[36:39], v[64:79]
    v_mfma_f32_32x32x16_bf16 v[80:95], v[36:39], a[228:231], v[80:95]
    s_waitcnt lgkmcnt(5)
    v_mfma_f32_32x32x16_bf16 v[64:79], a[104:107], v[40:43], v[64:79]
    v_mfma_f32_32x32x16_bf16 v[80:95], v[40:43], a[232:235], v[80:95]
    s_add_u32 m0, s71, 7168
    s_nop 0
    buffer_load_dwordx4 v15, s[4:7], s70 offen lds
    s_waitcnt lgkmcnt(4)
    v_mfma_f32_32x32x16_bf16 v[64:79], a[108:111], v[44:47], v[64:79]
    v_mfma_f32_32x32x16_bf16 v[80:95], v[44:47], a[236:239], v[80:95]
    s_waitcnt lgkmcnt(3)
    v_mfma_f32_32x32x16_bf16 v[64:79], a[112:115], v[48:51], v[64:79]
    v_mfma_f32_32x32x16_bf16 v[80:95], v[48:51], a[240:243], v[80:95]
    s_waitcnt lgkmcnt(2)
    v_mfma_f32_32x32x16_bf16 v[64:79], a[116:119], v[52:55], v[64:79]
    v_mfma_f32_32x32x16_bf16 v[80:95], v[52:55], a[244:247], v[80:95]
    s_waitcnt lgkmcnt(1)
    v_mfma_f32_32x32x16_bf16 v[64:79], a[120:123], v[56:59], v[64:79]
    v_mfma_f32_32x32x16_bf16 v[80:95], v[56:59], a[248:251], v[80:95]
    s_waitcnt lgkmcnt(0)
    v_mfma_f32_32x32x16_bf16 v[64:79], a[124:127], v[60:63], v[64:79]
    v_mfma_f32_32x32x16_bf16 v[80:95], v[60:63], a[252:255], v[80:95]
    s_lshl_b32 s68, s66, 5
    s_add_u32 s68, s68, s53
    s_lshl_b32 s68, s68, 13
    s_lshl_b32 s3, s52, 11
    s_add_u32 s68, s68, s3
    s_add_u32 s72, s68, 16777216
    s_add_u32 s73, s68, 33554432
    s_add_u32 s64, s64, 1
    s_add_u32 s66, s66, 4
    s_add_u32 s67, s67, 32768
    s_and_b32 s67, s67, 0x1ffff
L_KV_LOOP:
    s_waitcnt vmcnt(8)
    s_barrier
    s_sub_u32 s61, s64, 1
    s_cmp_lg_u32 s52, 0
    s_cbranch_scc1 L_KV_NF_8
    v_mov_b32 v5, s61
    s_mov_b64 exec, 1
    buffer_store_dword v5, v7, s[48:51], s69 offen sc1
    s_mov_b64 exec, -1
L_KV_NF_8:
    v_add_u32 v24, s67, v16
    v_add_u32 v25, s67, v17
    v_add_u32 v26, s67, v18
    v_add_u32 v27, s67, v19
    v_add_u32 v28, s67, v20
    v_add_u32 v29, s67, v21
    v_add_u32 v30, s67, v22
    v_add_u32 v31, s67, v23
    ds_read_b128 v[32:35], v24 offset:0
    ds_read_b128 v[36:39], v25 offset:0
    ds_read_b128 v[40:43], v26 offset:0
    ds_read_b128 v[44:47], v27 offset:0
    ds_read_b128 v[48:51], v28 offset:0
    ds_read_b128 v[52:55], v29 offset:0
    ds_read_b128 v[56:59], v30 offset:0
    s_add_u32 s61, s66, 12
    s_lshl_b32 s70, s61, 15
    s_add_u32 s62, s67, 98304
    s_and_b32 s62, s62, 0x1ffff
    s_lshl_b32 s71, s52, 13
    s_add_u32 s71, s71, s62
    s_waitcnt lgkmcnt(6)
    v_mfma_f32_32x32x16_bf16 v[96:111], a[0:3], v[32:35], 0
    ds_read_b128 v[60:63], v31 offset:0
    v_cvt_pk_bf16_f32 v128, v64, v65
    v_cvt_pk_bf16_f32 v129, v66, v67
    v_mfma_f32_32x32x16_bf16 v[112:127], v[32:35], a[128:131], 0
    s_waitcnt lgkmcnt(6)
    v_mfma_f32_32x32x16_bf16 v[96:111], a[4:7], v[36:39], v[96:111]
    ds_read_b128 v[32:35], v24 offset:256
    v_cvt_pk_bf16_f32 v130, v68, v69
    v_cvt_pk_bf16_f32 v131, v70, v71
    v_mfma_f32_32x32x16_bf16 v[112:127], v[36:39], a[132:135], v[112:127]
    s_waitcnt lgkmcnt(6)
    v_mfma_f32_32x32x16_bf16 v[96:111], a[8:11], v[40:43], v[96:111]
    ds_read_b128 v[36:39], v25 offset:256
    v_cvt_pk_bf16_f32 v132, v72, v73
    v_cvt_pk_bf16_f32 v133, v74, v75
    v_mfma_f32_32x32x16_bf16 v[112:127], v[40:43], a[136:139], v[112:127]
    buffer_store_dwordx4 v[128:131], v6, s[48:51], s72 offen offset:0 sc1
    s_waitcnt lgkmcnt(6)
    v_mfma_f32_32x32x16_bf16 v[96:111], a[12:15], v[44:47], v[96:111]
    ds_read_b128 v[40:43], v26 offset:256
    v_cvt_pk_bf16_f32 v134, v76, v77
    v_cvt_pk_bf16_f32 v135, v78, v79
    v_mfma_f32_32x32x16_bf16 v[112:127], v[44:47], a[140:143], v[112:127]
    s_waitcnt lgkmcnt(6)
    v_mfma_f32_32x32x16_bf16 v[96:111], a[16:19], v[48:51], v[96:111]
    ds_read_b128 v[44:47], v27 offset:256
    v_cvt_pk_bf16_f32 v136, v80, v81
    v_cvt_pk_bf16_f32 v137, v82, v83
    v_mfma_f32_32x32x16_bf16 v[112:127], v[48:51], a[144:147], v[112:127]
    buffer_store_dwordx4 v[132:135], v6, s[48:51], s72 offen offset:1024 sc1
    s_waitcnt lgkmcnt(6)
    v_mfma_f32_32x32x16_bf16 v[96:111], a[20:23], v[52:55], v[96:111]
    ds_read_b128 v[48:51], v28 offset:256
    v_cvt_pk_bf16_f32 v138, v84, v85
    v_cvt_pk_bf16_f32 v139, v86, v87
    v_mfma_f32_32x32x16_bf16 v[112:127], v[52:55], a[148:151], v[112:127]
    s_waitcnt lgkmcnt(6)
    v_mfma_f32_32x32x16_bf16 v[96:111], a[24:27], v[56:59], v[96:111]
    ds_read_b128 v[52:55], v29 offset:256
    v_cvt_pk_bf16_f32 v140, v88, v89
    v_cvt_pk_bf16_f32 v141, v90, v91
    v_mfma_f32_32x32x16_bf16 v[112:127], v[56:59], a[152:155], v[112:127]
    buffer_store_dwordx4 v[136:139], v4, s[48:51], s73 offen offset:0 sc1
    s_waitcnt lgkmcnt(6)
    v_mfma_f32_32x32x16_bf16 v[96:111], a[28:31], v[60:63], v[96:111]
    ds_read_b128 v[56:59], v30 offset:256
    v_cvt_pk_bf16_f32 v142, v92, v93
    v_cvt_pk_bf16_f32 v143, v94, v95
    v_mfma_f32_32x32x16_bf16 v[112:127], v[60:63], a[156:159], v[112:127]
    s_waitcnt lgkmcnt(6)
    v_mfma_f32_32x32x16_bf16 v[96:111], a[32:35], v[32:35], v[96:111]
    ds_read_b128 v[60:63], v31 offset:256
    v_mfma_f32_32x32x16_bf16 v[112:127], v[32:35], a[160:163], v[112:127]
    buffer_store_dwordx4 v[140:143], v4, s[48:51], s73 offen offset:1024 sc1
    s_waitcnt lgkmcnt(6)
    v_mfma_f32_32x32x16_bf16 v[96:111], a[36:39], v[36:39], v[96:111]
    ds_read_b128 v[32:35], v24 offset:512
    v_mfma_f32_32x32x16_bf16 v[112:127], v[36:39], a[164:167], v[112:127]
    s_waitcnt lgkmcnt(6)
    v_mfma_f32_32x32x16_bf16 v[96:111], a[40:43], v[40:43], v[96:111]
    ds_read_b128 v[36:39], v25 offset:512
    v_mfma_f32_32x32x16_bf16 v[112:127], v[40:43], a[168:171], v[112:127]
    s_cmp_lt_u32 s64, 8
    s_cbranch_scc1 L_KV_RI_9
    buffer_store_dwordx4 v[148:151], v4, s[48:51], s74 offen offset:0 sc1
    buffer_store_dwordx4 v[148:151], v4, s[48:51], s74 offen offset:1024 sc1
    buffer_store_dwordx4 v[148:151], v4, s[48:51], s74 offen offset:2048 sc1
    buffer_store_dwordx4 v[148:151], v4, s[48:51], s74 offen offset:3072 sc1
    s_add_u32 s74, s74, 4096
L_KV_RI_9:
    s_waitcnt lgkmcnt(6)
    v_mfma_f32_32x32x16_bf16 v[96:111], a[44:47], v[44:47], v[96:111]
    ds_read_b128 v[40:43], v26 offset:512
    v_mfma_f32_32x32x16_bf16 v[112:127], v[44:47], a[172:175], v[112:127]
    s_waitcnt lgkmcnt(6)
    v_mfma_f32_32x32x16_bf16 v[96:111], a[48:51], v[48:51], v[96:111]
    ds_read_b128 v[44:47], v27 offset:512
    v_mfma_f32_32x32x16_bf16 v[112:127], v[48:51], a[176:179], v[112:127]
    s_add_u32 m0, s71, 0
    s_nop 0
    buffer_load_dwordx4 v8, s[4:7], s70 offen lds
    s_waitcnt lgkmcnt(6)
    v_mfma_f32_32x32x16_bf16 v[96:111], a[52:55], v[52:55], v[96:111]
    ds_read_b128 v[48:51], v28 offset:512
    v_mfma_f32_32x32x16_bf16 v[112:127], v[52:55], a[180:183], v[112:127]
    s_waitcnt lgkmcnt(6)
    v_mfma_f32_32x32x16_bf16 v[96:111], a[56:59], v[56:59], v[96:111]
    ds_read_b128 v[52:55], v29 offset:512
    v_mfma_f32_32x32x16_bf16 v[112:127], v[56:59], a[184:187], v[112:127]
    s_add_u32 m0, s71, 1024
    s_nop 0
    buffer_load_dwordx4 v9, s[4:7], s70 offen lds
    s_waitcnt lgkmcnt(6)
    v_mfma_f32_32x32x16_bf16 v[96:111], a[60:63], v[60:63], v[96:111]
    ds_read_b128 v[56:59], v30 offset:512
    v_mfma_f32_32x32x16_bf16 v[112:127], v[60:63], a[188:191], v[112:127]
    s_waitcnt lgkmcnt(6)
    v_mfma_f32_32x32x16_bf16 v[96:111], a[64:67], v[32:35], v[96:111]
    ds_read_b128 v[60:63], v31 offset:512
    v_mfma_f32_32x32x16_bf16 v[112:127], v[32:35], a[192:195], v[112:127]
    s_add_u32 m0, s71, 2048
    s_nop 0
    buffer_load_dwordx4 v10, s[4:7], s70 offen lds
    s_waitcnt lgkmcnt(6)
    v_mfma_f32_32x32x16_bf16 v[96:111], a[68:71], v[36:39], v[96:111]
    ds_read_b128 v[32:35], v24 offset:768
    v_mfma_f32_32x32x16_bf16 v[112:127], v[36:39], a[196:199], v[112:127]
    s_waitcnt lgkmcnt(6)
    v_mfma_f32_32x32x16_bf16 v[96:111], a[72:75], v[40:43], v[96:111]
    ds_read_b128 v[36:39], v25 offset:768
    v_mfma_f32_32x32x16_bf16 v[112:127], v[40:43], a[200:203], v[112:127]
    s_add_u32 m0, s71, 3072
    s_nop 0
    buffer_load_dwordx4 v11, s[4:7], s70 offen lds
    s_waitcnt lgkmcnt(6)
    v_mfma_f32_32x32x16_bf16 v[96:111], a[76:79], v[44:47], v[96:111]
    ds_read_b128 v[40:43], v26 offset:768
    v_mfma_f32_32x32x16_bf16 v[112:127], v[44:47], a[204:207], v[112:127]
    s_waitcnt lgkmcnt(6)
    v_mfma_f32_32x32x16_bf16 v[96:111], a[80:83], v[48:51], v[96:111]
    ds_read_b128 v[44:47], v27 offset:768
    v_mfma_f32_32x32x16_bf16 v[112:127], v[48:51], a[208:211], v[112:127]
    s_add_u32 m0, s71, 4096
    s_nop 0
    buffer_load_dwordx4 v12, s[4:7], s70 offen lds
    s_waitcnt lgkmcnt(6)
    v_mfma_f32_32x32x16_bf16 v[96:111], a[84:87], v[52:55], v[96:111]
    ds_read_b128 v[48:51], v28 offset:768
    v_mfma_f32_32x32x16_bf16 v[112:127], v[52:55], a[212:215], v[112:127]
    s_waitcnt lgkmcnt(6)
    v_mfma_f32_32x32x16_bf16 v[96:111], a[88:91], v[56:59], v[96:111]
    ds_read_b128 v[52:55], v29 offset:768
    v_mfma_f32_32x32x16_bf16 v[112:127], v[56:59], a[216:219], v[112:127]
    s_add_u32 m0, s71, 5120
    s_nop 0
    buffer_load_dwordx4 v13, s[4:7], s70 offen lds
    s_waitcnt lgkmcnt(6)
    v_mfma_f32_32x32x16_bf16 v[96:111], a[92:95], v[60:63], v[96:111]
    ds_read_b128 v[56:59], v30 offset:768
    v_mfma_f32_32x32x16_bf16 v[112:127], v[60:63], a[220:223], v[112:127]
    s_waitcnt lgkmcnt(6)
    v_mfma_f32_32x32x16_bf16 v[96:111], a[96:99], v[32:35], v[96:111]
    ds_read_b128 v[60:63], v31 offset:768
    v_mfma_f32_32x32x16_bf16 v[112:127], v[32:35], a[224:227], v[112:127]
    s_add_u32 m0, s71, 6144
    s_nop 0
    buffer_load_dwordx4 v14, s[4:7], s70 offen lds
    s_waitcnt lgkmcnt(6)
    v_mfma_f32_32x32x16_bf16 v[96:111], a[100:103], v[36:39], v[96:111]
    v_mfma_f32_32x32x16_bf16 v[112:127], v[36:39], a[228:231], v[112:127]
    s_waitcnt lgkmcnt(5)
    v_mfma_f32_32x32x16_bf16 v[96:111], a[104:107], v[40:43], v[96:111]
    v_mfma_f32_32x32x16_bf16 v[112:127], v[40:43], a[232:235], v[112:127]
    s_add_u32 m0, s71, 7168
    s_nop 0
    buffer_load_dwordx4 v15, s[4:7], s70 offen lds
    s_waitcnt lgkmcnt(4)
    v_mfma_f32_32x32x16_bf16 v[96:111], a[108:111], v[44:47], v[96:111]
    v_mfma_f32_32x32x16_bf16 v[112:127], v[44:47], a[236:239], v[112:127]
    s_waitcnt lgkmcnt(3)
    v_mfma_f32_32x32x16_bf16 v[96:111], a[112:115], v[48:51], v[96:111]
    v_mfma_f32_32x32x16_bf16 v[112:127], v[48:51], a[240:243], v[112:127]
    s_waitcnt lgkmcnt(2)
    v_mfma_f32_32x32x16_bf16 v[96:111], a[116:119], v[52:55], v[96:111]
    v_mfma_f32_32x32x16_bf16 v[112:127], v[52:55], a[244:247], v[112:127]
    s_waitcnt lgkmcnt(1)
    v_mfma_f32_32x32x16_bf16 v[96:111], a[120:123], v[56:59], v[96:111]
    v_mfma_f32_32x32x16_bf16 v[112:127], v[56:59], a[248:251], v[112:127]
    s_waitcnt lgkmcnt(0)
    v_mfma_f32_32x32x16_bf16 v[96:111], a[124:127], v[60:63], v[96:111]
    v_mfma_f32_32x32x16_bf16 v[112:127], v[60:63], a[252:255], v[112:127]
    s_lshl_b32 s68, s66, 5
    s_add_u32 s68, s68, s53
    s_lshl_b32 s68, s68, 13
    s_lshl_b32 s3, s52, 11
    s_add_u32 s68, s68, s3
    s_add_u32 s72, s68, 16777216
    s_add_u32 s73, s68, 33554432
    s_add_u32 s64, s64, 1
    s_add_u32 s66, s66, 4
    s_add_u32 s67, s67, 32768
    s_and_b32 s67, s67, 0x1ffff
    s_cmp_ge_u32 s64, s65
    s_cbranch_scc1 L_KV_DONE
    s_waitcnt vmcnt(8)
    s_barrier
    s_sub_u32 s61, s64, 1
    s_cmp_lg_u32 s52, 0
    s_cbranch_scc1 L_KV_NF_10
    v_mov_b32 v5, s61
    s_mov_b64 exec, 1
    buffer_store_dword v5, v7, s[48:51], s69 offen sc1
    s_mov_b64 exec, -1
L_KV_NF_10:
    v_add_u32 v24, s67, v16
    v_add_u32 v25, s67, v17
    v_add_u32 v26, s67, v18
    v_add_u32 v27, s67, v19
    v_add_u32 v28, s67, v20
    v_add_u32 v29, s67, v21
    v_add_u32 v30, s67, v22
    v_add_u32 v31, s67, v23
    ds_read_b128 v[32:35], v24 offset:0
    ds_read_b128 v[36:39], v25 offset:0
    ds_read_b128 v[40:43], v26 offset:0
    ds_read_b128 v[44:47], v27 offset:0
    ds_read_b128 v[48:51], v28 offset:0
    ds_read_b128 v[52:55], v29 offset:0
    ds_read_b128 v[56:59], v30 offset:0
    s_add_u32 s61, s66, 12
    s_lshl_b32 s70, s61, 15
    s_add_u32 s62, s67, 98304
    s_and_b32 s62, s62, 0x1ffff
    s_lshl_b32 s71, s52, 13
    s_add_u32 s71, s71, s62
    s_waitcnt lgkmcnt(6)
    v_mfma_f32_32x32x16_bf16 v[64:79], a[0:3], v[32:35], 0
    ds_read_b128 v[60:63], v31 offset:0
    v_cvt_pk_bf16_f32 v128, v96, v97
    v_cvt_pk_bf16_f32 v129, v98, v99
    v_mfma_f32_32x32x16_bf16 v[80:95], v[32:35], a[128:131], 0
    s_waitcnt lgkmcnt(6)
    v_mfma_f32_32x32x16_bf16 v[64:79], a[4:7], v[36:39], v[64:79]
    ds_read_b128 v[32:35], v24 offset:256
    v_cvt_pk_bf16_f32 v130, v100, v101
    v_cvt_pk_bf16_f32 v131, v102, v103
    v_mfma_f32_32x32x16_bf16 v[80:95], v[36:39], a[132:135], v[80:95]
    s_waitcnt lgkmcnt(6)
    v_mfma_f32_32x32x16_bf16 v[64:79], a[8:11], v[40:43], v[64:79]
    ds_read_b128 v[36:39], v25 offset:256
    v_cvt_pk_bf16_f32 v132, v104, v105
    v_cvt_pk_bf16_f32 v133, v106, v107
    v_mfma_f32_32x32x16_bf16 v[80:95], v[40:43], a[136:139], v[80:95]
    buffer_store_dwordx4 v[128:131], v6, s[48:51], s72 offen offset:0 sc1
    s_waitcnt lgkmcnt(6)
    v_mfma_f32_32x32x16_bf16 v[64:79], a[12:15], v[44:47], v[64:79]
    ds_read_b128 v[40:43], v26 offset:256
    v_cvt_pk_bf16_f32 v134, v108, v109
    v_cvt_pk_bf16_f32 v135, v110, v111
    v_mfma_f32_32x32x16_bf16 v[80:95], v[44:47], a[140:143], v[80:95]
    s_waitcnt lgkmcnt(6)
    v_mfma_f32_32x32x16_bf16 v[64:79], a[16:19], v[48:51], v[64:79]
    ds_read_b128 v[44:47], v27 offset:256
    v_cvt_pk_bf16_f32 v136, v112, v113
    v_cvt_pk_bf16_f32 v137, v114, v115
    v_mfma_f32_32x32x16_bf16 v[80:95], v[48:51], a[144:147], v[80:95]
    buffer_store_dwordx4 v[132:135], v6, s[48:51], s72 offen offset:1024 sc1
    s_waitcnt lgkmcnt(6)
    v_mfma_f32_32x32x16_bf16 v[64:79], a[20:23], v[52:55], v[64:79]
    ds_read_b128 v[48:51], v28 offset:256
    v_cvt_pk_bf16_f32 v138, v116, v117
    v_cvt_pk_bf16_f32 v139, v118, v119
    v_mfma_f32_32x32x16_bf16 v[80:95], v[52:55], a[148:151], v[80:95]
    s_waitcnt lgkmcnt(6)
    v_mfma_f32_32x32x16_bf16 v[64:79], a[24:27], v[56:59], v[64:79]
    ds_read_b128 v[52:55], v29 offset:256
    v_cvt_pk_bf16_f32 v140, v120, v121
    v_cvt_pk_bf16_f32 v141, v122, v123
    v_mfma_f32_32x32x16_bf16 v[80:95], v[56:59], a[152:155], v[80:95]
    buffer_store_dwordx4 v[136:139], v4, s[48:51], s73 offen offset:0 sc1
    s_waitcnt lgkmcnt(6)
    v_mfma_f32_32x32x16_bf16 v[64:79], a[28:31], v[60:63], v[64:79]
    ds_read_b128 v[56:59], v30 offset:256
    v_cvt_pk_bf16_f32 v142, v124, v125
    v_cvt_pk_bf16_f32 v143, v126, v127
    v_mfma_f32_32x32x16_bf16 v[80:95], v[60:63], a[156:159], v[80:95]
    s_waitcnt lgkmcnt(6)
    v_mfma_f32_32x32x16_bf16 v[64:79], a[32:35], v[32:35], v[64:79]
    ds_read_b128 v[60:63], v31 offset:256
    v_mfma_f32_32x32x16_bf16 v[80:95], v[32:35], a[160:163], v[80:95]
    buffer_store_dwordx4 v[140:143], v4, s[48:51], s73 offen offset:1024 sc1
    s_waitcnt lgkmcnt(6)
    v_mfma_f32_32x32x16_bf16 v[64:79], a[36:39], v[36:39], v[64:79]
    ds_read_b128 v[32:35], v24 offset:512
    v_mfma_f32_32x32x16_bf16 v[80:95], v[36:39], a[164:167], v[80:95]
    s_waitcnt lgkmcnt(6)
    v_mfma_f32_32x32x16_bf16 v[64:79], a[40:43], v[40:43], v[64:79]
    ds_read_b128 v[36:39], v25 offset:512
    v_mfma_f32_32x32x16_bf16 v[80:95], v[40:43], a[168:171], v[80:95]
    s_cmp_lt_u32 s64, 8
    s_cbranch_scc1 L_KV_RI_11
    buffer_store_dwordx4 v[148:151], v4, s[48:51], s74 offen offset:0 sc1
    buffer_store_dwordx4 v[148:151], v4, s[48:51], s74 offen offset:1024 sc1
    buffer_store_dwordx4 v[148:151], v4, s[48:51], s74 offen offset:2048 sc1
    buffer_store_dwordx4 v[148:151], v4, s[48:51], s74 offen offset:3072 sc1
    s_add_u32 s74, s74, 4096
L_KV_RI_11:
    s_waitcnt lgkmcnt(6)
    v_mfma_f32_32x32x16_bf16 v[64:79], a[44:47], v[44:47], v[64:79]
    ds_read_b128 v[40:43], v26 offset:512
    v_mfma_f32_32x32x16_bf16 v[80:95], v[44:47], a[172:175], v[80:95]
    s_waitcnt lgkmcnt(6)
    v_mfma_f32_32x32x16_bf16 v[64:79], a[48:51], v[48:51], v[64:79]
    ds_read_b128 v[44:47], v27 offset:512
    v_mfma_f32_32x32x16_bf16 v[80:95], v[48:51], a[176:179], v[80:95]
    s_add_u32 m0, s71, 0
    s_nop 0
    buffer_load_dwordx4 v8, s[4:7], s70 offen lds
    s_waitcnt lgkmcnt(6)
    v_mfma_f32_32x32x16_bf16 v[64:79], a[52:55], v[52:55], v[64:79]
    ds_read_b128 v[48:51], v28 offset:512
    v_mfma_f32_32x32x16_bf16 v[80:95], v[52:55], a[180:183], v[80:95]
    s_waitcnt lgkmcnt(6)
    v_mfma_f32_32x32x16_bf16 v[64:79], a[56:59], v[56:59], v[64:79]
    ds_read_b128 v[52:55], v29 offset:512
    v_mfma_f32_32x32x16_bf16 v[80:95], v[56:59], a[184:187], v[80:95]
    s_add_u32 m0, s71, 1024
    s_nop 0
    buffer_load_dwordx4 v9, s[4:7], s70 offen lds
    s_waitcnt lgkmcnt(6)
    v_mfma_f32_32x32x16_bf16 v[64:79], a[60:63], v[60:63], v[64:79]
    ds_read_b128 v[56:59], v30 offset:512
    v_mfma_f32_32x32x16_bf16 v[80:95], v[60:63], a[188:191], v[80:95]
    s_waitcnt lgkmcnt(6)
    v_mfma_f32_32x32x16_bf16 v[64:79], a[64:67], v[32:35], v[64:79]
    ds_read_b128 v[60:63], v31 offset:512
    v_mfma_f32_32x32x16_bf16 v[80:95], v[32:35], a[192:195], v[80:95]
    s_add_u32 m0, s71, 2048
    s_nop 0
    buffer_load_dwordx4 v10, s[4:7], s70 offen lds
    s_waitcnt lgkmcnt(6)
    v_mfma_f32_32x32x16_bf16 v[64:79], a[68:71], v[36:39], v[64:79]
    ds_read_b128 v[32:35], v24 offset:768
    v_mfma_f32_32x32x16_bf16 v[80:95], v[36:39], a[196:199], v[80:95]
    s_waitcnt lgkmcnt(6)
    v_mfma_f32_32x32x16_bf16 v[64:79], a[72:75], v[40:43], v[64:79]
    ds_read_b128 v[36:39], v25 offset:768
    v_mfma_f32_32x32x16_bf16 v[80:95], v[40:43], a[200:203], v[80:95]
    s_add_u32 m0, s71, 3072
    s_nop 0
    buffer_load_dwordx4 v11, s[4:7], s70 offen lds
    s_waitcnt lgkmcnt(6)
    v_mfma_f32_32x32x16_bf16 v[64:79], a[76:79], v[44:47], v[64:79]
    ds_read_b128 v[40:43], v26 offset:768
    v_mfma_f32_32x32x16_bf16 v[80:95], v[44:47], a[204:207], v[80:95]
    s_waitcnt lgkmcnt(6)
    v_mfma_f32_32x32x16_bf16 v[64:79], a[80:83], v[48:51], v[64:79]
    ds_read_b128 v[44:47], v27 offset:768
    v_mfma_f32_32x32x16_bf16 v[80:95], v[48:51], a[208:211], v[80:95]
    s_add_u32 m0, s71, 4096
    s_nop 0
    buffer_load_dwordx4 v12, s[4:7], s70 offen lds
    s_waitcnt lgkmcnt(6)
    v_mfma_f32_32x32x16_bf16 v[64:79], a[84:87], v[52:55], v[64:79]
    ds_read_b128 v[48:51], v28 offset:768
    v_mfma_f32_32x32x16_bf16 v[80:95], v[52:55], a[212:215], v[80:95]
    s_waitcnt lgkmcnt(6)
    v_mfma_f32_32x32x16_bf16 v[64:79], a[88:91], v[56:59], v[64:79]
    ds_read_b128 v[52:55], v29 offset:768
    v_mfma_f32_32x32x16_bf16 v[80:95], v[56:59], a[216:219], v[80:95]
    s_add_u32 m0, s71, 5120
    s_nop 0
    buffer_load_dwordx4 v13, s[4:7], s70 offen lds
    s_waitcnt lgkmcnt(6)
    v_mfma_f32_32x32x16_bf16 v[64:79], a[92:95], v[60:63], v[64:79]
    ds_read_b128 v[56:59], v30 offset:768
    v_mfma_f32_32x32x16_bf16 v[80:95], v[60:63], a[220:223], v[80:95]
    s_waitcnt lgkmcnt(6)
    v_mfma_f32_32x32x16_bf16 v[64:79], a[96:99], v[32:35], v[64:79]
    ds_read_b128 v[60:63], v31 offset:768
    v_mfma_f32_32x32x16_bf16 v[80:95], v[32:35], a[224:227], v[80:95]
    s_add_u32 m0, s71, 6144
    s_nop 0
    buffer_load_dwordx4 v14, s[4:7], s70 offen lds
    s_waitcnt lgkmcnt(6)
    v_mfma_f32_32x32x16_bf16 v[64:79], a[100:103], v[36:39], v[64:79]
    v_mfma_f32_32x32x16_bf16 v[80:95], v[36:39], a[228:231], v[80:95]
    s_waitcnt lgkmcnt(5)
    v_mfma_f32_32x32x16_bf16 v[64:79], a[104:107], v[40:43], v[64:79]
    v_mfma_f32_32x32x16_bf16 v[80:95], v[40:43], a[232:235], v[80:95]
    s_add_u32 m0, s71, 7168
    s_nop 0
    buffer_load_dwordx4 v15, s[4:7], s70 offen lds
    s_waitcnt lgkmcnt(4)
    v_mfma_f32_32x32x16_bf16 v[64:79], a[108:111], v[44:47], v[64:79]
    v_mfma_f32_32x32x16_bf16 v[80:95], v[44:47], a[236:239], v[80:95]
    s_waitcnt lgkmcnt(3)
    v_mfma_f32_32x32x16_bf16 v[64:79], a[112:115], v[48:51], v[64:79]
    v_mfma_f32_32x32x16_bf16 v[80:95], v[48:51], a[240:243], v[80:95]
    s_waitcnt lgkmcnt(2)
    v_mfma_f32_32x32x16_bf16 v[64:79], a[116:119], v[52:55], v[64:79]
    v_mfma_f32_32x32x16_bf16 v[80:95], v[52:55], a[244:247], v[80:95]
    s_waitcnt lgkmcnt(1)
    v_mfma_f32_32x32x16_bf16 v[64:79], a[120:123], v[56:59], v[64:79]
    v_mfma_f32_32x32x16_bf16 v[80:95], v[56:59], a[248:251], v[80:95]
    s_waitcnt lgkmcnt(0)
    v_mfma_f32_32x32x16_bf16 v[64:79], a[124:127], v[60:63], v[64:79]
    v_mfma_f32_32x32x16_bf16 v[80:95], v[60:63], a[252:255], v[80:95]
    s_lshl_b32 s68, s66, 5
    s_add_u32 s68, s68, s53
    s_lshl_b32 s68, s68, 13
    s_lshl_b32 s3, s52, 11
    s_add_u32 s68, s68, s3
    s_add_u32 s72, s68, 16777216
    s_add_u32 s73, s68, 33554432
    s_add_u32 s64, s64, 1
    s_add_u32 s66, s66, 4
    s_add_u32 s67, s67, 32768
    s_and_b32 s67, s67, 0x1ffff
    s_branch L_KV_LOOP
.p2align 5
L_KV_DONE:
    v_cvt_pk_bf16_f32 v128, v96, v97
    v_cvt_pk_bf16_f32 v129, v98, v99
    v_cvt_pk_bf16_f32 v130, v100, v101
    v_cvt_pk_bf16_f32 v131, v102, v103
    v_cvt_pk_bf16_f32 v132, v104, v105
    v_cvt_pk_bf16_f32 v133, v106, v107
    v_cvt_pk_bf16_f32 v134, v108, v109
    v_cvt_pk_bf16_f32 v135, v110, v111
    v_cvt_pk_bf16_f32 v136, v112, v113
    v_cvt_pk_bf16_f32 v137, v114, v115
    v_cvt_pk_bf16_f32 v138, v116, v117
    v_cvt_pk_bf16_f32 v139, v118, v119
    v_cvt_pk_bf16_f32 v140, v120, v121
    v_cvt_pk_bf16_f32 v141, v122, v123
    v_cvt_pk_bf16_f32 v142, v124, v125
    v_cvt_pk_bf16_f32 v143, v126, v127
    buffer_store_dwordx4 v[128:131], v6, s[48:51], s72 offen offset:0 sc1
    buffer_store_dwordx4 v[132:135], v6, s[48:51], s72 offen offset:1024 sc1
    buffer_store_dwordx4 v[136:139], v4, s[48:51], s73 offen offset:0 sc1
    buffer_store_dwordx4 v[140:143], v4, s[48:51], s73 offen offset:1024 sc1
    s_waitcnt vmcnt(0)
    s_barrier
    v_mov_b32 v5, s65
    s_mov_b64 exec, 1
    buffer_store_dword v5, v7, s[48:51], s69 offen sc1
    s_mov_b64 exec, -1
    s_cmp_lg_u32 s52, 1
    s_cbranch_scc1 L_KV_NOQI
    s_lshl_b32 s3, s54, 2
    s_add_u32 s3, s3, 168
    v_mov_b32 v5, s3
    v_mov_b32 v3, 1
    s_mov_b64 exec, 1
    buffer_atomic_add v3, v5, s[44:47], 0 offen
    s_mov_b64 exec, -1
L_KV_NOQI:
    s_branch L_ROLE_QA
.p2align 5
L_ROLE_B:
    v_lshlrev_b32 v1, 4, v0
    s_mul_i32 s65, s54, 16
    s_lshl_b32 s75, s54, 1
    s_mul_i32 s64, s54, 6
    s_add_u32 s64, s64, 6
    v_lshlrev_b32 v14, 7, v0
    s_lshl_b32 s60, s65, 15
    s_mul_i32 s61, s53, 40960
    s_add_u32 s60, s60, s61
    s_mul_i32 s61, s52, 10240
    s_add_u32 s60, s60, s61
    buffer_load_dword v30, v14, s[4:7], s60 offen
    s_add_u32 s60, s60, 2048
    buffer_load_dword v31, v14, s[4:7], s60 offen
    s_add_u32 s65, s65, s52
    v_bfe_u32 v15, v0, 0, 1
    v_mul_u32_u24 v15, 16, v15
    v_bfe_u32 v14, v0, 1, 2
    v_mul_u32_u24 v14, 1024, v14
    v_add_u32 v15, v15, v14
    v_bfe_u32 v14, v0, 3, 3
    v_mul_u32_u24 v14, 3072, v14
    v_add_u32 v15, v15, v14
    s_mul_i32 s60, s52, 393216
    s_lshl_b32 s3, s53, 5
    s_add_u32 s60, s60, s3
    s_lshl_b32 s61, s52, 14
    s_add_u32 s61, s61, 98304
    s_add_u32 m0, s61, 0
    s_add_u32 s62, s60, 0
    buffer_load_dwordx4 v15, s[28:31], s62 offen lds
    s_add_u32 m0, s61, 1024
    s_add_u32 s62, s60, 24576
    buffer_load_dwordx4 v15, s[28:31], s62 offen lds
    s_add_u32 m0, s61, 2048
    s_add_u32 s62, s60, 49152
    buffer_load_dwordx4 v15, s[28:31], s62 offen lds
    s_add_u32 m0, s61, 3072
    s_add_u32 s62, s60, 73728
    buffer_load_dwordx4 v15, s[28:31], s62 offen lds
    s_add_u32 m0, s61, 4096
    s_add_u32 s62, s60, 98304
    buffer_load_dwordx4 v15, s[28:31], s62 offen lds
    s_add_u32 m0, s61, 5120
    s_add_u32 s62, s60, 122880
    buffer_load_dwordx4 v15, s[28:31], s62 offen lds
    s_add_u32 m0, s61, 6144
    s_add_u32 s62, s60, 147456
    buffer_load_dwordx4 v15, s[28:31], s62 offen lds
    s_add_u32 m0, s61, 7168
    s_add_u32 s62, s60, 172032
    buffer_load_dwordx4 v15, s[28:31], s62 offen lds
    s_add_u32 m0, s61, 8192
    s_add_u32 s62, s60, 196608
    buffer_load_dwordx4 v15, s[28:31], s62 offen lds
    s_add_u32 m0, s61, 9216
    s_add_u32 s62, s60, 221184
    buffer_load_dwordx4 v15, s[28:31], s62 offen lds
    s_add_u32 m0, s61, 10240
    s_add_u32 s62, s60, 245760
    buffer_load_dwordx4 v15, s[28:31], s62 offen lds
    s_add_u32 m0, s61, 11264
    s_add_u32 s62, s60, 270336
    buffer_load_dwordx4 v15, s[28:31], s62 offen lds
    s_add_u32 m0, s61, 12288
    s_add_u32 s62, s60, 294912
    buffer_load_dwordx4 v15, s[28:31], s62 offen lds
    s_add_u32 m0, s61, 13312
    s_add_u32 s62, s60, 319488
    buffer_load_dwordx4 v15, s[28:31], s62 offen lds
    s_add_u32 m0, s61, 14336
    s_add_u32 s62, s60, 344064
    buffer_load_dwordx4 v15, s[28:31], s62 offen lds
    s_add_u32 m0, s61, 15360
    s_add_u32 s62, s60, 368640
    buffer_load_dwordx4 v15, s[28:31], s62 offen lds
    s_lshl_b32 s3, s52, 7
    v_lshlrev_b32 v14, 1, v0
    buffer_load_ushort v28, v14, s[36:39], s3 offen
    buffer_load_ushort v29, v14, s[36:39], s3 offen offset:512
    v_bfe_u32 v14, v0, 0, 4
    v_mul_u32_u24 v14, 16, v14
    v_bfe_u32 v15, v0, 4, 2
    v_mul_u32_u24 v15, 16, v15
    v_bfe_u32 v20, v0, 4, 2
    v_mul_u32_u24 v20, 1024, v20
    v_add_u32 v21, 0, v15
    v_xor_b32 v21, v21, v14
    v_add_u32 v2, v20, v21
    v_add_u32 v21, 64, v15
    v_xor_b32 v21, v21, v14
    v_add_u32 v3, v20, v21
    v_add_u32 v3, 4096, v3
    v_add_u32 v21, 128, v15
    v_xor_b32 v21, v21, v14
    v_add_u32 v4, v20, v21
    v_add_u32 v4, 8192, v4
    v_add_u32 v21, 192, v15
    v_xor_b32 v21, v21, v14
    v_add_u32 v5, v20, v21
    v_add_u32 v5, 12288, v5
    s_mul_i32 s69, s52, 24576
    s_add_u32 s3, s52, 0
    s_and_b32 s3, s3, 3
    s_lshl_b32 s94, s3, 8
    s_add_u32 s3, s52, 1
    s_and_b32 s3, s3, 3
    s_lshl_b32 s95, s3, 8
    s_add_u32 s3, s52, 2
    s_and_b32 s3, s3, 3
    s_lshl_b32 s96, s3, 8
    s_add_u32 s3, s52, 3
    s_and_b32 s3, s3, 3
    s_lshl_b32 s97, s3, 8
    s_lshl_b32 s68, s65, 15
    s_add_u32 s61, s68, s94
    s_add_u32 m0, s69, 0
    s_nop 0
    buffer_load_dwordx4 v2, s[4:7], s61 offen lds
    s_add_u32 m0, s69, 1024
    s_nop 0
    buffer_load_dwordx4 v3, s[4:7], s61 offen lds
    s_add_u32 m0, s69, 2048
    s_nop 0
    buffer_load_dwordx4 v4, s[4:7], s61 offen lds
    s_add_u32 m0, s69, 3072
    s_nop 0
    buffer_load_dwordx4 v5, s[4:7], s61 offen lds
    s_add_u32 m0, s69, 4096
    s_add_u32 s3, s61, 16384
    buffer_load_dwordx4 v2, s[4:7], s3 offen lds
    s_add_u32 m0, s69, 5120
    s_add_u32 s3, s61, 16384
    buffer_load_dwordx4 v3, s[4:7], s3 offen lds
    s_add_u32 m0, s69, 6144
    s_add_u32 s3, s61, 16384
    buffer_load_dwordx4 v4, s[4:7], s3 offen lds
    s_add_u32 m0, s69, 7168
    s_add_u32 s3, s61, 16384
    buffer_load_dwordx4 v5, s[4:7], s3 offen lds
    s_add_u32 s60, s69, 8192
    s_add_u32 s61, s68, s95
    s_add_u32 m0, s60, 0
    s_nop 0
    buffer_load_dwordx4 v2, s[4:7], s61 offen lds
    s_add_u32 m0, s60, 1024
    s_nop 0
    buffer_load_dwordx4 v3, s[4:7], s61 offen lds
    s_add_u32 m0, s60, 2048
    s_nop 0
    buffer_load_dwordx4 v4, s[4:7], s61 offen lds
    s_add_u32 m0, s60, 3072
    s_nop 0
    buffer_load_dwordx4 v5, s[4:7], s61 offen lds
    s_add_u32 m0, s60, 4096
    s_add_u32 s3, s61, 16384
    buffer_load_dwordx4 v2, s[4:7], s3 offen lds
    s_add_u32 m0, s60, 5120
    s_add_u32 s3, s61, 16384
    buffer_load_dwordx4 v3, s[4:7], s3 offen lds
    s_add_u32 m0, s60, 6144
    s_add_u32 s3, s61, 16384
    buffer_load_dwordx4 v4, s[4:7], s3 offen lds
    s_add_u32 m0, s60, 7168
    s_add_u32 s3, s61, 16384
    buffer_load_dwordx4 v5, s[4:7], s3 offen lds
    v_bfe_u32 v14, v0, 5, 1
    v_mul_u32_u24 v14, 16, v14
    v_bfe_u32 v15, v0, 0, 4
    v_mul_u32_u24 v15, 16, v15
    v_bfe_u32 v20, v0, 0, 5
    v_mul_u32_u24 v20, 256, v20
    v_add_u32 v21, 0, v14
    v_xor_b32 v21, v21, v15
    v_add_u32 v6, v21, v20
    v_add_u32 v21, 32, v14
    v_xor_b32 v21, v21, v15
    v_add_u32 v7, v21, v20
    v_add_u32 v21, 64, v14
    v_xor_b32 v21, v21, v15
    v_add_u32 v8, v21, v20
    v_add_u32 v21, 96, v14
    v_xor_b32 v21, v21, v15
    v_add_u32 v9, v21, v20
    v_add_u32 v21, 128, v14
    v_xor_b32 v21, v21, v15
    v_add_u32 v10, v21, v20
    v_add_u32 v21, 160, v14
    v_xor_b32 v21, v21, v15
    v_add_u32 v11, v21, v20
    v_add_u32 v21, 192, v14
    v_xor_b32 v21, v21, v15
    v_add_u32 v12, v21, v20
    v_add_u32 v21, 224, v14
    v_xor_b32 v21, v21, v15
    v_add_u32 v13, v21, v20
    s_waitcnt vmcnt(16)
    s_barrier
    s_lshl_b32 s3, s52, 13
    v_lshlrev_b32 v14, 7, v0
    v_add_u32 v14, s3, v14
    v_add_u32 v14, 98400, v14
    ds_write_b16 v14, v28
    ds_write_b16 v14, v29 offset:32768
    s_waitcnt lgkmcnt(0)
    s_barrier
    v_bfe_u32 v14, v0, 0, 2
    v_mul_u32_u24 v14, 8, v14
    v_bfe_u32 v21, v0, 2, 2
    v_mul_u32_u24 v21, 128, v21
    v_add_u32 v14, v14, v21
    v_bfe_u32 v21, v0, 4, 1
    v_mul_u32_u24 v21, 32, v21
    v_add_u32 v14, v14, v21
    v_bfe_u32 v21, v0, 5, 1
    v_mul_u32_u24 v21, 1024, v21
    v_add_u32 v14, v14, v21
    v_add_u32 v14, 98304, v14
    s_lshl_b32 s3, s94, 6
    v_add_u32 v56, s3, v14
    s_lshl_b32 s3, s95, 6
    v_add_u32 v57, s3, v14
    s_lshl_b32 s3, s96, 6
    v_add_u32 v58, s3, v14
    s_lshl_b32 s3, s97, 6
    v_add_u32 v59, s3, v14
    ds_read_b64_tr_b16 a[0:1], v56 offset:0
    ds_read_b64_tr_b16 a[2:3], v56 offset:512
    ds_read_b64_tr_b16 a[4:5], v56 offset:2048
    ds_read_b64_tr_b16 a[6:7], v56 offset:2560
    ds_read_b64_tr_b16 a[8:9], v56 offset:4096
    ds_read_b64_tr_b16 a[10:11], v56 offset:4608
    ds_read_b64_tr_b16 a[12:13], v56 offset:6144
    ds_read_b64_tr_b16 a[14:15], v56 offset:6656
    ds_read_b64_tr_b16 a[16:17], v56 offset:8192
    ds_read_b64_tr_b16 a[18:19], v56 offset:8704
    ds_read_b64_tr_b16 a[20:21], v56 offset:10240
    ds_read_b64_tr_b16 a[22:23], v56 offset:10752
    ds_read_b64_tr_b16 a[24:25], v56 offset:12288
    ds_read_b64_tr_b16 a[26:27], v56 offset:12800
    ds_read_b64_tr_b16 a[28:29], v56 offset:14336
    ds_read_b64_tr_b16 a[30:31], v56 offset:14848
    ds_read_b64_tr_b16 a[32:33], v57 offset:0
    ds_read_b64_tr_b16 a[34:35], v57 offset:512
    ds_read_b64_tr_b16 a[36:37], v57 offset:2048
    ds_read_b64_tr_b16 a[38:39], v57 offset:2560
    ds_read_b64_tr_b16 a[40:41], v57 offset:4096
    ds_read_b64_tr_b16 a[42:43], v57 offset:4608
    ds_read_b64_tr_b16 a[44:45], v57 offset:6144
    ds_read_b64_tr_b16 a[46:47], v57 offset:6656
    ds_read_b64_tr_b16 a[48:49], v57 offset:8192
    ds_read_b64_tr_b16 a[50:51], v57 offset:8704
    ds_read_b64_tr_b16 a[52:53], v57 offset:10240
    ds_read_b64_tr_b16 a[54:55], v57 offset:10752
    ds_read_b64_tr_b16 a[56:57], v57 offset:12288
    ds_read_b64_tr_b16 a[58:59], v57 offset:12800
    ds_read_b64_tr_b16 a[60:61], v57 offset:14336
    ds_read_b64_tr_b16 a[62:63], v57 offset:14848
    ds_read_b64_tr_b16 a[64:65], v58 offset:0
    ds_read_b64_tr_b16 a[66:67], v58 offset:512
    ds_read_b64_tr_b16 a[68:69], v58 offset:2048
    ds_read_b64_tr_b16 a[70:71], v58 offset:2560
    ds_read_b64_tr_b16 a[72:73], v58 offset:4096
    ds_read_b64_tr_b16 a[74:75], v58 offset:4608
    ds_read_b64_tr_b16 a[76:77], v58 offset:6144
    ds_read_b64_tr_b16 a[78:79], v58 offset:6656
    ds_read_b64_tr_b16 a[80:81], v58 offset:8192
    ds_read_b64_tr_b16 a[82:83], v58 offset:8704
    ds_read_b64_tr_b16 a[84:85], v58 offset:10240
    ds_read_b64_tr_b16 a[86:87], v58 offset:10752
    ds_read_b64_tr_b16 a[88:89], v58 offset:12288
    ds_read_b64_tr_b16 a[90:91], v58 offset:12800
    ds_read_b64_tr_b16 a[92:93], v58 offset:14336
    ds_read_b64_tr_b16 a[94:95], v58 offset:14848
    ds_read_b64_tr_b16 a[96:97], v59 offset:0
    ds_read_b64_tr_b16 a[98:99], v59 offset:512
    ds_read_b64_tr_b16 a[100:101], v59 offset:2048
    ds_read_b64_tr_b16 a[102:103], v59 offset:2560
    ds_read_b64_tr_b16 a[104:105], v59 offset:4096
    ds_read_b64_tr_b16 a[106:107], v59 offset:4608
    ds_read_b64_tr_b16 a[108:109], v59 offset:6144
    ds_read_b64_tr_b16 a[110:111], v59 offset:6656
    ds_read_b64_tr_b16 a[112:113], v59 offset:8192
    ds_read_b64_tr_b16 a[114:115], v59 offset:8704
    ds_read_b64_tr_b16 a[116:117], v59 offset:10240
    ds_read_b64_tr_b16 a[118:119], v59 offset:10752
    ds_read_b64_tr_b16 a[120:121], v59 offset:12288
    ds_read_b64_tr_b16 a[122:123], v59 offset:12800
    ds_read_b64_tr_b16 a[124:125], v59 offset:14336
    ds_read_b64_tr_b16 a[126:127], v59 offset:14848
    ds_read_b64_tr_b16 a[128:129], v56 offset:64
    ds_read_b64_tr_b16 a[130:131], v56 offset:576
    ds_read_b64_tr_b16 a[132:133], v56 offset:2112
    ds_read_b64_tr_b16 a[134:135], v56 offset:2624
    ds_read_b64_tr_b16 a[136:137], v56 offset:4160
    ds_read_b64_tr_b16 a[138:139], v56 offset:4672
    ds_read_b64_tr_b16 a[140:141], v56 offset:6208
    ds_read_b64_tr_b16 a[142:143], v56 offset:6720
    ds_read_b64_tr_b16 a[144:145], v56 offset:8256
    ds_read_b64_tr_b16 a[146:147], v56 offset:8768
    ds_read_b64_tr_b16 a[148:149], v56 offset:10304
    ds_read_b64_tr_b16 a[150:151], v56 offset:10816
    ds_read_b64_tr_b16 a[152:153], v56 offset:12352
    ds_read_b64_tr_b16 a[154:155], v56 offset:12864
    ds_read_b64_tr_b16 a[156:157], v56 offset:14400
    ds_read_b64_tr_b16 a[158:159], v56 offset:14912
    ds_read_b64_tr_b16 a[160:161], v57 offset:64
    ds_read_b64_tr_b16 a[162:163], v57 offset:576
    ds_read_b64_tr_b16 a[164:165], v57 offset:2112
    ds_read_b64_tr_b16 a[166:167], v57 offset:2624
    ds_read_b64_tr_b16 a[168:169], v57 offset:4160
    ds_read_b64_tr_b16 a[170:171], v57 offset:4672
    ds_read_b64_tr_b16 a[172:173], v57 offset:6208
    ds_read_b64_tr_b16 a[174:175], v57 offset:6720
    ds_read_b64_tr_b16 a[176:177], v57 offset:8256
    ds_read_b64_tr_b16 a[178:179], v57 offset:8768
    ds_read_b64_tr_b16 a[180:181], v57 offset:10304
    ds_read_b64_tr_b16 a[182:183], v57 offset:10816
    ds_read_b64_tr_b16 a[184:185], v57 offset:12352
    ds_read_b64_tr_b16 a[186:187], v57 offset:12864
    ds_read_b64_tr_b16 a[188:189], v57 offset:14400
    ds_read_b64_tr_b16 a[190:191], v57 offset:14912
    ds_read_b64_tr_b16 a[192:193], v58 offset:64
    ds_read_b64_tr_b16 a[194:195], v58 offset:576
    ds_read_b64_tr_b16 a[196:197], v58 offset:2112
    ds_read_b64_tr_b16 a[198:199], v58 offset:2624
    ds_read_b64_tr_b16 a[200:201], v58 offset:4160
    ds_read_b64_tr_b16 a[202:203], v58 offset:4672
    ds_read_b64_tr_b16 a[204:205], v58 offset:6208
    ds_read_b64_tr_b16 a[206:207], v58 offset:6720
    ds_read_b64_tr_b16 a[208:209], v58 offset:8256
    ds_read_b64_tr_b16 a[210:211], v58 offset:8768
    ds_read_b64_tr_b16 a[212:213], v58 offset:10304
    ds_read_b64_tr_b16 a[214:215], v58 offset:10816
    ds_read_b64_tr_b16 a[216:217], v58 offset:12352
    ds_read_b64_tr_b16 a[218:219], v58 offset:12864
    ds_read_b64_tr_b16 a[220:221], v58 offset:14400
    ds_read_b64_tr_b16 a[222:223], v58 offset:14912
    ds_read_b64_tr_b16 a[224:225], v59 offset:64
    ds_read_b64_tr_b16 a[226:227], v59 offset:576
    ds_read_b64_tr_b16 a[228:229], v59 offset:2112
    ds_read_b64_tr_b16 a[230:231], v59 offset:2624
    ds_read_b64_tr_b16 a[232:233], v59 offset:4160
    ds_read_b64_tr_b16 a[234:235], v59 offset:4672
    ds_read_b64_tr_b16 a[236:237], v59 offset:6208
    ds_read_b64_tr_b16 a[238:239], v59 offset:6720
    ds_read_b64_tr_b16 a[240:241], v59 offset:8256
    ds_read_b64_tr_b16 a[242:243], v59 offset:8768
    ds_read_b64_tr_b16 a[244:245], v59 offset:10304
    ds_read_b64_tr_b16 a[246:247], v59 offset:10816
    ds_read_b64_tr_b16 a[248:249], v59 offset:12352
    ds_read_b64_tr_b16 a[250:251], v59 offset:12864
    ds_read_b64_tr_b16 a[252:253], v59 offset:14400
    ds_read_b64_tr_b16 a[254:255], v59 offset:14912
    v_and_b32 v15, 31, v0
    v_lshrrev_b32 v21, 5, v0
    v_lshlrev_b32 v21, 2, v21
    v_sub_u32 v15, v15, v21
    v_mov_b32 v20, 0xf149f2ca
    v_cmp_le_i32 vcc, 0, v15
    s_nop 1
    v_cndmask_b32 v24, v20, 0, vcc
    v_cmp_le_i32 vcc, 1, v15
    s_nop 1
    v_cndmask_b32 v25, v20, 0, vcc
    v_cmp_le_i32 vcc, 2, v15
    s_nop 1
    v_cndmask_b32 v26, v20, 0, vcc
    v_cmp_le_i32 vcc, 3, v15
    s_nop 1
    v_cndmask_b32 v27, v20, 0, vcc
    v_cmp_le_i32 vcc, 8, v15
    s_nop 1
    v_cndmask_b32 v28, v20, 0, vcc
    v_cmp_le_i32 vcc, 9, v15
    s_nop 1
    v_cndmask_b32 v29, v20, 0, vcc
    v_cmp_le_i32 vcc, 10, v15
    s_nop 1
    v_cndmask_b32 v30, v20, 0, vcc
    v_cmp_le_i32 vcc, 11, v15
    s_nop 1
    v_cndmask_b32 v31, v20, 0, vcc
    v_cmp_le_i32 vcc, 16, v15
    s_nop 1
    v_cndmask_b32 v32, v20, 0, vcc
    v_cmp_le_i32 vcc, 17, v15
    s_nop 1
    v_cndmask_b32 v33, v20, 0, vcc
    v_cmp_le_i32 vcc, 18, v15
    s_nop 1
    v_cndmask_b32 v34, v20, 0, vcc
    v_cmp_le_i32 vcc, 19, v15
    s_nop 1
    v_cndmask_b32 v35, v20, 0, vcc
    v_cmp_le_i32 vcc, 24, v15
    s_nop 1
    v_cndmask_b32 v36, v20, 0, vcc
    v_cmp_le_i32 vcc, 25, v15
    s_nop 1
    v_cndmask_b32 v37, v20, 0, vcc
    v_cmp_le_i32 vcc, 26, v15
    s_nop 1
    v_cndmask_b32 v38, v20, 0, vcc
    v_cmp_le_i32 vcc, 27, v15
    s_nop 1
    v_cndmask_b32 v39, v20, 0, vcc
    v_and_b32 v15, 31, v0
    v_lshrrev_b32 v21, 5, v0
    v_lshlrev_b32 v21, 2, v21
    v_sub_u32 v15, v15, v21
    v_mov_b32 v20, 0xf149f2ca
    v_cmp_le_i32 vcc, 0, v15
    s_nop 1
    v_cndmask_b32 v40, 0, v20, vcc
    v_cmp_le_i32 vcc, 1, v15
    s_nop 1
    v_cndmask_b32 v41, 0, v20, vcc
    v_cmp_le_i32 vcc, 2, v15
    s_nop 1
    v_cndmask_b32 v42, 0, v20, vcc
    v_cmp_le_i32 vcc, 3, v15
    s_nop 1
    v_cndmask_b32 v43, 0, v20, vcc
    v_cmp_le_i32 vcc, 8, v15
    s_nop 1
    v_cndmask_b32 v44, 0, v20, vcc
    v_cmp_le_i32 vcc, 9, v15
    s_nop 1
    v_cndmask_b32 v45, 0, v20, vcc
    v_cmp_le_i32 vcc, 10, v15
    s_nop 1
    v_cndmask_b32 v46, 0, v20, vcc
    v_cmp_le_i32 vcc, 11, v15
    s_nop 1
    v_cndmask_b32 v47, 0, v20, vcc
    v_cmp_le_i32 vcc, 16, v15
    s_nop 1
    v_cndmask_b32 v48, 0, v20, vcc
    v_cmp_le_i32 vcc, 17, v15
    s_nop 1
    v_cndmask_b32 v49, 0, v20, vcc
    v_cmp_le_i32 vcc, 18, v15
    s_nop 1
    v_cndmask_b32 v50, 0, v20, vcc
    v_cmp_le_i32 vcc, 19, v15
    s_nop 1
    v_cndmask_b32 v51, 0, v20, vcc
    v_cmp_le_i32 vcc, 24, v15
    s_nop 1
    v_cndmask_b32 v52, 0, v20, vcc
    v_cmp_le_i32 vcc, 25, v15
    s_nop 1
    v_cndmask_b32 v53, 0, v20, vcc
    v_cmp_le_i32 vcc, 26, v15
    s_nop 1
    v_cndmask_b32 v54, 0, v20, vcc
    v_cmp_le_i32 vcc, 27, v15
    s_nop 1
    v_cndmask_b32 v55, 0, v20, vcc
    s_waitcnt lgkmcnt(0)
    s_barrier
    v_mov_b32 v200, 0
    v_mov_b32 v201, 0
    v_mov_b32 v202, 0
    v_mov_b32 v203, 0
    s_mul_i32 s3, s52, 12288
    v_add_u32 v14, s3, v1
    v_add_u32 v14, 98304, v14
    ds_write_b128 v14, v[200:203] offset:0
    ds_write_b128 v14, v[200:203] offset:1024
    ds_write_b128 v14, v[200:203] offset:2048
    ds_write_b128 v14, v[200:203] offset:3072
    ds_write_b128 v14, v[200:203] offset:4096
    ds_write_b128 v14, v[200:203] offset:5120
    ds_write_b128 v14, v[200:203] offset:6144
    ds_write_b128 v14, v[200:203] offset:7168
    ds_write_b128 v14, v[200:203] offset:8192
    ds_write_b128 v14, v[200:203] offset:9216
    ds_write_b128 v14, v[200:203] offset:10240
    ds_write_b128 v14, v[200:203] offset:11264
    s_lshl_b32 s3, s52, 7
    v_bfe_u32 v18, v0, 5, 1
    v_mul_u32_u24 v18, 16, v18
    v_add_u32 v18, 147456, v18
    v_add_u32 v18, s3, v18
    v_bfe_u32 v19, v0, 0, 5
    v_mul_u32_u24 v19, 4, v19
    v_add_u32 v19, 147456, v19
    v_add_u32 v19, s3, v19
    s_mov_b32 s78, 0x00010000
    s_mov_b32 s79, 0x00010000
    s_mov_b32 s80, 0xffff0000
    s_mov_b32 s81, 0xffff0000
    v_mov_b32 v22, 0x3f803f80
    s_mov_b32 s72, 0x3eb8aa3b
    s_mul_i32 s70, s54, 4096
    s_lshl_b32 s3, s53, 7
    s_add_u32 s70, s70, s3
    s_add_u32 s70, s70, 20480
    s_lshl_b32 s73, s53, 16
    s_add_u32 s73, s73, 2097152
    s_lshl_b32 s74, s53, 13
    s_add_u32 s74, s74, 1048576
    s_cmp_lg_u32 s52, 0
    s_cbranch_scc1 L_WD_12
    v_mov_b32 v15, 48
    s_mov_b32 s56, 0
L_poll_13:
    buffer_load_dword v14, v15, s[44:47], 0 offen sc1
    s_waitcnt vmcnt(0)
    v_readfirstlane_b32 s58, v14
    s_nop 0
    s_cmp_ge_u32 s58, 256
    s_cbranch_scc1 L_polled_14
    s_sleep 40
    s_add_u32 s56, s56, 1
    s_cmp_gt_u32 s56, 60000
    s_cbranch_scc1 L_TIMEOUT_1
    s_branch L_poll_13
.p2align 5
L_polled_14:
.p2align 5
L_WD_12:
    s_waitcnt vmcnt(0)
    s_barrier
    s_waitcnt lgkmcnt(0)
    s_barrier
    s_mov_b32 s63, 0
    s_mov_b32 s71, 0
    s_mov_b32 s66, s69
    s_add_u32 s67, s69, 16384
L_B_LOOP:
    v_add_u32 v120, s66, v6
    v_add_u32 v121, s66, v7
    v_add_u32 v122, s66, v8
    v_add_u32 v123, s66, v9
    v_add_u32 v124, s66, v10
    v_add_u32 v125, s66, v11
    v_add_u32 v126, s66, v12
    v_add_u32 v127, s66, v13
    ds_read_b128 v[56:59], v120
    ds_read_b128 v[60:63], v121
    ds_read_b128 v[64:67], v122
    ds_read_b128 v[68:71], v123
    ds_read_b128 v[72:75], v124
    ds_read_b128 v[76:79], v125
    ds_read_b128 v[80:83], v126
    ds_read_b128 v[84:87], v127
    s_add_u32 s61, s68, s96
    s_waitcnt lgkmcnt(7)
    v_mfma_f32_32x32x16_bf16 v[88:103], a[0:3], v[56:59], 0
    v_mfma_f32_32x32x16_bf16 v[104:119], v[56:59], a[128:131], 0
    s_add_u32 m0, s67, 0
    s_nop 0
    buffer_load_dwordx4 v2, s[4:7], s61 offen lds
    s_waitcnt lgkmcnt(6)
    v_mfma_f32_32x32x16_bf16 v[88:103], a[4:7], v[60:63], v[88:103]
    v_mfma_f32_32x32x16_bf16 v[104:119], v[60:63], a[132:135], v[104:119]
    s_add_u32 m0, s67, 1024
    s_nop 0
    buffer_load_dwordx4 v3, s[4:7], s61 offen lds
    s_waitcnt lgkmcnt(5)
    v_mfma_f32_32x32x16_bf16 v[88:103], a[8:11], v[64:67], v[88:103]
    v_mfma_f32_32x32x16_bf16 v[104:119], v[64:67], a[136:139], v[104:119]
    s_add_u32 m0, s67, 2048
    s_nop 0
    buffer_load_dwordx4 v4, s[4:7], s61 offen lds
    s_waitcnt lgkmcnt(4)
    v_mfma_f32_32x32x16_bf16 v[88:103], a[12:15], v[68:71], v[88:103]
    v_mfma_f32_32x32x16_bf16 v[104:119], v[68:71], a[140:143], v[104:119]
    s_add_u32 m0, s67, 3072
    s_nop 0
    buffer_load_dwordx4 v5, s[4:7], s61 offen lds
    s_waitcnt lgkmcnt(3)
    v_mfma_f32_32x32x16_bf16 v[88:103], a[16:19], v[72:75], v[88:103]
    v_mfma_f32_32x32x16_bf16 v[104:119], v[72:75], a[144:147], v[104:119]
    s_add_u32 m0, s67, 4096
    s_add_u32 s3, s61, 16384
    buffer_load_dwordx4 v2, s[4:7], s3 offen lds
    s_waitcnt lgkmcnt(2)
    v_mfma_f32_32x32x16_bf16 v[88:103], a[20:23], v[76:79], v[88:103]
    v_mfma_f32_32x32x16_bf16 v[104:119], v[76:79], a[148:151], v[104:119]
    s_add_u32 m0, s67, 5120
    s_add_u32 s3, s61, 16384
    buffer_load_dwordx4 v3, s[4:7], s3 offen lds
    s_waitcnt lgkmcnt(1)
    v_mfma_f32_32x32x16_bf16 v[88:103], a[24:27], v[80:83], v[88:103]
    v_mfma_f32_32x32x16_bf16 v[104:119], v[80:83], a[152:155], v[104:119]
    s_add_u32 m0, s67, 6144
    s_add_u32 s3, s61, 16384
    buffer_load_dwordx4 v4, s[4:7], s3 offen lds
    s_waitcnt lgkmcnt(0)
    v_mfma_f32_32x32x16_bf16 v[88:103], a[28:31], v[84:87], v[88:103]
    v_mfma_f32_32x32x16_bf16 v[104:119], v[84:87], a[156:159], v[104:119]
    s_add_u32 m0, s67, 7168
    s_add_u32 s3, s61, 16384
    buffer_load_dwordx4 v5, s[4:7], s3 offen lds
    s_add_u32 s66, s66, 8192
    s_sub_u32 s3, s66, s69
    s_cmp_eq_u32 s3, 24576
    s_cselect_b32 s66, s69, s66
    s_add_u32 s67, s67, 8192
    s_sub_u32 s3, s67, s69
    s_cmp_eq_u32 s3, 24576
    s_cselect_b32 s67, s69, s67
    v_add_u32 v120, s66, v6
    v_add_u32 v121, s66, v7
    v_add_u32 v122, s66, v8
    v_add_u32 v123, s66, v9
    v_add_u32 v124, s66, v10
    v_add_u32 v125, s66, v11
    v_add_u32 v126, s66, v12
    v_add_u32 v127, s66, v13
    ds_read_b128 v[56:59], v120
    ds_read_b128 v[60:63], v121
    ds_read_b128 v[64:67], v122
    ds_read_b128 v[68:71], v123
    ds_read_b128 v[72:75], v124
    ds_read_b128 v[76:79], v125
    ds_read_b128 v[80:83], v126
    ds_read_b128 v[84:87], v127
    s_add_u32 s61, s68, s97
    s_waitcnt lgkmcnt(7)
    v_mfma_f32_32x32x16_bf16 v[88:103], a[32:35], v[56:59], v[88:103]
    v_mfma_f32_32x32x16_bf16 v[104:119], v[56:59], a[160:163], v[104:119]
    s_add_u32 m0, s67, 0
    s_nop 0
    buffer_load_dwordx4 v2, s[4:7], s61 offen lds
    s_waitcnt lgkmcnt(6)
    v_mfma_f32_32x32x16_bf16 v[88:103], a[36:39], v[60:63], v[88:103]
    v_mfma_f32_32x32x16_bf16 v[104:119], v[60:63], a[164:167], v[104:119]
    s_add_u32 m0, s67, 1024
    s_nop 0
    buffer_load_dwordx4 v3, s[4:7], s61 offen lds
    s_waitcnt lgkmcnt(5)
    v_mfma_f32_32x32x16_bf16 v[88:103], a[40:43], v[64:67], v[88:103]
    v_mfma_f32_32x32x16_bf16 v[104:119], v[64:67], a[168:171], v[104:119]
    s_add_u32 m0, s67, 2048
    s_nop 0
    buffer_load_dwordx4 v4, s[4:7], s61 offen lds
    s_waitcnt lgkmcnt(4)
    v_mfma_f32_32x32x16_bf16 v[88:103], a[44:47], v[68:71], v[88:103]
    v_mfma_f32_32x32x16_bf16 v[104:119], v[68:71], a[172:175], v[104:119]
    s_add_u32 m0, s67, 3072
    s_nop 0
    buffer_load_dwordx4 v5, s[4:7], s61 offen lds
    s_waitcnt lgkmcnt(3)
    v_mfma_f32_32x32x16_bf16 v[88:103], a[48:51], v[72:75], v[88:103]
    v_mfma_f32_32x32x16_bf16 v[104:119], v[72:75], a[176:179], v[104:119]
    s_add_u32 m0, s67, 4096
    s_add_u32 s3, s61, 16384
    buffer_load_dwordx4 v2, s[4:7], s3 offen lds
    s_waitcnt lgkmcnt(2)
    v_mfma_f32_32x32x16_bf16 v[88:103], a[52:55], v[76:79], v[88:103]
    v_mfma_f32_32x32x16_bf16 v[104:119], v[76:79], a[180:183], v[104:119]
    s_add_u32 m0, s67, 5120
    s_add_u32 s3, s61, 16384
    buffer_load_dwordx4 v3, s[4:7], s3 offen lds
    s_waitcnt lgkmcnt(1)
    v_mfma_f32_32x32x16_bf16 v[88:103], a[56:59], v[80:83], v[88:103]
    v_mfma_f32_32x32x16_bf16 v[104:119], v[80:83], a[184:187], v[104:119]
    s_add_u32 m0, s67, 6144
    s_add_u32 s3, s61, 16384
    buffer_load_dwordx4 v4, s[4:7], s3 offen lds
    s_waitcnt lgkmcnt(0)
    v_mfma_f32_32x32x16_bf16 v[88:103], a[60:63], v[84:87], v[88:103]
    v_mfma_f32_32x32x16_bf16 v[104:119], v[84:87], a[188:191], v[104:119]
    s_add_u32 m0, s67, 7168
    s_add_u32 s3, s61, 16384
    buffer_load_dwordx4 v5, s[4:7], s3 offen lds
    s_add_u32 s66, s66, 8192
    s_sub_u32 s3, s66, s69
    s_cmp_eq_u32 s3, 24576
    s_cselect_b32 s66, s69, s66
    s_add_u32 s67, s67, 8192
    s_sub_u32 s3, s67, s69
    s_cmp_eq_u32 s3, 24576
    s_cselect_b32 s67, s69, s67
    s_waitcnt vmcnt(8)
    v_add_u32 v120, s66, v6
    v_add_u32 v121, s66, v7
    v_add_u32 v122, s66, v8
    v_add_u32 v123, s66, v9
    v_add_u32 v124, s66, v10
    v_add_u32 v125, s66, v11
    v_add_u32 v126, s66, v12
    v_add_u32 v127, s66, v13
    ds_read_b128 v[56:59], v120
    ds_read_b128 v[60:63], v121
    ds_read_b128 v[64:67], v122
    ds_read_b128 v[68:71], v123
    ds_read_b128 v[72:75], v124
    ds_read_b128 v[76:79], v125
    ds_read_b128 v[80:83], v126
    ds_read_b128 v[84:87], v127
    s_add_u32 s61, s68, s94
    s_add_u32 s61, s61, 131072
    s_waitcnt lgkmcnt(7)
    v_mfma_f32_32x32x16_bf16 v[88:103], a[64:67], v[56:59], v[88:103]
    v_mfma_f32_32x32x16_bf16 v[104:119], v[56:59], a[192:195], v[104:119]
    s_add_u32 m0, s67, 0
    s_nop 0
    buffer_load_dwordx4 v2, s[4:7], s61 offen lds
    s_waitcnt lgkmcnt(6)
    v_mfma_f32_32x32x16_bf16 v[88:103], a[68:71], v[60:63], v[88:103]
    v_mfma_f32_32x32x16_bf16 v[104:119], v[60:63], a[196:199], v[104:119]
    s_add_u32 m0, s67, 1024
    s_nop 0
    buffer_load_dwordx4 v3, s[4:7], s61 offen lds
    s_waitcnt lgkmcnt(5)
    v_mfma_f32_32x32x16_bf16 v[88:103], a[72:75], v[64:67], v[88:103]
    v_mfma_f32_32x32x16_bf16 v[104:119], v[64:67], a[200:203], v[104:119]
    s_add_u32 m0, s67, 2048
    s_nop 0
    buffer_load_dwordx4 v4, s[4:7], s61 offen lds
    s_waitcnt lgkmcnt(4)
    v_mfma_f32_32x32x16_bf16 v[88:103], a[76:79], v[68:71], v[88:103]
    v_mfma_f32_32x32x16_bf16 v[104:119], v[68:71], a[204:207], v[104:119]
    s_add_u32 m0, s67, 3072
    s_nop 0
    buffer_load_dwordx4 v5, s[4:7], s61 offen lds
    s_waitcnt lgkmcnt(3)
    v_mfma_f32_32x32x16_bf16 v[88:103], a[80:83], v[72:75], v[88:103]
    v_mfma_f32_32x32x16_bf16 v[104:119], v[72:75], a[208:211], v[104:119]
    s_add_u32 m0, s67, 4096
    s_add_u32 s3, s61, 16384
    buffer_load_dwordx4 v2, s[4:7], s3 offen lds
    s_waitcnt lgkmcnt(2)
    v_mfma_f32_32x32x16_bf16 v[88:103], a[84:87], v[76:79], v[88:103]
    v_mfma_f32_32x32x16_bf16 v[104:119], v[76:79], a[212:215], v[104:119]
    s_add_u32 m0, s67, 5120
    s_add_u32 s3, s61, 16384
    buffer_load_dwordx4 v3, s[4:7], s3 offen lds
    s_waitcnt lgkmcnt(1)
    v_mfma_f32_32x32x16_bf16 v[88:103], a[88:91], v[80:83], v[88:103]
    v_mfma_f32_32x32x16_bf16 v[104:119], v[80:83], a[216:219], v[104:119]
    s_add_u32 m0, s67, 6144
    s_add_u32 s3, s61, 16384
    buffer_load_dwordx4 v4, s[4:7], s3 offen lds
    s_waitcnt lgkmcnt(0)
    v_mfma_f32_32x32x16_bf16 v[88:103], a[92:95], v[84:87], v[88:103]
    v_mfma_f32_32x32x16_bf16 v[104:119], v[84:87], a[220:223], v[104:119]
    s_add_u32 m0, s67, 7168
    s_add_u32 s3, s61, 16384
    buffer_load_dwordx4 v5, s[4:7], s3 offen lds
    s_add_u32 s66, s66, 8192
    s_sub_u32 s3, s66, s69
    s_cmp_eq_u32 s3, 24576
    s_cselect_b32 s66, s69, s66
    s_add_u32 s67, s67, 8192
    s_sub_u32 s3, s67, s69
    s_cmp_eq_u32 s3, 24576
    s_cselect_b32 s67, s69, s67
    s_waitcnt vmcnt(8)
    v_add_u32 v120, s66, v6
    v_add_u32 v121, s66, v7
    v_add_u32 v122, s66, v8
    v_add_u32 v123, s66, v9
    v_add_u32 v124, s66, v10
    v_add_u32 v125, s66, v11
    v_add_u32 v126, s66, v12
    v_add_u32 v127, s66, v13
    ds_read_b128 v[56:59], v120
    ds_read_b128 v[60:63], v121
    ds_read_b128 v[64:67], v122
    ds_read_b128 v[68:71], v123
    ds_read_b128 v[72:75], v124
    ds_read_b128 v[76:79], v125
    ds_read_b128 v[80:83], v126
    ds_read_b128 v[84:87], v127
    s_add_u32 s61, s68, s95
    s_add_u32 s61, s61, 131072
    s_waitcnt lgkmcnt(7)
    v_mfma_f32_32x32x16_bf16 v[88:103], a[96:99], v[56:59], v[88:103]
    v_mfma_f32_32x32x16_bf16 v[104:119], v[56:59], a[224:227], v[104:119]
    s_add_u32 m0, s67, 0
    s_nop 0
    buffer_load_dwordx4 v2, s[4:7], s61 offen lds
    s_waitcnt lgkmcnt(6)
    v_mfma_f32_32x32x16_bf16 v[88:103], a[100:103], v[60:63], v[88:103]
    v_mfma_f32_32x32x16_bf16 v[104:119], v[60:63], a[228:231], v[104:119]
    s_add_u32 m0, s67, 1024
    s_nop 0
    buffer_load_dwordx4 v3, s[4:7], s61 offen lds
    s_waitcnt lgkmcnt(5)
    v_mfma_f32_32x32x16_bf16 v[88:103], a[104:107], v[64:67], v[88:103]
    v_mfma_f32_32x32x16_bf16 v[104:119], v[64:67], a[232:235], v[104:119]
    s_add_u32 m0, s67, 2048
    s_nop 0
    buffer_load_dwordx4 v4, s[4:7], s61 offen lds
    s_waitcnt lgkmcnt(4)
    v_mfma_f32_32x32x16_bf16 v[88:103], a[108:111], v[68:71], v[88:103]
    v_mfma_f32_32x32x16_bf16 v[104:119], v[68:71], a[236:239], v[104:119]
    s_add_u32 m0, s67, 3072
    s_nop 0
    buffer_load_dwordx4 v5, s[4:7], s61 offen lds
    s_waitcnt lgkmcnt(3)
    v_mfma_f32_32x32x16_bf16 v[88:103], a[112:115], v[72:75], v[88:103]
    v_mfma_f32_32x32x16_bf16 v[104:119], v[72:75], a[240:243], v[104:119]
    s_add_u32 m0, s67, 4096
    s_add_u32 s3, s61, 16384
    buffer_load_dwordx4 v2, s[4:7], s3 offen lds
    s_waitcnt lgkmcnt(2)
    v_mfma_f32_32x32x16_bf16 v[88:103], a[116:119], v[76:79], v[88:103]
    v_mfma_f32_32x32x16_bf16 v[104:119], v[76:79], a[244:247], v[104:119]
    s_add_u32 m0, s67, 5120
    s_add_u32 s3, s61, 16384
    buffer_load_dwordx4 v3, s[4:7], s3 offen lds
    s_waitcnt lgkmcnt(1)
    v_mfma_f32_32x32x16_bf16 v[88:103], a[120:123], v[80:83], v[88:103]
    v_mfma_f32_32x32x16_bf16 v[104:119], v[80:83], a[248:251], v[104:119]
    s_add_u32 m0, s67, 6144
    s_add_u32 s3, s61, 16384
    buffer_load_dwordx4 v4, s[4:7], s3 offen lds
    s_waitcnt lgkmcnt(0)
    v_mfma_f32_32x32x16_bf16 v[88:103], a[124:127], v[84:87], v[88:103]
    v_mfma_f32_32x32x16_bf16 v[104:119], v[84:87], a[252:255], v[104:119]
    s_add_u32 m0, s67, 7168
    s_add_u32 s3, s61, 16384
    buffer_load_dwordx4 v5, s[4:7], s3 offen lds
    s_add_u32 s66, s66, 8192
    s_sub_u32 s3, s66, s69
    s_cmp_eq_u32 s3, 24576
    s_cselect_b32 s66, s69, s66
    s_add_u32 s67, s67, 8192
    s_sub_u32 s3, s67, s69
    s_cmp_eq_u32 s3, 24576
    s_cselect_b32 s67, s69, s67
    s_and_b32 s60, s65, 15
    s_mul_i32 s60, s60, 3072
    s_add_u32 s60, s60, 98304
    v_add_u32 v20, s60, v1
    v_cvt_pk_bf16_f32 v216, v88, v89
    v_cvt_pk_bf16_f32 v217, v90, v91
    v_cvt_pk_bf16_f32 v218, v92, v93
    v_cvt_pk_bf16_f32 v219, v94, v95
    v_cvt_pk_bf16_f32 v128, v96, v97
    v_cvt_pk_bf16_f32 v129, v98, v99
    v_cvt_pk_bf16_f32 v130, v100, v101
    v_cvt_pk_bf16_f32 v131, v102, v103
    ds_write_b128 v20, v[128:131]
    s_mov_b64 exec, s[78:79]
    ds_write_b128 v18, v[104:107] offset:0
    ds_write_b128 v18, v[108:111] offset:32
    ds_write_b128 v18, v[112:115] offset:64
    ds_write_b128 v18, v[116:119] offset:96
    s_mov_b64 exec, -1
    v_cvt_pk_bf16_f32 v132, v104, v105
    v_cvt_pk_bf16_f32 v133, v106, v107
    v_cvt_pk_bf16_f32 v134, v108, v109
    v_cvt_pk_bf16_f32 v135, v110, v111
    v_cvt_pk_bf16_f32 v136, v112, v113
    v_cvt_pk_bf16_f32 v137, v114, v115
    v_cvt_pk_bf16_f32 v138, v116, v117
    v_cvt_pk_bf16_f32 v139, v118, v119
    v_cndmask_b32 v132, v132, v22, s[80:81]
    v_cndmask_b32 v133, v133, v22, s[80:81]
    v_cndmask_b32 v134, v134, v22, s[80:81]
    v_cndmask_b32 v135, v135, v22, s[80:81]
    v_cndmask_b32 v136, v136, v22, s[80:81]
    v_cndmask_b32 v137, v137, v22, s[80:81]
    v_cndmask_b32 v138, v138, v22, s[80:81]
    v_cndmask_b32 v139, v139, v22, s[80:81]
    ds_write_b128 v20, v[132:135] offset:1024
    ds_write_b128 v20, v[136:139] offset:2048
    ds_read_b32 v17, v19
    s_waitcnt lgkmcnt(0)
    s_barrier
    s_cmp_lg_u32 s52, 0
    s_cbranch_scc1 L_B_NOFLAG
    v_mov_b32 v14, s71
    v_mov_b32 v15, 0
    s_mov_b64 exec, 1
    buffer_store_dword v14, v15, s[48:51], s70 offen sc1
    s_mov_b64 exec, -1
L_B_NOFLAG:
    s_cmp_lt_u32 s63, s75
    s_cbranch_scc1 L_B_SKIP
    s_add_u32 s3, s65, 8
    s_and_b32 s3, s3, 15
    s_mul_i32 s84, s3, 3072
    s_add_u32 s84, s84, 98304
    s_add_u32 s3, s65, 9
    s_and_b32 s3, s3, 15
    s_mul_i32 s85, s3, 3072
    s_add_u32 s85, s85, 98304
    s_add_u32 s3, s65, 10
    s_and_b32 s3, s3, 15
    s_mul_i32 s86, s3, 3072
    s_add_u32 s86, s86, 98304
    s_add_u32 s3, s65, 11
    s_and_b32 s3, s3, 15
    s_mul_i32 s87, s3, 3072
    s_add_u32 s87, s87, 98304
    s_add_u32 s3, s65, 12
    s_and_b32 s3, s3, 15
    s_mul_i32 s88, s3, 3072
    s_add_u32 s88, s88, 98304
    s_add_u32 s3, s65, 13
    s_and_b32 s3, s3, 15
    s_mul_i32 s89, s3, 3072
    s_add_u32 s89, s89, 98304
    s_add_u32 s3, s65, 14
    s_and_b32 s3, s3, 15
    s_mul_i32 s90, s3, 3072
    s_add_u32 s90, s90, 98304
    s_add_u32 s3, s65, 15
    s_and_b32 s3, s3, 15
    s_mul_i32 s91, s3, 3072
    s_add_u32 s91, s91, 98304
    s_add_u32 s3, s65, 16
    s_and_b32 s3, s3, 15
    s_mul_i32 s92, s3, 3072
    s_add_u32 s92, s92, 98304
    v_add_u32 v20, s84, v1
    ds_read_b128 v[220:223], v20
    v_add_u32 v21, s85, v1
    ds_read_b128 v[224:227], v21
    v_add_u32 v20, s86, v1
    ds_read_b128 v[228:231], v20
    v_add_u32 v21, s87, v1
    ds_read_b128 v[232:235], v21
    v_add_u32 v20, s88, v1
    ds_read_b128 v[236:239], v20
    v_add_u32 v21, s89, v1
    ds_read_b128 v[240:243], v21
    v_add_u32 v20, s90, v1
    ds_read_b128 v[244:247], v20
    v_add_u32 v21, s91, v1
    ds_read_b128 v[248:251], v21
    v_add_u32 v20, s92, v1
    ds_read_b128 v[252:255], v20
    v_mul_f32 v17, 0xbfb8aa3b, v17
    v_exp_f32 v17, v17
    s_nop 0
    v_add_f32 v17, 1.0, v17
    v_rcp_f32 v17, v17
    s_waitcnt lgkmcnt(8)
    v_mfma_f32_32x32x16_bf16 v[56:71], v[220:223], v[216:219], v[40:55]
    s_waitcnt lgkmcnt(7)
    v_mfma_f32_32x32x16_bf16 v[72:87], v[224:227], v[216:219], 0
    s_waitcnt lgkmcnt(6)
    v_mfma_f32_32x32x16_bf16 v[88:103], v[228:231], v[216:219], 0
    s_waitcnt lgkmcnt(5)
    v_mfma_f32_32x32x16_bf16 v[104:119], v[232:235], v[216:219], 0
    s_waitcnt lgkmcnt(4)
    v_mfma_f32_32x32x16_bf16 v[120:135], v[236:239], v[216:219], 0
    s_waitcnt lgkmcnt(3)
    v_mfma_f32_32x32x16_bf16 v[136:151], v[240:243], v[216:219], 0
    s_waitcnt lgkmcnt(2)
    v_mfma_f32_32x32x16_bf16 v[152:167], v[244:247], v[216:219], 0
    s_waitcnt lgkmcnt(1)
    v_mfma_f32_32x32x16_bf16 v[168:183], v[248:251], v[216:219], 0
    s_waitcnt lgkmcnt(0)
    v_mfma_f32_32x32x16_bf16 v[184:199], v[252:255], v[216:219], v[24:39]
    v_add_u32 v20, s84, v1
    ds_read_b128 v[220:223], v20 offset:1024
    ds_read_b128 v[224:227], v20 offset:2048
    v_add_u32 v21, s85, v1
    ds_read_b128 v[228:231], v21 offset:1024
    ds_read_b128 v[232:235], v21 offset:2048
    v_add_u32 v20, s86, v1
    ds_read_b128 v[236:239], v20 offset:1024
    ds_read_b128 v[240:243], v20 offset:2048
    v_add_u32 v21, s87, v1
    ds_read_b128 v[244:247], v21 offset:1024
    ds_read_b128 v[248:251], v21 offset:2048
    s_cmp_ge_u32 s65, 8
    s_cbranch_scc1 L_B_ALLVALID
    s_nop 15
    s_cmp_ge_u32 s65, 8
    s_cbranch_scc1 L_B_ALLVALID
    v_mov_b32 v56, 0xf149f2ca
    v_mov_b32 v57, 0xf149f2ca
    v_mov_b32 v58, 0xf149f2ca
    v_mov_b32 v59, 0xf149f2ca
    v_mov_b32 v60, 0xf149f2ca
    v_mov_b32 v61, 0xf149f2ca
    v_mov_b32 v62, 0xf149f2ca
    v_mov_b32 v63, 0xf149f2ca
    v_mov_b32 v64, 0xf149f2ca
    v_mov_b32 v65, 0xf149f2ca
    v_mov_b32 v66, 0xf149f2ca
    v_mov_b32 v67, 0xf149f2ca
    v_mov_b32 v68, 0xf149f2ca
    v_mov_b32 v69, 0xf149f2ca
    v_mov_b32 v70, 0xf149f2ca
    v_mov_b32 v71, 0xf149f2ca
    s_cmp_ge_u32 s65, 7
    s_cbranch_scc1 L_B_ALLVALID
    v_mov_b32 v72, 0xf149f2ca
    v_mov_b32 v73, 0xf149f2ca
    v_mov_b32 v74, 0xf149f2ca
    v_mov_b32 v75, 0xf149f2ca
    v_mov_b32 v76, 0xf149f2ca
    v_mov_b32 v77, 0xf149f2ca
    v_mov_b32 v78, 0xf149f2ca
    v_mov_b32 v79, 0xf149f2ca
    v_mov_b32 v80, 0xf149f2ca
    v_mov_b32 v81, 0xf149f2ca
    v_mov_b32 v82, 0xf149f2ca
    v_mov_b32 v83, 0xf149f2ca
    v_mov_b32 v84, 0xf149f2ca
    v_mov_b32 v85, 0xf149f2ca
    v_mov_b32 v86, 0xf149f2ca
    v_mov_b32 v87, 0xf149f2ca
    s_cmp_ge_u32 s65, 6
    s_cbranch_scc1 L_B_ALLVALID
    v_mov_b32 v88, 0xf149f2ca
    v_mov_b32 v89, 0xf149f2ca
    v_mov_b32 v90, 0xf149f2ca
    v_mov_b32 v91, 0xf149f2ca
    v_mov_b32 v92, 0xf149f2ca
    v_mov_b32 v93, 0xf149f2ca
    v_mov_b32 v94, 0xf149f2ca
    v_mov_b32 v95, 0xf149f2ca
    v_mov_b32 v96, 0xf149f2ca
    v_mov_b32 v97, 0xf149f2ca
    v_mov_b32 v98, 0xf149f2ca
    v_mov_b32 v99, 0xf149f2ca
    v_mov_b32 v100, 0xf149f2ca
    v_mov_b32 v101, 0xf149f2ca
    v_mov_b32 v102, 0xf149f2ca
    v_mov_b32 v103, 0xf149f2ca
    s_cmp_ge_u32 s65, 5
    s_cbranch_scc1 L_B_ALLVALID
    v_mov_b32 v104, 0xf149f2ca
    v_mov_b32 v105, 0xf149f2ca
    v_mov_b32 v106, 0xf149f2ca
    v_mov_b32 v107, 0xf149f2ca
    v_mov_b32 v108, 0xf149f2ca
    v_mov_b32 v109, 0xf149f2ca
    v_mov_b32 v110, 0xf149f2ca
    v_mov_b32 v111, 0xf149f2ca
    v_mov_b32 v112, 0xf149f2ca
    v_mov_b32 v113, 0xf149f2ca
    v_mov_b32 v114, 0xf149f2ca
    v_mov_b32 v115, 0xf149f2ca
    v_mov_b32 v116, 0xf149f2ca
    v_mov_b32 v117, 0xf149f2ca
    v_mov_b32 v118, 0xf149f2ca
    v_mov_b32 v119, 0xf149f2ca
    s_cmp_ge_u32 s65, 4
    s_cbranch_scc1 L_B_ALLVALID
    v_mov_b32 v120, 0xf149f2ca
    v_mov_b32 v121, 0xf149f2ca
    v_mov_b32 v122, 0xf149f2ca
    v_mov_b32 v123, 0xf149f2ca
    v_mov_b32 v124, 0xf149f2ca
    v_mov_b32 v125, 0xf149f2ca
    v_mov_b32 v126, 0xf149f2ca
    v_mov_b32 v127, 0xf149f2ca
    v_mov_b32 v128, 0xf149f2ca
    v_mov_b32 v129, 0xf149f2ca
    v_mov_b32 v130, 0xf149f2ca
    v_mov_b32 v131, 0xf149f2ca
    v_mov_b32 v132, 0xf149f2ca
    v_mov_b32 v133, 0xf149f2ca
    v_mov_b32 v134, 0xf149f2ca
    v_mov_b32 v135, 0xf149f2ca
    s_cmp_ge_u32 s65, 3
    s_cbranch_scc1 L_B_ALLVALID
    v_mov_b32 v136, 0xf149f2ca
    v_mov_b32 v137, 0xf149f2ca
    v_mov_b32 v138, 0xf149f2ca
    v_mov_b32 v139, 0xf149f2ca
    v_mov_b32 v140, 0xf149f2ca
    v_mov_b32 v141, 0xf149f2ca
    v_mov_b32 v142, 0xf149f2ca
    v_mov_b32 v143, 0xf149f2ca
    v_mov_b32 v144, 0xf149f2ca
    v_mov_b32 v145, 0xf149f2ca
    v_mov_b32 v146, 0xf149f2ca
    v_mov_b32 v147, 0xf149f2ca
    v_mov_b32 v148, 0xf149f2ca
    v_mov_b32 v149, 0xf149f2ca
    v_mov_b32 v150, 0xf149f2ca
    v_mov_b32 v151, 0xf149f2ca
    s_cmp_ge_u32 s65, 2
    s_cbranch_scc1 L_B_ALLVALID
    v_mov_b32 v152, 0xf149f2ca
    v_mov_b32 v153, 0xf149f2ca
    v_mov_b32 v154, 0xf149f2ca
    v_mov_b32 v155, 0xf149f2ca
    v_mov_b32 v156, 0xf149f2ca
    v_mov_b32 v157, 0xf149f2ca
    v_mov_b32 v158, 0xf149f2ca
    v_mov_b32 v159, 0xf149f2ca
    v_mov_b32 v160, 0xf149f2ca
    v_mov_b32 v161, 0xf149f2ca
    v_mov_b32 v162, 0xf149f2ca
    v_mov_b32 v163, 0xf149f2ca
    v_mov_b32 v164, 0xf149f2ca
    v_mov_b32 v165, 0xf149f2ca
    v_mov_b32 v166, 0xf149f2ca
    v_mov_b32 v167, 0xf149f2ca
    s_cmp_ge_u32 s65, 1
    s_cbranch_scc1 L_B_ALLVALID
    v_mov_b32 v168, 0xf149f2ca
    v_mov_b32 v169, 0xf149f2ca
    v_mov_b32 v170, 0xf149f2ca
    v_mov_b32 v171, 0xf149f2ca
    v_mov_b32 v172, 0xf149f2ca
    v_mov_b32 v173, 0xf149f2ca
    v_mov_b32 v174, 0xf149f2ca
    v_mov_b32 v175, 0xf149f2ca
    v_mov_b32 v176, 0xf149f2ca
    v_mov_b32 v177, 0xf149f2ca
    v_mov_b32 v178, 0xf149f2ca
    v_mov_b32 v179, 0xf149f2ca
    v_mov_b32 v180, 0xf149f2ca
    v_mov_b32 v181, 0xf149f2ca
    v_mov_b32 v182, 0xf149f2ca
    v_mov_b32 v183, 0xf149f2ca
L_B_ALLVALID:
    v_max3_f32 v16, v56, v57, v58
    v_max_f32 v14, v59, v60
    v_max3_f32 v16, v16, v61, v62
    v_max3_f32 v14, v14, v63, v64
    v_max3_f32 v16, v16, v65, v66
    v_max3_f32 v14, v14, v67, v68
    v_max3_f32 v16, v16, v69, v70
    v_max3_f32 v14, v14, v71, v72
    v_max3_f32 v16, v16, v73, v74
    v_max3_f32 v14, v14, v75, v76
    v_max3_f32 v16, v16, v77, v78
    v_max3_f32 v14, v14, v79, v80
    v_max3_f32 v16, v16, v81, v82
    v_max3_f32 v14, v14, v83, v84
    v_max3_f32 v16, v16, v85, v86
    v_max3_f32 v14, v14, v87, v88
    v_max3_f32 v16, v16, v89, v90
    v_max3_f32 v14, v14, v91, v92
    v_max3_f32 v16, v16, v93, v94
    v_max3_f32 v14, v14, v95, v96
    v_max3_f32 v16, v16, v97, v98
    v_max3_f32 v14, v14, v99, v100
    v_max3_f32 v16, v16, v101, v102
    v_max3_f32 v14, v14, v103, v104
    v_max3_f32 v16, v16, v105, v106
    v_max3_f32 v14, v14, v107, v108
    v_max3_f32 v16, v16, v109, v110
    v_max3_f32 v14, v14, v111, v112
    v_max3_f32 v16, v16, v113, v114
    v_max3_f32 v14, v14, v115, v116
    v_max3_f32 v16, v16, v117, v118
    v_max3_f32 v14, v14, v119, v120
    v_max3_f32 v16, v16, v121, v122
    v_max3_f32 v14, v14, v123, v124
    v_max3_f32 v16, v16, v125, v126
    v_max3_f32 v14, v14, v127, v128
    v_max3_f32 v16, v16, v129, v130
    v_max3_f32 v14, v14, v131, v132
    v_max3_f32 v16, v16, v133, v134
    v_max3_f32 v14, v14, v135, v136
    v_max3_f32 v16, v16, v137, v138
    v_max3_f32 v14, v14, v139, v140
    v_max3_f32 v16, v16, v141, v142
    v_max3_f32 v14, v14, v143, v144
    v_max3_f32 v16, v16, v145, v146
    v_max3_f32 v14, v14, v147, v148
    v_max3_f32 v16, v16, v149, v150
    v_max3_f32 v14, v14, v151, v152
    v_max3_f32 v16, v16, v153, v154
    v_max3_f32 v14, v14, v155, v156
    v_max3_f32 v16, v16, v157, v158
    v_max3_f32 v14, v14, v159, v160
    v_max3_f32 v16, v16, v161, v162
    v_max3_f32 v14, v14, v163, v164
    v_max3_f32 v16, v16, v165, v166
    v_max3_f32 v14, v14, v167, v168
    v_max3_f32 v16, v16, v169, v170
    v_max3_f32 v14, v14, v171, v172
    v_max3_f32 v16, v16, v173, v174
    v_max3_f32 v14, v14, v175, v176
    v_max3_f32 v16, v16, v177, v178
    v_max3_f32 v14, v14, v179, v180
    v_max3_f32 v16, v16, v181, v182
    v_max3_f32 v14, v14, v183, v184
    v_max3_f32 v16, v16, v185, v186
    v_max3_f32 v14, v14, v187, v188
    v_max3_f32 v16, v16, v189, v190
    v_max3_f32 v14, v14, v191, v192
    v_max3_f32 v16, v16, v193, v194
    v_max3_f32 v14, v14, v195, v196
    v_max3_f32 v16, v16, v197, v198
    v_max_f32 v14, v14, v199
    v_max_f32 v16, v16, v14
    v_mov_b32 v14, v16
    s_nop 1
    v_permlane32_swap_b32 v16, v14
    v_max_f32 v16, v16, v14
    v_mul_f32 v16, s72, v16
    v_fma_f32 v56, v56, s72, -v16
    v_fma_f32 v57, v57, s72, -v16
    v_fma_f32 v58, v58, s72, -v16
    v_fma_f32 v59, v59, s72, -v16
    v_fma_f32 v60, v60, s72, -v16
    v_fma_f32 v61, v61, s72, -v16
    v_fma_f32 v62, v62, s72, -v16
    v_fma_f32 v63, v63, s72, -v16
    v_fma_f32 v64, v64, s72, -v16
    v_fma_f32 v65, v65, s72, -v16
    v_fma_f32 v66, v66, s72, -v16
    v_fma_f32 v67, v67, s72, -v16
    v_fma_f32 v68, v68, s72, -v16
    v_fma_f32 v69, v69, s72, -v16
    v_fma_f32 v70, v70, s72, -v16
    v_fma_f32 v71, v71, s72, -v16
    v_exp_f32 v56, v56
    v_exp_f32 v57, v57
    v_exp_f32 v58, v58
    v_exp_f32 v59, v59
    v_exp_f32 v60, v60
    v_exp_f32 v61, v61
    v_exp_f32 v62, v62
    v_exp_f32 v63, v63
    v_exp_f32 v64, v64
    v_exp_f32 v65, v65
    v_exp_f32 v66, v66
    v_exp_f32 v67, v67
    v_exp_f32 v68, v68
    v_exp_f32 v69, v69
    v_exp_f32 v70, v70
    v_exp_f32 v71, v71
    v_cvt_pk_bf16_f32 v56, v56, v57
    v_cvt_pk_bf16_f32 v57, v58, v59
    v_cvt_pk_bf16_f32 v58, v60, v61
    v_cvt_pk_bf16_f32 v59, v62, v63
    v_cvt_pk_bf16_f32 v60, v64, v65
    v_cvt_pk_bf16_f32 v61, v66, v67
    v_cvt_pk_bf16_f32 v62, v68, v69
    v_cvt_pk_bf16_f32 v63, v70, v71
    s_waitcnt lgkmcnt(7)
    v_mfma_f32_32x32x16_bf16 v[200:215], v[220:223], v[56:59], 0
    v_add_u32 v20, s88, v1
    ds_read_b128 v[220:223], v20 offset:1024
    s_waitcnt lgkmcnt(7)
    v_mfma_f32_32x32x16_bf16 v[200:215], v[224:227], v[60:63], v[200:215]
    ds_read_b128 v[224:227], v20 offset:2048
    v_fma_f32 v72, v72, s72, -v16
    v_fma_f32 v73, v73, s72, -v16
    v_fma_f32 v74, v74, s72, -v16
    v_fma_f32 v75, v75, s72, -v16
    v_fma_f32 v76, v76, s72, -v16
    v_fma_f32 v77, v77, s72, -v16
    v_fma_f32 v78, v78, s72, -v16
    v_fma_f32 v79, v79, s72, -v16
    v_fma_f32 v80, v80, s72, -v16
    v_fma_f32 v81, v81, s72, -v16
    v_fma_f32 v82, v82, s72, -v16
    v_fma_f32 v83, v83, s72, -v16
    v_fma_f32 v84, v84, s72, -v16
    v_fma_f32 v85, v85, s72, -v16
    v_fma_f32 v86, v86, s72, -v16
    v_fma_f32 v87, v87, s72, -v16
    v_exp_f32 v72, v72
    v_exp_f32 v73, v73
    v_exp_f32 v74, v74
    v_exp_f32 v75, v75
    v_exp_f32 v76, v76
    v_exp_f32 v77, v77
    v_exp_f32 v78, v78
    v_exp_f32 v79, v79
    v_exp_f32 v80, v80
    v_exp_f32 v81, v81
    v_exp_f32 v82, v82
    v_exp_f32 v83, v83
    v_exp_f32 v84, v84
    v_exp_f32 v85, v85
    v_exp_f32 v86, v86
    v_exp_f32 v87, v87
    v_cvt_pk_bf16_f32 v72, v72, v73
    v_cvt_pk_bf16_f32 v73, v74, v75
    v_cvt_pk_bf16_f32 v74, v76, v77
    v_cvt_pk_bf16_f32 v75, v78, v79
    v_cvt_pk_bf16_f32 v76, v80, v81
    v_cvt_pk_bf16_f32 v77, v82, v83
    v_cvt_pk_bf16_f32 v78, v84, v85
    v_cvt_pk_bf16_f32 v79, v86, v87
    s_waitcnt lgkmcnt(7)
    v_mfma_f32_32x32x16_bf16 v[200:215], v[228:231], v[72:75], v[200:215]
    v_add_u32 v21, s89, v1
    ds_read_b128 v[228:231], v21 offset:1024
    s_waitcnt lgkmcnt(7)
    v_mfma_f32_32x32x16_bf16 v[200:215], v[232:235], v[76:79], v[200:215]
    ds_read_b128 v[232:235], v21 offset:2048
    v_fma_f32 v88, v88, s72, -v16
    v_fma_f32 v89, v89, s72, -v16
    v_fma_f32 v90, v90, s72, -v16
    v_fma_f32 v91, v91, s72, -v16
    v_fma_f32 v92, v92, s72, -v16
    v_fma_f32 v93, v93, s72, -v16
    v_fma_f32 v94, v94, s72, -v16
    v_fma_f32 v95, v95, s72, -v16
    v_fma_f32 v96, v96, s72, -v16
    v_fma_f32 v97, v97, s72, -v16
    v_fma_f32 v98, v98, s72, -v16
    v_fma_f32 v99, v99, s72, -v16
    v_fma_f32 v100, v100, s72, -v16
    v_fma_f32 v101, v101, s72, -v16
    v_fma_f32 v102, v102, s72, -v16
    v_fma_f32 v103, v103, s72, -v16
    v_exp_f32 v88, v88
    v_exp_f32 v89, v89
    v_exp_f32 v90, v90
    v_exp_f32 v91, v91
    v_exp_f32 v92, v92
    v_exp_f32 v93, v93
    v_exp_f32 v94, v94
    v_exp_f32 v95, v95
    v_exp_f32 v96, v96
    v_exp_f32 v97, v97
    v_exp_f32 v98, v98
    v_exp_f32 v99, v99
    v_exp_f32 v100, v100
    v_exp_f32 v101, v101
    v_exp_f32 v102, v102
    v_exp_f32 v103, v103
    v_cvt_pk_bf16_f32 v88, v88, v89
    v_cvt_pk_bf16_f32 v89, v90, v91
    v_cvt_pk_bf16_f32 v90, v92, v93
    v_cvt_pk_bf16_f32 v91, v94, v95
    v_cvt_pk_bf16_f32 v92, v96, v97
    v_cvt_pk_bf16_f32 v93, v98, v99
    v_cvt_pk_bf16_f32 v94, v100, v101
    v_cvt_pk_bf16_f32 v95, v102, v103
    s_waitcnt lgkmcnt(7)
    v_mfma_f32_32x32x16_bf16 v[200:215], v[236:239], v[88:91], v[200:215]
    v_add_u32 v20, s90, v1
    ds_read_b128 v[236:239], v20 offset:1024
    s_waitcnt lgkmcnt(7)
    v_mfma_f32_32x32x16_bf16 v[200:215], v[240:243], v[92:95], v[200:215]
    ds_read_b128 v[240:243], v20 offset:2048
    v_fma_f32 v104, v104, s72, -v16
    v_fma_f32 v105, v105, s72, -v16
    v_fma_f32 v106, v106, s72, -v16
    v_fma_f32 v107, v107, s72, -v16
    v_fma_f32 v108, v108, s72, -v16
    v_fma_f32 v109, v109, s72, -v16
    v_fma_f32 v110, v110, s72, -v16
    v_fma_f32 v111, v111, s72, -v16
    v_fma_f32 v112, v112, s72, -v16
    v_fma_f32 v113, v113, s72, -v16
    v_fma_f32 v114, v114, s72, -v16
    v_fma_f32 v115, v115, s72, -v16
    v_fma_f32 v116, v116, s72, -v16
    v_fma_f32 v117, v117, s72, -v16
    v_fma_f32 v118, v118, s72, -v16
    v_fma_f32 v119, v119, s72, -v16
    v_exp_f32 v104, v104
    v_exp_f32 v105, v105
    v_exp_f32 v106, v106
    v_exp_f32 v107, v107
    v_exp_f32 v108, v108
    v_exp_f32 v109, v109
    v_exp_f32 v110, v110
    v_exp_f32 v111, v111
    v_exp_f32 v112, v112
    v_exp_f32 v113, v113
    v_exp_f32 v114, v114
    v_exp_f32 v115, v115
    v_exp_f32 v116, v116
    v_exp_f32 v117, v117
    v_exp_f32 v118, v118
    v_exp_f32 v119, v119
    v_cvt_pk_bf16_f32 v104, v104, v105
    v_cvt_pk_bf16_f32 v105, v106, v107
    v_cvt_pk_bf16_f32 v106, v108, v109
    v_cvt_pk_bf16_f32 v107, v110, v111
    v_cvt_pk_bf16_f32 v108, v112, v113
    v_cvt_pk_bf16_f32 v109, v114, v115
    v_cvt_pk_bf16_f32 v110, v116, v117
    v_cvt_pk_bf16_f32 v111, v118, v119
    s_waitcnt lgkmcnt(7)
    v_mfma_f32_32x32x16_bf16 v[200:215], v[244:247], v[104:107], v[200:215]
    v_add_u32 v21, s91, v1
    ds_read_b128 v[244:247], v21 offset:1024
    s_waitcnt lgkmcnt(7)
    v_mfma_f32_32x32x16_bf16 v[200:215], v[248:251], v[108:111], v[200:215]
    ds_read_b128 v[248:251], v21 offset:2048
    v_fma_f32 v120, v120, s72, -v16
    v_fma_f32 v121, v121, s72, -v16
    v_fma_f32 v122, v122, s72, -v16
    v_fma_f32 v123, v123, s72, -v16
    v_fma_f32 v124, v124, s72, -v16
    v_fma_f32 v125, v125, s72, -v16
    v_fma_f32 v126, v126, s72, -v16
    v_fma_f32 v127, v127, s72, -v16
    v_fma_f32 v128, v128, s72, -v16
    v_fma_f32 v129, v129, s72, -v16
    v_fma_f32 v130, v130, s72, -v16
    v_fma_f32 v131, v131, s72, -v16
    v_fma_f32 v132, v132, s72, -v16
    v_fma_f32 v133, v133, s72, -v16
    v_fma_f32 v134, v134, s72, -v16
    v_fma_f32 v135, v135, s72, -v16
    v_exp_f32 v120, v120
    v_exp_f32 v121, v121
    v_exp_f32 v122, v122
    v_exp_f32 v123, v123
    v_exp_f32 v124, v124
    v_exp_f32 v125, v125
    v_exp_f32 v126, v126
    v_exp_f32 v127, v127
    v_exp_f32 v128, v128
    v_exp_f32 v129, v129
    v_exp_f32 v130, v130
    v_exp_f32 v131, v131
    v_exp_f32 v132, v132
    v_exp_f32 v133, v133
    v_exp_f32 v134, v134
    v_exp_f32 v135, v135
    v_cvt_pk_bf16_f32 v120, v120, v121
    v_cvt_pk_bf16_f32 v121, v122, v123
    v_cvt_pk_bf16_f32 v122, v124, v125
    v_cvt_pk_bf16_f32 v123, v126, v127
    v_cvt_pk_bf16_f32 v124, v128, v129
    v_cvt_pk_bf16_f32 v125, v130, v131
    v_cvt_pk_bf16_f32 v126, v132, v133
    v_cvt_pk_bf16_f32 v127, v134, v135
    s_waitcnt lgkmcnt(7)
    v_mfma_f32_32x32x16_bf16 v[200:215], v[220:223], v[120:123], v[200:215]
    v_add_u32 v20, s92, v1
    ds_read_b128 v[220:223], v20 offset:1024
    s_waitcnt lgkmcnt(7)
    v_mfma_f32_32x32x16_bf16 v[200:215], v[224:227], v[124:127], v[200:215]
    ds_read_b128 v[224:227], v20 offset:2048
    v_fma_f32 v136, v136, s72, -v16
    v_fma_f32 v137, v137, s72, -v16
    v_fma_f32 v138, v138, s72, -v16
    v_fma_f32 v139, v139, s72, -v16
    v_fma_f32 v140, v140, s72, -v16
    v_fma_f32 v141, v141, s72, -v16
    v_fma_f32 v142, v142, s72, -v16
    v_fma_f32 v143, v143, s72, -v16
    v_fma_f32 v144, v144, s72, -v16
    v_fma_f32 v145, v145, s72, -v16
    v_fma_f32 v146, v146, s72, -v16
    v_fma_f32 v147, v147, s72, -v16
    v_fma_f32 v148, v148, s72, -v16
    v_fma_f32 v149, v149, s72, -v16
    v_fma_f32 v150, v150, s72, -v16
    v_fma_f32 v151, v151, s72, -v16
    v_exp_f32 v136, v136
    v_exp_f32 v137, v137
    v_exp_f32 v138, v138
    v_exp_f32 v139, v139
    v_exp_f32 v140, v140
    v_exp_f32 v141, v141
    v_exp_f32 v142, v142
    v_exp_f32 v143, v143
    v_exp_f32 v144, v144
    v_exp_f32 v145, v145
    v_exp_f32 v146, v146
    v_exp_f32 v147, v147
    v_exp_f32 v148, v148
    v_exp_f32 v149, v149
    v_exp_f32 v150, v150
    v_exp_f32 v151, v151
    v_cvt_pk_bf16_f32 v136, v136, v137
    v_cvt_pk_bf16_f32 v137, v138, v139
    v_cvt_pk_bf16_f32 v138, v140, v141
    v_cvt_pk_bf16_f32 v139, v142, v143
    v_cvt_pk_bf16_f32 v140, v144, v145
    v_cvt_pk_bf16_f32 v141, v146, v147
    v_cvt_pk_bf16_f32 v142, v148, v149
    v_cvt_pk_bf16_f32 v143, v150, v151
    s_waitcnt lgkmcnt(7)
    v_mfma_f32_32x32x16_bf16 v[200:215], v[228:231], v[136:139], v[200:215]
    s_waitcnt lgkmcnt(6)
    v_mfma_f32_32x32x16_bf16 v[200:215], v[232:235], v[140:143], v[200:215]
    v_fma_f32 v152, v152, s72, -v16
    v_fma_f32 v153, v153, s72, -v16
    v_fma_f32 v154, v154, s72, -v16
    v_fma_f32 v155, v155, s72, -v16
    v_fma_f32 v156, v156, s72, -v16
    v_fma_f32 v157, v157, s72, -v16
    v_fma_f32 v158, v158, s72, -v16
    v_fma_f32 v159, v159, s72, -v16
    v_fma_f32 v160, v160, s72, -v16
    v_fma_f32 v161, v161, s72, -v16
    v_fma_f32 v162, v162, s72, -v16
    v_fma_f32 v163, v163, s72, -v16
    v_fma_f32 v164, v164, s72, -v16
    v_fma_f32 v165, v165, s72, -v16
    v_fma_f32 v166, v166, s72, -v16
    v_fma_f32 v167, v167, s72, -v16
    v_exp_f32 v152, v152
    v_exp_f32 v153, v153
    v_exp_f32 v154, v154
    v_exp_f32 v155, v155
    v_exp_f32 v156, v156
    v_exp_f32 v157, v157
    v_exp_f32 v158, v158
    v_exp_f32 v159, v159
    v_exp_f32 v160, v160
    v_exp_f32 v161, v161
    v_exp_f32 v162, v162
    v_exp_f32 v163, v163
    v_exp_f32 v164, v164
    v_exp_f32 v165, v165
    v_exp_f32 v166, v166
    v_exp_f32 v167, v167
    v_cvt_pk_bf16_f32 v152, v152, v153
    v_cvt_pk_bf16_f32 v153, v154, v155
    v_cvt_pk_bf16_f32 v154, v156, v157
    v_cvt_pk_bf16_f32 v155, v158, v159
    v_cvt_pk_bf16_f32 v156, v160, v161
    v_cvt_pk_bf16_f32 v157, v162, v163
    v_cvt_pk_bf16_f32 v158, v164, v165
    v_cvt_pk_bf16_f32 v159, v166, v167
    s_waitcnt lgkmcnt(5)
    v_mfma_f32_32x32x16_bf16 v[200:215], v[236:239], v[152:155], v[200:215]
    s_waitcnt lgkmcnt(4)
    v_mfma_f32_32x32x16_bf16 v[200:215], v[240:243], v[156:159], v[200:215]
    v_fma_f32 v168, v168, s72, -v16
    v_fma_f32 v169, v169, s72, -v16
    v_fma_f32 v170, v170, s72, -v16
    v_fma_f32 v171, v171, s72, -v16
    v_fma_f32 v172, v172, s72, -v16
    v_fma_f32 v173, v173, s72, -v16
    v_fma_f32 v174, v174, s72, -v16
    v_fma_f32 v175, v175, s72, -v16
    v_fma_f32 v176, v176, s72, -v16
    v_fma_f32 v177, v177, s72, -v16
    v_fma_f32 v178, v178, s72, -v16
    v_fma_f32 v179, v179, s72, -v16
    v_fma_f32 v180, v180, s72, -v16
    v_fma_f32 v181, v181, s72, -v16
    v_fma_f32 v182, v182, s72, -v16
    v_fma_f32 v183, v183, s72, -v16
    v_exp_f32 v168, v168
    v_exp_f32 v169, v169
    v_exp_f32 v170, v170
    v_exp_f32 v171, v171
    v_exp_f32 v172, v172
    v_exp_f32 v173, v173
    v_exp_f32 v174, v174
    v_exp_f32 v175, v175
    v_exp_f32 v176, v176
    v_exp_f32 v177, v177
    v_exp_f32 v178, v178
    v_exp_f32 v179, v179
    v_exp_f32 v180, v180
    v_exp_f32 v181, v181
    v_exp_f32 v182, v182
    v_exp_f32 v183, v183
    v_cvt_pk_bf16_f32 v168, v168, v169
    v_cvt_pk_bf16_f32 v169, v170, v171
    v_cvt_pk_bf16_f32 v170, v172, v173
    v_cvt_pk_bf16_f32 v171, v174, v175
    v_cvt_pk_bf16_f32 v172, v176, v177
    v_cvt_pk_bf16_f32 v173, v178, v179
    v_cvt_pk_bf16_f32 v174, v180, v181
    v_cvt_pk_bf16_f32 v175, v182, v183
    s_waitcnt lgkmcnt(3)
    v_mfma_f32_32x32x16_bf16 v[200:215], v[244:247], v[168:171], v[200:215]
    s_waitcnt lgkmcnt(2)
    v_mfma_f32_32x32x16_bf16 v[200:215], v[248:251], v[172:175], v[200:215]
    v_fma_f32 v184, v184, s72, -v16
    v_fma_f32 v185, v185, s72, -v16
    v_fma_f32 v186, v186, s72, -v16
    v_fma_f32 v187, v187, s72, -v16
    v_fma_f32 v188, v188, s72, -v16
    v_fma_f32 v189, v189, s72, -v16
    v_fma_f32 v190, v190, s72, -v16
    v_fma_f32 v191, v191, s72, -v16
    v_fma_f32 v192, v192, s72, -v16
    v_fma_f32 v193, v193, s72, -v16
    v_fma_f32 v194, v194, s72, -v16
    v_fma_f32 v195, v195, s72, -v16
    v_fma_f32 v196, v196, s72, -v16
    v_fma_f32 v197, v197, s72, -v16
    v_fma_f32 v198, v198, s72, -v16
    v_fma_f32 v199, v199, s72, -v16
    v_exp_f32 v184, v184
    v_exp_f32 v185, v185
    v_exp_f32 v186, v186
    v_exp_f32 v187, v187
    v_exp_f32 v188, v188
    v_exp_f32 v189, v189
    v_exp_f32 v190, v190
    v_exp_f32 v191, v191
    v_exp_f32 v192, v192
    v_exp_f32 v193, v193
    v_exp_f32 v194, v194
    v_exp_f32 v195, v195
    v_exp_f32 v196, v196
    v_exp_f32 v197, v197
    v_exp_f32 v198, v198
    v_exp_f32 v199, v199
    v_cvt_pk_bf16_f32 v184, v184, v185
    v_cvt_pk_bf16_f32 v185, v186, v187
    v_cvt_pk_bf16_f32 v186, v188, v189
    v_cvt_pk_bf16_f32 v187, v190, v191
    v_cvt_pk_bf16_f32 v188, v192, v193
    v_cvt_pk_bf16_f32 v189, v194, v195
    v_cvt_pk_bf16_f32 v190, v196, v197
    v_cvt_pk_bf16_f32 v191, v198, v199
    s_waitcnt lgkmcnt(1)
    v_mfma_f32_32x32x16_bf16 v[200:215], v[220:223], v[184:187], v[200:215]
    s_waitcnt lgkmcnt(0)
    v_mfma_f32_32x32x16_bf16 v[200:215], v[224:227], v[188:191], v[200:215]
    v_sub_f32 v15, 1.0, v17
    s_lshl_b32 s60, s65, 10
    s_add_u32 s60, s60, s73
    s_lshl_b32 s61, s65, 7
    s_add_u32 s61, s61, s74
    s_nop 6
    v_rcp_f32 v14, v208
    s_nop 0
    v_mul_f32 v14, v14, v15
    v_mul_f32 v200, v200, v14
    v_mul_f32 v201, v201, v14
    v_mul_f32 v202, v202, v14
    v_mul_f32 v203, v203, v14
    v_mul_f32 v204, v204, v14
    v_mul_f32 v205, v205, v14
    v_mul_f32 v206, v206, v14
    v_mul_f32 v207, v207, v14
    v_cvt_pk_bf16_f32 v208, v200, v201
    v_cvt_pk_bf16_f32 v209, v202, v203
    v_cvt_pk_bf16_f32 v210, v204, v205
    v_cvt_pk_bf16_f32 v211, v206, v207
    v_lshlrev_b32 v14, 2, v0
    s_waitcnt vmcnt(0)
    buffer_store_dwordx4 v[208:211], v1, s[48:51], s60 offen sc1
    s_mov_b64 exec, 0xffffffff
    buffer_store_dword v17, v14, s[48:51], s61 offen sc1
    s_mov_b64 exec, -1
    s_add_u32 s71, s71, 4
    s_branch L_B_NEXT
.p2align 5
L_B_SKIP:
    s_waitcnt vmcnt(0)
L_B_NEXT:
    s_add_u32 s65, s65, 4
    s_add_u32 s68, s68, 131072
    s_add_u32 s63, s63, 1
    s_cmp_lt_u32 s63, s64
    s_cbranch_scc1 L_B_LOOP
    s_waitcnt vmcnt(0)
    s_barrier
    v_mov_b32 v14, s71
    v_mov_b32 v15, 0
    s_mov_b64 exec, 1
    buffer_store_dword v14, v15, s[48:51], s70 offen sc1
    s_mov_b64 exec, -1
    s_cmp_eq_u32 s54, 0
    s_cbranch_scc1 L_B2KM
    s_endpgm
.p2align 5
L_B2KM:
    s_branch L_ROLE_KM
.p2align 5
L_ROLE_R:
    v_lshlrev_b32 v1, 4, v0
    v_mov_b32 v20, 0x7f817f81
    s_mov_b32 s76, 0x00ff00ff
    s_mov_b32 s77, 0x00ff00ff
    s_mov_b32 s80, 0x33333333
    s_mov_b32 s81, 0x33333333
    s_lshl_b32 s89, s52, 11
    s_lshl_b32 s90, s52, 10
    s_and_b32 s3, s52, 1
    s_lshl_b32 s91, s3, 12
    s_lshl_b32 s60, s52, 12
    v_bfe_u32 v24, v0, 0, 4
    v_mul_u32_u24 v24, 16, v24
    v_bfe_u32 v14, v0, 4, 2
    v_mul_u32_u24 v14, 8192, v14
    v_add_u32 v24, v24, v14
    v_bfe_u32 v26, v0, 0, 4
    v_mul_u32_u24 v26, 16, v26
    v_bfe_u32 v14, v0, 4, 2
    v_mul_u32_u24 v14, 1024, v14
    v_add_u32 v26, v26, v14
    v_lshlrev_b32 v14, 1, v0
    v_and_b32 v14, 32, v14
    v_xor_b32 v24, v24, v14
    v_lshlrev_b32 v14, 1, v14
    v_xor_b32 v26, v26, v14
    v_xor_b32 v124, 0, v24
    v_xor_b32 v30, 0, v26
    v_xor_b32 v125, 64, v24
    v_xor_b32 v30, 0, v26
    v_xor_b32 v126, 128, v24
    v_xor_b32 v31, 128, v26
    v_xor_b32 v127, 192, v24
    v_xor_b32 v31, 128, v26
    v_bfe_u32 v25, v0, 0, 2
    v_mul_u32_u24 v25, 8, v25
    v_bfe_u32 v14, v0, 2, 1
    v_mul_u32_u24 v14, 288, v14
    v_add_u32 v25, v25, v14
    v_bfe_u32 v14, v0, 3, 1
    v_mul_u32_u24 v14, 2176, v14
    v_add_u32 v25, v25, v14
    v_bfe_u32 v14, v0, 4, 1
    v_mul_u32_u24 v14, 1088, v14
    v_add_u32 v25, v25, v14
    v_bfe_u32 v14, v0, 5, 1
    v_mul_u32_u24 v14, 4096, v14
    v_add_u32 v25, v25, v14
    s_lshl_b32 s3, s52, 6
    v_xor_b32 v25, s3, v25
    v_bfe_u32 v27, v0, 0, 2
    v_mul_u32_u24 v27, 8, v27
    v_bfe_u32 v14, v0, 2, 1
    v_mul_u32_u24 v14, 320, v14
    v_add_u32 v27, v27, v14
    v_bfe_u32 v14, v0, 3, 1
    v_mul_u32_u24 v14, 32, v14
    v_add_u32 v27, v27, v14
    v_bfe_u32 v14, v0, 4, 1
    v_mul_u32_u24 v14, 2176, v14
    v_add_u32 v27, v27, v14
    v_bfe_u32 v14, v0, 5, 1
    v_mul_u32_u24 v14, 1024, v14
    v_add_u32 v27, v27, v14
    v_add_u32 v27, s60, v27
    v_add_u32 v2, s60, v1
    v_add_u32 v23, 0x10000, v2
    s_lshl_b32 s63, s53, 8
    s_lshl_b32 s3, s52, 17
    s_add_u32 s63, s63, s3
    s_lshl_b32 s74, s53, 17
    s_lshl_b32 s3, s52, 8
    s_add_u32 s74, s74, s3
    s_xor_b32 s3, s52, 0
    s_lshl_b32 s3, s3, 15
    s_add_u32 s96, s74, s3
    s_xor_b32 s3, s52, 1
    s_lshl_b32 s3, s3, 15
    s_add_u32 s97, s74, s3
    s_xor_b32 s3, s52, 2
    s_lshl_b32 s3, s3, 15
    s_add_u32 s98, s74, s3
    s_xor_b32 s3, s52, 3
    s_lshl_b32 s3, s3, 15
    s_add_u32 s99, s74, s3
    s_mov_b32 s93, 0
    v_lshrrev_b32 v112, 2, v1
    s_lshl_b32 s73, s53, 7
    s_add_u32 s73, s73, 0
    v_lshlrev_b32 v114, 8, v1
    v_and_b32 v114, 0x3fff, v114
    s_cmp_lg_u32 s52, 3
    s_cbranch_scc1 L_R_W3_15
    v_mov_b32 v115, 0
    s_mov_b64 exec, 15
    buffer_store_dword v115, v114, s[48:51], s73 offen sc1
    s_mov_b64 exec, -1
L_R_W3_15:
    s_add_u32 m0, s60, 98304
    s_add_u32 s62, s63, 0
    buffer_load_dwordx4 v124, s[20:23], s62 offen lds
    s_add_u32 m0, s60, 99328
    s_add_u32 s62, s63, 32768
    buffer_load_dwordx4 v125, s[20:23], s62 offen lds
    s_add_u32 m0, s60, 100352
    s_add_u32 s62, s63, 65536
    buffer_load_dwordx4 v126, s[20:23], s62 offen lds
    s_add_u32 m0, s60, 101376
    s_add_u32 s62, s63, 98304
    buffer_load_dwordx4 v127, s[20:23], s62 offen lds
    s_add_u32 m0, s60, 114688
    s_add_u32 s62, s63, 1048576
    buffer_load_dwordx4 v124, s[20:23], s62 offen lds
    s_add_u32 m0, s60, 115712
    s_add_u32 s62, s63, 1081344
    buffer_load_dwordx4 v125, s[20:23], s62 offen lds
    s_add_u32 m0, s60, 116736
    s_add_u32 s62, s63, 1114112
    buffer_load_dwordx4 v126, s[20:23], s62 offen lds
    s_add_u32 m0, s60, 117760
    s_add_u32 s62, s63, 1146880
    buffer_load_dwordx4 v127, s[20:23], s62 offen lds
    s_add_u32 m0, s60, 131072
    s_add_u32 s62, s63, 2097152
    buffer_load_dwordx4 v124, s[20:23], s62 offen lds
    s_add_u32 m0, s60, 132096
    s_add_u32 s62, s63, 2129920
    buffer_load_dwordx4 v125, s[20:23], s62 offen lds
    s_add_u32 m0, s60, 133120
    s_add_u32 s62, s63, 2162688
    buffer_load_dwordx4 v126, s[20:23], s62 offen lds
    s_add_u32 m0, s60, 134144
    s_add_u32 s62, s63, 2195456
    buffer_load_dwordx4 v127, s[20:23], s62 offen lds
    s_add_u32 m0, s60, 147456
    s_add_u32 s62, s63, 3145728
    buffer_load_dwordx4 v124, s[20:23], s62 offen lds
    s_add_u32 m0, s60, 148480
    s_add_u32 s62, s63, 3178496
    buffer_load_dwordx4 v125, s[20:23], s62 offen lds
    s_add_u32 m0, s60, 149504
    s_add_u32 s62, s63, 3211264
    buffer_load_dwordx4 v126, s[20:23], s62 offen lds
    s_add_u32 m0, s60, 150528
    s_add_u32 s62, s63, 3244032
    buffer_load_dwordx4 v127, s[20:23], s62 offen lds
    s_add_u32 m0, s60, 0
    s_add_u32 s62, s63, 524288
    buffer_load_dwordx4 v124, s[20:23], s62 offen lds
    s_add_u32 m0, s60, 1024
    s_add_u32 s62, s63, 557056
    buffer_load_dwordx4 v125, s[20:23], s62 offen lds
    s_add_u32 m0, s60, 2048
    s_add_u32 s62, s63, 589824
    buffer_load_dwordx4 v126, s[20:23], s62 offen lds
    s_add_u32 m0, s60, 3072
    s_add_u32 s62, s63, 622592
    buffer_load_dwordx4 v127, s[20:23], s62 offen lds
    s_add_u32 m0, s60, 16384
    s_add_u32 s62, s63, 1572864
    buffer_load_dwordx4 v124, s[20:23], s62 offen lds
    s_add_u32 m0, s60, 17408
    s_add_u32 s62, s63, 1605632
    buffer_load_dwordx4 v125, s[20:23], s62 offen lds
    s_add_u32 m0, s60, 18432
    s_add_u32 s62, s63, 1638400
    buffer_load_dwordx4 v126, s[20:23], s62 offen lds
    s_add_u32 m0, s60, 19456
    s_add_u32 s62, s63, 1671168
    buffer_load_dwordx4 v127, s[20:23], s62 offen lds
    s_add_u32 m0, s60, 32768
    s_add_u32 s62, s63, 2621440
    buffer_load_dwordx4 v124, s[20:23], s62 offen lds
    s_add_u32 m0, s60, 33792
    s_add_u32 s62, s63, 2654208
    buffer_load_dwordx4 v125, s[20:23], s62 offen lds
    s_add_u32 m0, s60, 34816
    s_add_u32 s62, s63, 2686976
    buffer_load_dwordx4 v126, s[20:23], s62 offen lds
    s_add_u32 m0, s60, 35840
    s_add_u32 s62, s63, 2719744
    buffer_load_dwordx4 v127, s[20:23], s62 offen lds
    s_add_u32 m0, s60, 49152
    s_add_u32 s62, s63, 3670016
    buffer_load_dwordx4 v124, s[20:23], s62 offen lds
    s_add_u32 m0, s60, 50176
    s_add_u32 s62, s63, 3702784
    buffer_load_dwordx4 v125, s[20:23], s62 offen lds
    s_add_u32 m0, s60, 51200
    s_add_u32 s62, s63, 3735552
    buffer_load_dwordx4 v126, s[20:23], s62 offen lds
    s_add_u32 m0, s60, 52224
    s_add_u32 s62, s63, 3768320
    buffer_load_dwordx4 v127, s[20:23], s62 offen lds
    s_add_u32 m0, s60, 65536
    s_add_u32 s62, s96, 0
    buffer_load_dwordx4 v30, s[24:27], s62 offen lds
    s_add_u32 m0, s60, 66560
    s_add_u32 s62, s96, 4096
    buffer_load_dwordx4 v30, s[24:27], s62 offen lds
    s_add_u32 m0, s60, 67584
    s_add_u32 s62, s96, 16384
    buffer_load_dwordx4 v31, s[24:27], s62 offen lds
    s_add_u32 m0, s60, 68608
    s_add_u32 s62, s96, 20480
    buffer_load_dwordx4 v31, s[24:27], s62 offen lds
    s_add_u32 m0, s60, 81920
    s_add_u32 s62, s96, 8192
    buffer_load_dwordx4 v30, s[24:27], s62 offen lds
    s_add_u32 m0, s60, 82944
    s_add_u32 s62, s96, 12288
    buffer_load_dwordx4 v30, s[24:27], s62 offen lds
    s_add_u32 m0, s60, 83968
    s_add_u32 s62, s96, 24576
    buffer_load_dwordx4 v31, s[24:27], s62 offen lds
    s_add_u32 m0, s60, 84992
    s_add_u32 s62, s96, 28672
    buffer_load_dwordx4 v31, s[24:27], s62 offen lds
    s_waitcnt vmcnt(36)
    s_barrier
    v_add_u32 v28, 98304, v25
    ds_read_b64_tr_b16 a[96:97], v28 offset:0
    ds_read_b64_tr_b16 a[98:99], v28 offset:512
    ds_read_b64_tr_b16 a[100:101], v28 offset:8192
    ds_read_b64_tr_b16 a[102:103], v28 offset:8704
    v_xor_b32 v28, 32, v28
    ds_read_b64_tr_b16 a[104:105], v28 offset:0
    ds_read_b64_tr_b16 a[106:107], v28 offset:512
    ds_read_b64_tr_b16 a[108:109], v28 offset:8192
    ds_read_b64_tr_b16 a[110:111], v28 offset:8704
    s_waitcnt lgkmcnt(0)
    s_waitcnt vmcnt(32)
    s_barrier
    s_cmp_lg_u32 s52, 3
    s_cbranch_scc1 L_SIG_16
    s_mov_b64 exec, 1
    v_mov_b32 v14, 48
    v_mov_b32 v15, 1
    buffer_atomic_add v15, v14, s[44:47], 0 offen
    s_mov_b64 exec, -1
L_SIG_16:
    v_mov_b32 v116, 0
    v_mov_b32 v117, 0
    v_mov_b32 v118, 0
    v_mov_b32 v119, 0
    v_mov_b32 v120, 0x7f817f81
    v_mov_b32 v121, 0x7f817f81
    v_mov_b32 v122, 0x7f817f81
    v_mov_b32 v123, 0x7f817f81
    s_lshl_b32 s61, s53, 13
    s_add_u32 s61, s61, s89
    s_add_u32 s72, s61, 524288
    buffer_store_dwordx4 v[116:119], v1, s[48:51], s72 offen offset:0 sc1
    buffer_store_dwordx4 v[116:119], v1, s[48:51], s72 offen offset:1024 sc1
    s_lshl_b32 s61, s61, 1
    s_add_u32 s72, s61, 4202496
    buffer_store_dwordx4 v[120:123], v1, s[48:51], s72 offen offset:0 sc1
    buffer_store_dwordx4 v[120:123], v1, s[48:51], s72 offen offset:1024 sc1
    buffer_store_dwordx4 v[120:123], v1, s[48:51], s72 offen offset:2048 sc1
    buffer_store_dwordx4 v[120:123], v1, s[48:51], s72 offen offset:3072 sc1
    v_bfe_u32 v11, v0, 0, 3
    v_mul_u32_u24 v11, 16, v11
    v_bfe_u32 v14, v0, 4, 1
    v_mul_u32_u24 v14, 8, v14
    v_add_u32 v11, v11, v14
    v_bfe_u32 v14, v0, 5, 1
    v_mul_u32_u24 v14, 4, v14
    v_add_u32 v11, v11, v14
    s_lshl_b32 s3, s53, 7
    s_add_u32 s3, s3, s91
    v_add_u32 v11, s3, v11
    s_cmp_ge_u32 s52, 2
    s_cbranch_scc1 L_R_NOINIT
    v_bfe_u32 v15, v0, 0, 1
    v_mul_u32_u24 v15, 1024, v15
    v_bfe_u32 v14, v0, 1, 2
    v_mul_u32_u24 v14, 32, v14
    v_add_u32 v15, v15, v14
    v_bfe_u32 v14, v0, 4, 1
    v_mul_u32_u24 v14, 8, v14
    v_add_u32 v15, v15, v14
    v_bfe_u32 v14, v0, 5, 1
    v_mul_u32_u24 v14, 4, v14
    v_add_u32 v15, v15, v14
    s_bfe_u32 s3, s53, 0x20001
    s_lshl_b32 s61, s3, 11
    s_lshr_b32 s3, s53, 3
    s_lshl_b32 s3, s3, 8
    s_add_u32 s61, s61, s3
    s_and_b32 s3, s53, 1
    s_lshl_b32 s3, s3, 4
    s_add_u32 s61, s61, s3
    s_lshl_b32 s3, s52, 7
    s_add_u32 s61, s61, s3
    buffer_load_dword v29, v15, s[8:11], s61 offen
    s_mov_b64 exec, s[76:77]
    s_mov_b32 s61, 73728
    s_mov_b32 s72, 81920
    s_mov_b32 s71, 65536
    buffer_store_dword v20, v11, s[48:51], s61 offen sc1
    buffer_store_dword v20, v11, s[48:51], s72 offen sc1
    s_mov_b64 exec, -1
L_R_NOINIT:
    s_add_u32 m0, s60, 98304
    s_add_u32 s62, s97, 0
    buffer_load_dwordx4 v30, s[24:27], s62 offen lds
    s_add_u32 m0, s60, 99328
    s_add_u32 s62, s97, 4096
    buffer_load_dwordx4 v30, s[24:27], s62 offen lds
    s_add_u32 m0, s60, 100352
    s_add_u32 s62, s97, 16384
    buffer_load_dwordx4 v31, s[24:27], s62 offen lds
    s_add_u32 m0, s60, 101376
    s_add_u32 s62, s97, 20480
    buffer_load_dwordx4 v31, s[24:27], s62 offen lds
    v_add_u32 v28, 114688, v25
    ds_read_b64_tr_b16 a[112:113], v28 offset:0
    ds_read_b64_tr_b16 a[114:115], v28 offset:512
    ds_read_b64_tr_b16 a[116:117], v28 offset:8192
    ds_read_b64_tr_b16 a[118:119], v28 offset:8704
    v_xor_b32 v28, 32, v28
    ds_read_b64_tr_b16 a[120:121], v28 offset:0
    ds_read_b64_tr_b16 a[122:123], v28 offset:512
    ds_read_b64_tr_b16 a[124:125], v28 offset:8192
    ds_read_b64_tr_b16 a[126:127], v28 offset:8704
    s_waitcnt lgkmcnt(0)
    s_waitcnt vmcnt(32)
    s_barrier
    s_add_u32 m0, s60, 114688
    s_add_u32 s62, s97, 8192
    buffer_load_dwordx4 v30, s[24:27], s62 offen lds
    s_add_u32 m0, s60, 115712
    s_add_u32 s62, s97, 12288
    buffer_load_dwordx4 v30, s[24:27], s62 offen lds
    s_add_u32 m0, s60, 116736
    s_add_u32 s62, s97, 24576
    buffer_load_dwordx4 v31, s[24:27], s62 offen lds
    s_add_u32 m0, s60, 117760
    s_add_u32 s62, s97, 28672
    buffer_load_dwordx4 v31, s[24:27], s62 offen lds
    v_add_u32 v28, 131072, v25
    ds_read_b64_tr_b16 a[128:129], v28 offset:0
    ds_read_b64_tr_b16 a[130:131], v28 offset:512
    ds_read_b64_tr_b16 a[132:133], v28 offset:8192
    ds_read_b64_tr_b16 a[134:135], v28 offset:8704
    v_xor_b32 v28, 32, v28
    ds_read_b64_tr_b16 a[136:137], v28 offset:0
    ds_read_b64_tr_b16 a[138:139], v28 offset:512
    ds_read_b64_tr_b16 a[140:141], v28 offset:8192
    ds_read_b64_tr_b16 a[142:143], v28 offset:8704
    s_waitcnt lgkmcnt(0)
    s_waitcnt vmcnt(32)
    s_barrier
    v_lshrrev_b32 v14, 3, v1
    v_and_b32 v14, 0x60, v14
    v_xor_b32 v3, v1, v14
    v_add_u32 v3, 131072, v3
    v_bfe_u32 v4, v0, 0, 4
    v_mul_u32_u24 v4, 16, v4
    v_bfe_u32 v14, v0, 4, 2
    v_mul_u32_u24 v14, 4, v14
    v_add_u32 v4, v4, v14
    v_add_u32 v4, 137216, v4
    s_lshl_b32 s3, s52, 9
    v_add_u32 v4, s3, v4
    v_bfe_u32 v5, v0, 2, 3
    v_mul_u32_u24 v5, 16, v5
    v_bfe_u32 v14, v0, 5, 1
    v_mul_u32_u24 v14, 256, v14
    v_add_u32 v5, v5, v14
    v_bfe_u32 v6, v0, 0, 4
    v_mul_u32_u24 v6, 16, v6
    v_bfe_u32 v14, v0, 4, 2
    v_mul_u32_u24 v14, 512, v14
    v_add_u32 v6, v6, v14
    v_bfe_u32 v7, v0, 0, 4
    v_mul_u32_u24 v7, 16, v7
    v_bfe_u32 v14, v0, 4, 2
    v_mul_u32_u24 v14, 512, v14
    v_add_u32 v7, v7, v14
    v_add_u32 v7, s89, v7
    v_mov_b32 v21, v6
    v_mov_b32 v22, v7
    v_bfe_u32 v8, v0, 0, 1
    v_mul_u32_u24 v8, 16, v8
    v_bfe_u32 v14, v0, 2, 4
    v_mul_u32_u24 v14, 32, v14
    v_add_u32 v8, v8, v14
    v_add_u32 v8, 135168, v8
    s_lshl_b32 s3, s52, 9
    v_add_u32 v8, s3, v8
    v_lshlrev_b32 v9, 1, v4
    v_subrev_u32 v9, 143360, v9
    v_lshlrev_b32 v14, 1, v0
    v_and_b32 v14, 0x18, v14
    v_xor_b32 v9, v9, v14
    v_bfe_u32 v10, v0, 0, 3
    v_mul_u32_u24 v10, 16, v10
    v_bfe_u32 v14, v0, 3, 3
    v_mul_u32_u24 v14, 8192, v14
    v_add_u32 v10, v10, v14
    v_bfe_u32 v13, v0, 0, 1
    v_mul_u32_u24 v13, 16, v13
    v_bfe_u32 v14, v0, 1, 2
    v_mul_u32_u24 v14, 256, v14
    v_add_u32 v13, v13, v14
    v_bfe_u32 v14, v0, 3, 3
    v_mul_u32_u24 v14, 32, v14
    v_add_u32 v13, v13, v14
    v_add_u32 v13, 131072, v13
    v_add_u32 v13, s90, v13
    v_lshrrev_b32 v14, 3, v13
    v_and_b32 v14, 0x60, v14
    v_xor_b32 v13, v13, v14
    v_mov_b32 v12, 0xeeee
    v_mov_b32 v14, 0x4444
    v_cndmask_b32 v12, v12, v14, s[80:81]
    v_and_b32 v14, 1, v0
    v_lshlrev_b32 v14, 4, v14
    v_mov_b32 v15, 0x3f80
    v_lshlrev_b32 v15, v14, v15
    v_bfe_u32 v14, v0, 1, 3
    v_cmp_eq_u32 vcc, 0, v14
    s_nop 1
    v_cndmask_b32 v16, 0, v15, vcc
    v_cmp_eq_u32 vcc, 1, v14
    s_nop 1
    v_cndmask_b32 v17, 0, v15, vcc
    v_cmp_eq_u32 vcc, 2, v14
    s_nop 1
    v_cndmask_b32 v18, 0, v15, vcc
    v_cmp_eq_u32 vcc, 3, v14
    s_nop 1
    v_cndmask_b32 v19, 0, v15, vcc
    s_mov_b32 s78, 0x3e0293ee
    s_mov_b32 s79, s78
    s_add_u32 m0, s60, 131072
    s_add_u32 s62, s98, 0
    buffer_load_dwordx4 v30, s[24:27], s62 offen lds
    s_add_u32 m0, s60, 132096
    s_add_u32 s62, s98, 4096
    buffer_load_dwordx4 v30, s[24:27], s62 offen lds
    s_add_u32 m0, s60, 133120
    s_add_u32 s62, s98, 16384
    buffer_load_dwordx4 v31, s[24:27], s62 offen lds
    s_add_u32 m0, s60, 134144
    s_add_u32 s62, s98, 20480
    buffer_load_dwordx4 v31, s[24:27], s62 offen lds
    v_add_u32 v28, 147456, v25
    ds_read_b64_tr_b16 a[144:145], v28 offset:0
    ds_read_b64_tr_b16 a[146:147], v28 offset:512
    ds_read_b64_tr_b16 a[148:149], v28 offset:8192
    ds_read_b64_tr_b16 a[150:151], v28 offset:8704
    v_xor_b32 v28, 32, v28
    ds_read_b64_tr_b16 a[152:153], v28 offset:0
    ds_read_b64_tr_b16 a[154:155], v28 offset:512
    ds_read_b64_tr_b16 a[156:157], v28 offset:8192
    ds_read_b64_tr_b16 a[158:159], v28 offset:8704
    s_waitcnt lgkmcnt(0)
    s_waitcnt vmcnt(32)
    s_barrier
    s_add_u32 m0, s60, 147456
    s_add_u32 s62, s98, 8192
    buffer_load_dwordx4 v30, s[24:27], s62 offen lds
    s_add_u32 m0, s60, 148480
    s_add_u32 s62, s98, 12288
    buffer_load_dwordx4 v30, s[24:27], s62 offen lds
    s_add_u32 m0, s60, 149504
    s_add_u32 s62, s98, 24576
    buffer_load_dwordx4 v31, s[24:27], s62 offen lds
    s_add_u32 m0, s60, 150528
    s_add_u32 s62, s98, 28672
    buffer_load_dwordx4 v31, s[24:27], s62 offen lds
    v_add_u32 v28, 0, v25
    ds_read_b64_tr_b16 a[160:161], v28 offset:0
    ds_read_b64_tr_b16 a[162:163], v28 offset:512
    ds_read_b64_tr_b16 a[164:165], v28 offset:8192
    ds_read_b64_tr_b16 a[166:167], v28 offset:8704
    v_xor_b32 v28, 32, v28
    ds_read_b64_tr_b16 a[168:169], v28 offset:0
    ds_read_b64_tr_b16 a[170:171], v28 offset:512
    ds_read_b64_tr_b16 a[172:173], v28 offset:8192
    ds_read_b64_tr_b16 a[174:175], v28 offset:8704
    s_waitcnt lgkmcnt(0)
    s_waitcnt vmcnt(32)
    s_barrier
    s_add_u32 m0, s60, 0
    s_add_u32 s62, s99, 0
    buffer_load_dwordx4 v30, s[24:27], s62 offen lds
    s_add_u32 m0, s60, 1024
    s_add_u32 s62, s99, 4096
    buffer_load_dwordx4 v30, s[24:27], s62 offen lds
    s_add_u32 m0, s60, 2048
    s_add_u32 s62, s99, 16384
    buffer_load_dwordx4 v31, s[24:27], s62 offen lds
    s_add_u32 m0, s60, 3072
    s_add_u32 s62, s99, 20480
    buffer_load_dwordx4 v31, s[24:27], s62 offen lds
    v_add_u32 v28, 16384, v25
    ds_read_b64_tr_b16 a[176:177], v28 offset:0
    ds_read_b64_tr_b16 a[178:179], v28 offset:512
    ds_read_b64_tr_b16 a[180:181], v28 offset:8192
    ds_read_b64_tr_b16 a[182:183], v28 offset:8704
    v_xor_b32 v28, 32, v28
    ds_read_b64_tr_b16 a[184:185], v28 offset:0
    ds_read_b64_tr_b16 a[186:187], v28 offset:512
    ds_read_b64_tr_b16 a[188:189], v28 offset:8192
    ds_read_b64_tr_b16 a[190:191], v28 offset:8704
    s_waitcnt lgkmcnt(0)
    s_waitcnt vmcnt(32)
    s_barrier
    s_add_u32 m0, s60, 16384
    s_add_u32 s62, s99, 8192
    buffer_load_dwordx4 v30, s[24:27], s62 offen lds
    s_add_u32 m0, s60, 17408
    s_add_u32 s62, s99, 12288
    buffer_load_dwordx4 v30, s[24:27], s62 offen lds
    s_add_u32 m0, s60, 18432
    s_add_u32 s62, s99, 24576
    buffer_load_dwordx4 v31, s[24:27], s62 offen lds
    s_add_u32 m0, s60, 19456
    s_add_u32 s62, s99, 28672
    buffer_load_dwordx4 v31, s[24:27], s62 offen lds
    v_add_u32 v28, 32768, v25
    ds_read_b64_tr_b16 a[192:193], v28 offset:0
    ds_read_b64_tr_b16 a[194:195], v28 offset:512
    ds_read_b64_tr_b16 a[196:197], v28 offset:8192
    ds_read_b64_tr_b16 a[198:199], v28 offset:8704
    v_xor_b32 v28, 32, v28
    ds_read_b64_tr_b16 a[200:201], v28 offset:0
    ds_read_b64_tr_b16 a[202:203], v28 offset:512
    ds_read_b64_tr_b16 a[204:205], v28 offset:8192
    ds_read_b64_tr_b16 a[206:207], v28 offset:8704
    s_waitcnt lgkmcnt(0)
    s_waitcnt vmcnt(32)
    s_barrier
    s_add_u32 m0, s60, 32768
    s_add_u32 s62, s63, 2097152
    buffer_load_dwordx4 v124, s[12:15], s62 offen lds
    s_add_u32 m0, s60, 33792
    s_add_u32 s62, s63, 2129920
    buffer_load_dwordx4 v125, s[12:15], s62 offen lds
    s_add_u32 m0, s60, 34816
    s_add_u32 s62, s63, 2162688
    buffer_load_dwordx4 v126, s[12:15], s62 offen lds
    s_add_u32 m0, s60, 35840
    s_add_u32 s62, s63, 2195456
    buffer_load_dwordx4 v127, s[12:15], s62 offen lds
    v_add_u32 v28, 49152, v25
    ds_read_b64_tr_b16 a[208:209], v28 offset:0
    ds_read_b64_tr_b16 a[210:211], v28 offset:512
    ds_read_b64_tr_b16 a[212:213], v28 offset:8192
    ds_read_b64_tr_b16 a[214:215], v28 offset:8704
    v_xor_b32 v28, 32, v28
    ds_read_b64_tr_b16 a[216:217], v28 offset:0
    ds_read_b64_tr_b16 a[218:219], v28 offset:512
    ds_read_b64_tr_b16 a[220:221], v28 offset:8192
    ds_read_b64_tr_b16 a[222:223], v28 offset:8704
    s_waitcnt lgkmcnt(0)
    s_waitcnt vmcnt(32)
    s_barrier
    s_add_u32 m0, s60, 49152
    s_add_u32 s62, s63, 3145728
    buffer_load_dwordx4 v124, s[12:15], s62 offen lds
    s_add_u32 m0, s60, 50176
    s_add_u32 s62, s63, 3178496
    buffer_load_dwordx4 v125, s[12:15], s62 offen lds
    s_add_u32 m0, s60, 51200
    s_add_u32 s62, s63, 3211264
    buffer_load_dwordx4 v126, s[12:15], s62 offen lds
    s_add_u32 m0, s60, 52224
    s_add_u32 s62, s63, 3244032
    buffer_load_dwordx4 v127, s[12:15], s62 offen lds
    v_add_u32 v28, 65536, v27
    ds_read_b64_tr_b16 a[0:1], v28 offset:0
    ds_read_b64_tr_b16 a[2:3], v28 offset:512
    v_xor_b32 v28, 64, v28
    ds_read_b64_tr_b16 a[32:33], v28 offset:0
    ds_read_b64_tr_b16 a[34:35], v28 offset:512
    v_xor_b32 v28, 192, v28
    ds_read_b64_tr_b16 a[64:65], v28 offset:0
    ds_read_b64_tr_b16 a[66:67], v28 offset:512
    v_xor_b32 v28, 64, v28
    ds_read_b64_tr_b16 a[88:89], v28 offset:0
    ds_read_b64_tr_b16 a[90:91], v28 offset:512
    s_waitcnt lgkmcnt(0)
    s_waitcnt vmcnt(32)
    s_barrier
    s_add_u32 m0, s60, 65536
    s_add_u32 s62, s63, 524288
    buffer_load_dwordx4 v124, s[12:15], s62 offen lds
    s_add_u32 m0, s60, 66560
    s_add_u32 s62, s63, 557056
    buffer_load_dwordx4 v125, s[12:15], s62 offen lds
    s_add_u32 m0, s60, 67584
    s_add_u32 s62, s63, 589824
    buffer_load_dwordx4 v126, s[12:15], s62 offen lds
    s_add_u32 m0, s60, 68608
    s_add_u32 s62, s63, 622592
    buffer_load_dwordx4 v127, s[12:15], s62 offen lds
    v_add_u32 v28, 81920, v27
    ds_read_b64_tr_b16 a[4:5], v28 offset:0
    ds_read_b64_tr_b16 a[6:7], v28 offset:512
    v_xor_b32 v28, 64, v28
    ds_read_b64_tr_b16 a[36:37], v28 offset:0
    ds_read_b64_tr_b16 a[38:39], v28 offset:512
    v_xor_b32 v28, 192, v28
    ds_read_b64_tr_b16 a[68:69], v28 offset:0
    ds_read_b64_tr_b16 a[70:71], v28 offset:512
    v_xor_b32 v28, 64, v28
    ds_read_b64_tr_b16 a[92:93], v28 offset:0
    ds_read_b64_tr_b16 a[94:95], v28 offset:512
    s_waitcnt lgkmcnt(0)
    s_waitcnt vmcnt(32)
    s_barrier
    s_add_u32 m0, s60, 81920
    s_add_u32 s62, s63, 1572864
    buffer_load_dwordx4 v124, s[12:15], s62 offen lds
    s_add_u32 m0, s60, 82944
    s_add_u32 s62, s63, 1605632
    buffer_load_dwordx4 v125, s[12:15], s62 offen lds
    s_add_u32 m0, s60, 83968
    s_add_u32 s62, s63, 1638400
    buffer_load_dwordx4 v126, s[12:15], s62 offen lds
    s_add_u32 m0, s60, 84992
    s_add_u32 s62, s63, 1671168
    buffer_load_dwordx4 v127, s[12:15], s62 offen lds
    v_add_u32 v28, 98304, v27
    ds_read_b64_tr_b16 a[8:9], v28 offset:0
    ds_read_b64_tr_b16 a[10:11], v28 offset:512
    v_xor_b32 v28, 64, v28
    ds_read_b64_tr_b16 a[40:41], v28 offset:0
    ds_read_b64_tr_b16 a[42:43], v28 offset:512
    v_xor_b32 v28, 192, v28
    ds_read_b64_tr_b16 a[72:73], v28 offset:0
    ds_read_b64_tr_b16 a[74:75], v28 offset:512
    v_xor_b32 v28, 64, v28
    ds_read_b64_tr_b16 v[56:57], v28 offset:0
    ds_read_b64_tr_b16 v[58:59], v28 offset:512
    s_waitcnt lgkmcnt(0)
    s_waitcnt vmcnt(32)
    s_barrier
    s_add_u32 m0, s60, 98304
    s_add_u32 s62, s63, 2621440
    buffer_load_dwordx4 v124, s[12:15], s62 offen lds
    s_add_u32 m0, s60, 99328
    s_add_u32 s62, s63, 2654208
    buffer_load_dwordx4 v125, s[12:15], s62 offen lds
    s_add_u32 m0, s60, 100352
    s_add_u32 s62, s63, 2686976
    buffer_load_dwordx4 v126, s[12:15], s62 offen lds
    s_add_u32 m0, s60, 101376
    s_add_u32 s62, s63, 2719744
    buffer_load_dwordx4 v127, s[12:15], s62 offen lds
    v_add_u32 v28, 114688, v27
    ds_read_b64_tr_b16 a[12:13], v28 offset:0
    ds_read_b64_tr_b16 a[14:15], v28 offset:512
    v_xor_b32 v28, 64, v28
    ds_read_b64_tr_b16 a[44:45], v28 offset:0
    ds_read_b64_tr_b16 a[46:47], v28 offset:512
    v_xor_b32 v28, 192, v28
    ds_read_b64_tr_b16 a[76:77], v28 offset:0
    ds_read_b64_tr_b16 a[78:79], v28 offset:512
    v_xor_b32 v28, 64, v28
    ds_read_b64_tr_b16 v[60:61], v28 offset:0
    ds_read_b64_tr_b16 v[62:63], v28 offset:512
    s_waitcnt lgkmcnt(0)
    s_waitcnt vmcnt(32)
    s_barrier
    s_cmp_ge_u32 s52, 2
    s_cbranch_scc1 L_R_NOINIT2
    s_mov_b64 exec, s[76:77]
    s_mov_b32 s71, 65536
    buffer_store_dword v29, v11, s[48:51], s71 offen sc1
    s_mov_b32 s71, 4194304
    buffer_store_dword v29, v11, s[48:51], s71 offen sc1
    s_mov_b64 exec, -1
L_R_NOINIT2:
    s_add_u32 m0, s60, 114688
    s_add_u32 s62, s63, 3670016
    buffer_load_dwordx4 v124, s[12:15], s62 offen lds
    s_add_u32 m0, s60, 115712
    s_add_u32 s62, s63, 3702784
    buffer_load_dwordx4 v125, s[12:15], s62 offen lds
    s_add_u32 m0, s60, 116736
    s_add_u32 s62, s63, 3735552
    buffer_load_dwordx4 v126, s[12:15], s62 offen lds
    s_add_u32 m0, s60, 117760
    s_add_u32 s62, s63, 3768320
    buffer_load_dwordx4 v127, s[12:15], s62 offen lds
    v_add_u32 v28, 131072, v27
    ds_read_b64_tr_b16 a[16:17], v28 offset:0
    ds_read_b64_tr_b16 a[18:19], v28 offset:512
    v_xor_b32 v28, 64, v28
    ds_read_b64_tr_b16 a[48:49], v28 offset:0
    ds_read_b64_tr_b16 a[50:51], v28 offset:512
    v_xor_b32 v28, 192, v28
    ds_read_b64_tr_b16 a[80:81], v28 offset:0
    ds_read_b64_tr_b16 a[82:83], v28 offset:512
    v_xor_b32 v28, 64, v28
    ds_read_b64_tr_b16 v[64:65], v28 offset:0
    ds_read_b64_tr_b16 v[66:67], v28 offset:512
    s_waitcnt lgkmcnt(0)
    s_waitcnt vmcnt(32)
    s_barrier
    s_add_u32 m0, s60, 131072
    s_add_u32 s62, s63, 0
    buffer_load_dwordx4 v124, s[16:19], s62 offen lds
    s_add_u32 m0, s60, 132096
    s_add_u32 s62, s63, 32768
    buffer_load_dwordx4 v125, s[16:19], s62 offen lds
    s_add_u32 m0, s60, 133120
    s_add_u32 s62, s63, 65536
    buffer_load_dwordx4 v126, s[16:19], s62 offen lds
    s_add_u32 m0, s60, 134144
    s_add_u32 s62, s63, 98304
    buffer_load_dwordx4 v127, s[16:19], s62 offen lds
    v_add_u32 v28, 147456, v27
    ds_read_b64_tr_b16 a[20:21], v28 offset:0
    ds_read_b64_tr_b16 a[22:23], v28 offset:512
    v_xor_b32 v28, 64, v28
    ds_read_b64_tr_b16 a[52:53], v28 offset:0
    ds_read_b64_tr_b16 a[54:55], v28 offset:512
    v_xor_b32 v28, 192, v28
    ds_read_b64_tr_b16 a[84:85], v28 offset:0
    ds_read_b64_tr_b16 a[86:87], v28 offset:512
    v_xor_b32 v28, 64, v28
    ds_read_b64_tr_b16 v[68:69], v28 offset:0
    ds_read_b64_tr_b16 v[70:71], v28 offset:512
    s_waitcnt lgkmcnt(0)
    s_waitcnt vmcnt(32)
    s_barrier
    s_add_u32 m0, s60, 147456
    s_add_u32 s62, s63, 1048576
    buffer_load_dwordx4 v124, s[16:19], s62 offen lds
    s_add_u32 m0, s60, 148480
    s_add_u32 s62, s63, 1081344
    buffer_load_dwordx4 v125, s[16:19], s62 offen lds
    s_add_u32 m0, s60, 149504
    s_add_u32 s62, s63, 1114112
    buffer_load_dwordx4 v126, s[16:19], s62 offen lds
    s_add_u32 m0, s60, 150528
    s_add_u32 s62, s63, 1146880
    buffer_load_dwordx4 v127, s[16:19], s62 offen lds
    v_add_u32 v28, 0, v27
    ds_read_b64_tr_b16 a[24:25], v28 offset:0
    ds_read_b64_tr_b16 a[26:27], v28 offset:512
    v_xor_b32 v28, 64, v28
    ds_read_b64_tr_b16 a[56:57], v28 offset:0
    ds_read_b64_tr_b16 a[58:59], v28 offset:512
    v_xor_b32 v28, 192, v28
    ds_read_b64_tr_b16 v[48:49], v28 offset:0
    ds_read_b64_tr_b16 v[50:51], v28 offset:512
    v_xor_b32 v28, 64, v28
    ds_read_b64_tr_b16 v[72:73], v28 offset:0
    ds_read_b64_tr_b16 v[74:75], v28 offset:512
    s_waitcnt lgkmcnt(0)
    s_waitcnt vmcnt(32)
    s_barrier
    s_add_u32 m0, s60, 0
    s_add_u32 s62, s63, 2621440
    buffer_load_dwordx4 v124, s[16:19], s62 offen lds
    s_add_u32 m0, s60, 1024
    s_add_u32 s62, s63, 2654208
    buffer_load_dwordx4 v125, s[16:19], s62 offen lds
    s_add_u32 m0, s60, 2048
    s_add_u32 s62, s63, 2686976
    buffer_load_dwordx4 v126, s[16:19], s62 offen lds
    s_add_u32 m0, s60, 3072
    s_add_u32 s62, s63, 2719744
    buffer_load_dwordx4 v127, s[16:19], s62 offen lds
    v_add_u32 v28, 16384, v27
    ds_read_b64_tr_b16 a[28:29], v28 offset:0
    ds_read_b64_tr_b16 a[30:31], v28 offset:512
    v_xor_b32 v28, 64, v28
    ds_read_b64_tr_b16 a[60:61], v28 offset:0
    ds_read_b64_tr_b16 a[62:63], v28 offset:512
    v_xor_b32 v28, 192, v28
    ds_read_b64_tr_b16 v[52:53], v28 offset:0
    ds_read_b64_tr_b16 v[54:55], v28 offset:512
    v_xor_b32 v28, 64, v28
    ds_read_b64_tr_b16 v[76:77], v28 offset:0
    ds_read_b64_tr_b16 v[78:79], v28 offset:512
    s_waitcnt lgkmcnt(0)
    s_waitcnt vmcnt(32)
    s_barrier
    s_add_u32 m0, s60, 16384
    s_add_u32 s62, s63, 3670016
    buffer_load_dwordx4 v124, s[16:19], s62 offen lds
    s_add_u32 m0, s60, 17408
    s_add_u32 s62, s63, 3702784
    buffer_load_dwordx4 v125, s[16:19], s62 offen lds
    s_add_u32 m0, s60, 18432
    s_add_u32 s62, s63, 3735552
    buffer_load_dwordx4 v126, s[16:19], s62 offen lds
    s_add_u32 m0, s60, 19456
    s_add_u32 s62, s63, 3768320
    buffer_load_dwordx4 v127, s[16:19], s62 offen lds
    v_add_u32 v28, 32768, v25
    ds_read_b64_tr_b16 a[224:225], v28 offset:0
    ds_read_b64_tr_b16 a[226:227], v28 offset:512
    ds_read_b64_tr_b16 a[228:229], v28 offset:8192
    ds_read_b64_tr_b16 a[230:231], v28 offset:8704
    v_xor_b32 v28, 32, v28
    ds_read_b64_tr_b16 a[232:233], v28 offset:0
    ds_read_b64_tr_b16 a[234:235], v28 offset:512
    ds_read_b64_tr_b16 a[236:237], v28 offset:8192
    ds_read_b64_tr_b16 a[238:239], v28 offset:8704
    s_waitcnt lgkmcnt(0)
    s_waitcnt vmcnt(32)
    s_barrier
    s_add_u32 m0, s60, 32768
    s_add_u32 s62, s63, 0
    buffer_load_dwordx4 v124, s[12:15], s62 offen lds
    s_add_u32 m0, s60, 33792
    s_add_u32 s62, s63, 32768
    buffer_load_dwordx4 v125, s[12:15], s62 offen lds
    s_add_u32 m0, s60, 34816
    s_add_u32 s62, s63, 65536
    buffer_load_dwordx4 v126, s[12:15], s62 offen lds
    s_add_u32 m0, s60, 35840
    s_add_u32 s62, s63, 98304
    buffer_load_dwordx4 v127, s[12:15], s62 offen lds
    v_add_u32 v28, 49152, v25
    ds_read_b64_tr_b16 a[240:241], v28 offset:0
    ds_read_b64_tr_b16 a[242:243], v28 offset:512
    ds_read_b64_tr_b16 a[244:245], v28 offset:8192
    ds_read_b64_tr_b16 a[246:247], v28 offset:8704
    v_xor_b32 v28, 32, v28
    ds_read_b64_tr_b16 a[248:249], v28 offset:0
    ds_read_b64_tr_b16 a[250:251], v28 offset:512
    ds_read_b64_tr_b16 a[252:253], v28 offset:8192
    ds_read_b64_tr_b16 a[254:255], v28 offset:8704
    s_waitcnt lgkmcnt(0)
    s_waitcnt vmcnt(32)
    s_barrier
    s_add_u32 m0, s60, 49152
    s_add_u32 s62, s63, 1048576
    buffer_load_dwordx4 v124, s[12:15], s62 offen lds
    s_add_u32 m0, s60, 50176
    s_add_u32 s62, s63, 1081344
    buffer_load_dwordx4 v125, s[12:15], s62 offen lds
    s_add_u32 m0, s60, 51200
    s_add_u32 s62, s63, 1114112
    buffer_load_dwordx4 v126, s[12:15], s62 offen lds
    s_add_u32 m0, s60, 52224
    s_add_u32 s62, s63, 1146880
    buffer_load_dwordx4 v127, s[12:15], s62 offen lds
    v_add_u32 v28, 65536, v25
    ds_read_b64_tr_b16 v[128:129], v28 offset:0
    ds_read_b64_tr_b16 v[130:131], v28 offset:512
    ds_read_b64_tr_b16 v[132:133], v28 offset:8192
    ds_read_b64_tr_b16 v[134:135], v28 offset:8704
    v_xor_b32 v28, 32, v28
    ds_read_b64_tr_b16 v[136:137], v28 offset:0
    ds_read_b64_tr_b16 v[138:139], v28 offset:512
    ds_read_b64_tr_b16 v[140:141], v28 offset:8192
    ds_read_b64_tr_b16 v[142:143], v28 offset:8704
    s_waitcnt lgkmcnt(0)
    s_waitcnt vmcnt(32)
    s_barrier
    s_add_u32 m0, s60, 65536
    s_add_u32 s62, s63, 2097152
    buffer_load_dwordx4 v124, s[16:19], s62 offen lds
    s_add_u32 m0, s60, 66560
    s_add_u32 s62, s63, 2129920
    buffer_load_dwordx4 v125, s[16:19], s62 offen lds
    s_add_u32 m0, s60, 67584
    s_add_u32 s62, s63, 2162688
    buffer_load_dwordx4 v126, s[16:19], s62 offen lds
    s_add_u32 m0, s60, 68608
    s_add_u32 s62, s63, 2195456
    buffer_load_dwordx4 v127, s[16:19], s62 offen lds
    v_add_u32 v28, 81920, v25
    ds_read_b64_tr_b16 v[144:145], v28 offset:0
    ds_read_b64_tr_b16 v[146:147], v28 offset:512
    ds_read_b64_tr_b16 v[148:149], v28 offset:8192
    ds_read_b64_tr_b16 v[150:151], v28 offset:8704
    v_xor_b32 v28, 32, v28
    ds_read_b64_tr_b16 v[152:153], v28 offset:0
    ds_read_b64_tr_b16 v[154:155], v28 offset:512
    ds_read_b64_tr_b16 v[156:157], v28 offset:8192
    ds_read_b64_tr_b16 v[158:159], v28 offset:8704
    s_waitcnt lgkmcnt(0)
    s_waitcnt vmcnt(32)
    s_barrier
    s_cmp_lg_u32 s52, 3
    s_cbranch_scc1 L_R_W3_17
    buffer_load_dword v115, v114, s[48:51], s73 offen sc1
L_R_W3_17:
    s_add_u32 m0, s60, 81920
    s_add_u32 s62, s63, 3145728
    buffer_load_dwordx4 v124, s[16:19], s62 offen lds
    s_add_u32 m0, s60, 82944
    s_add_u32 s62, s63, 3178496
    buffer_load_dwordx4 v125, s[16:19], s62 offen lds
    s_add_u32 m0, s60, 83968
    s_add_u32 s62, s63, 3211264
    buffer_load_dwordx4 v126, s[16:19], s62 offen lds
    s_add_u32 m0, s60, 84992
    s_add_u32 s62, s63, 3244032
    buffer_load_dwordx4 v127, s[16:19], s62 offen lds
    v_add_u32 v28, 98304, v25
    ds_read_b64_tr_b16 v[160:161], v28 offset:0
    ds_read_b64_tr_b16 v[162:163], v28 offset:512
    ds_read_b64_tr_b16 v[164:165], v28 offset:8192
    ds_read_b64_tr_b16 v[166:167], v28 offset:8704
    v_xor_b32 v28, 32, v28
    ds_read_b64_tr_b16 v[168:169], v28 offset:0
    ds_read_b64_tr_b16 v[170:171], v28 offset:512
    ds_read_b64_tr_b16 v[172:173], v28 offset:8192
    ds_read_b64_tr_b16 v[174:175], v28 offset:8704
    s_waitcnt lgkmcnt(0)
    s_waitcnt vmcnt(32)
    s_barrier
    s_add_u32 m0, s60, 98304
    s_add_u32 s62, s63, 524288
    buffer_load_dwordx4 v124, s[16:19], s62 offen lds
    s_add_u32 m0, s60, 99328
    s_add_u32 s62, s63, 557056
    buffer_load_dwordx4 v125, s[16:19], s62 offen lds
    s_add_u32 m0, s60, 100352
    s_add_u32 s62, s63, 589824
    buffer_load_dwordx4 v126, s[16:19], s62 offen lds
    s_add_u32 m0, s60, 101376
    s_add_u32 s62, s63, 622592
    buffer_load_dwordx4 v127, s[16:19], s62 offen lds
    v_add_u32 v28, 114688, v25
    ds_read_b64_tr_b16 v[176:177], v28 offset:0
    ds_read_b64_tr_b16 v[178:179], v28 offset:512
    ds_read_b64_tr_b16 v[180:181], v28 offset:8192
    ds_read_b64_tr_b16 v[182:183], v28 offset:8704
    v_xor_b32 v28, 32, v28
    ds_read_b64_tr_b16 v[184:185], v28 offset:0
    ds_read_b64_tr_b16 v[186:187], v28 offset:512
    ds_read_b64_tr_b16 v[188:189], v28 offset:8192
    ds_read_b64_tr_b16 v[190:191], v28 offset:8704
    s_waitcnt lgkmcnt(0)
    s_waitcnt vmcnt(32)
    s_barrier
    s_add_u32 m0, s60, 114688
    s_add_u32 s62, s63, 1572864
    buffer_load_dwordx4 v124, s[16:19], s62 offen lds
    s_add_u32 m0, s60, 115712
    s_add_u32 s62, s63, 1605632
    buffer_load_dwordx4 v125, s[16:19], s62 offen lds
    s_add_u32 m0, s60, 116736
    s_add_u32 s62, s63, 1638400
    buffer_load_dwordx4 v126, s[16:19], s62 offen lds
    s_add_u32 m0, s60, 117760
    s_add_u32 s62, s63, 1671168
    buffer_load_dwordx4 v127, s[16:19], s62 offen lds
    v_add_u32 v28, 131072, v25
    ds_read_b64_tr_b16 v[192:193], v28 offset:0
    ds_read_b64_tr_b16 v[194:195], v28 offset:512
    ds_read_b64_tr_b16 v[196:197], v28 offset:8192
    ds_read_b64_tr_b16 v[198:199], v28 offset:8704
    v_xor_b32 v28, 32, v28
    ds_read_b64_tr_b16 v[200:201], v28 offset:0
    ds_read_b64_tr_b16 v[202:203], v28 offset:512
    ds_read_b64_tr_b16 v[204:205], v28 offset:8192
    ds_read_b64_tr_b16 v[206:207], v28 offset:8704
    s_waitcnt lgkmcnt(0)
    s_waitcnt vmcnt(32)
    s_barrier
    s_cmp_lg_u32 s52, 0
    s_cbranch_scc1 L_R_NOSIG
    s_mov_b64 exec, 1
    v_mov_b32 v14, 164
    v_mov_b32 v15, 1
    buffer_atomic_add v15, v14, s[44:47], 0 offen
    s_mov_b64 exec, -1
L_R_NOSIG:
    v_add_u32 v28, 147456, v25
    ds_read_b64_tr_b16 v[208:209], v28 offset:0
    ds_read_b64_tr_b16 v[210:211], v28 offset:512
    ds_read_b64_tr_b16 v[212:213], v28 offset:8192
    ds_read_b64_tr_b16 v[214:215], v28 offset:8704
    v_xor_b32 v28, 32, v28
    ds_read_b64_tr_b16 v[216:217], v28 offset:0
    ds_read_b64_tr_b16 v[218:219], v28 offset:512
    ds_read_b64_tr_b16 v[220:221], v28 offset:8192
    ds_read_b64_tr_b16 v[222:223], v28 offset:8704
    s_waitcnt lgkmcnt(0)
    s_waitcnt vmcnt(28)
    s_barrier
    v_add_u32 v28, 0, v25
    ds_read_b64_tr_b16 v[224:225], v28 offset:0
    ds_read_b64_tr_b16 v[226:227], v28 offset:512
    ds_read_b64_tr_b16 v[228:229], v28 offset:8192
    ds_read_b64_tr_b16 v[230:231], v28 offset:8704
    v_xor_b32 v28, 32, v28
    ds_read_b64_tr_b16 v[232:233], v28 offset:0
    ds_read_b64_tr_b16 v[234:235], v28 offset:512
    ds_read_b64_tr_b16 v[236:237], v28 offset:8192
    ds_read_b64_tr_b16 v[238:239], v28 offset:8704
    s_waitcnt lgkmcnt(0)
    s_waitcnt vmcnt(24)
    s_barrier
    v_add_u32 v28, 16384, v25
    ds_read_b64_tr_b16 v[240:241], v28 offset:0
    ds_read_b64_tr_b16 v[242:243], v28 offset:512
    ds_read_b64_tr_b16 v[244:245], v28 offset:8192
    ds_read_b64_tr_b16 v[246:247], v28 offset:8704
    v_xor_b32 v28, 32, v28
    ds_read_b64_tr_b16 v[248:249], v28 offset:0
    ds_read_b64_tr_b16 v[250:251], v28 offset:512
    ds_read_b64_tr_b16 v[252:253], v28 offset:8192
    ds_read_b64_tr_b16 v[254:255], v28 offset:8704
    s_waitcnt lgkmcnt(0)
    s_waitcnt vmcnt(20)
    s_barrier
    v_add_u32 v28, 32768, v25
    ds_read_b64_tr_b16 v[32:33], v28 offset:0
    ds_read_b64_tr_b16 v[34:35], v28 offset:512
    ds_read_b64_tr_b16 v[36:37], v28 offset:8192
    ds_read_b64_tr_b16 v[38:39], v28 offset:8704
    v_xor_b32 v28, 32, v28
    ds_read_b64_tr_b16 v[40:41], v28 offset:0
    ds_read_b64_tr_b16 v[42:43], v28 offset:512
    ds_read_b64_tr_b16 v[44:45], v28 offset:8192
    ds_read_b64_tr_b16 v[46:47], v28 offset:8704
    s_waitcnt lgkmcnt(0)
    s_waitcnt vmcnt(16)
    s_barrier
    ds_write_b128 v2, v[32:35] offset:32768
    ds_write_b128 v2, v[36:39] offset:33792
    ds_write_b128 v2, v[40:43] offset:34816
    ds_write_b128 v2, v[44:47] offset:35840
    ds_write_b128 v2, v[48:51] offset:0
    ds_write_b128 v2, v[52:55] offset:1024
    ds_write_b128 v2, v[56:59] offset:2048
    ds_write_b128 v2, v[60:63] offset:3072
    s_waitcnt lgkmcnt(0)
    v_add_u32 v28, 49152, v25
    ds_read_b64_tr_b16 v[32:33], v28 offset:0
    ds_read_b64_tr_b16 v[34:35], v28 offset:512
    ds_read_b64_tr_b16 v[36:37], v28 offset:8192
    ds_read_b64_tr_b16 v[38:39], v28 offset:8704
    v_xor_b32 v28, 32, v28
    ds_read_b64_tr_b16 v[40:41], v28 offset:0
    ds_read_b64_tr_b16 v[42:43], v28 offset:512
    ds_read_b64_tr_b16 v[44:45], v28 offset:8192
    ds_read_b64_tr_b16 v[46:47], v28 offset:8704
    s_waitcnt lgkmcnt(0)
    s_waitcnt vmcnt(12)
    s_barrier
    ds_write_b128 v2, v[32:35] offset:49152
    ds_write_b128 v2, v[36:39] offset:50176
    ds_write_b128 v2, v[40:43] offset:51200
    ds_write_b128 v2, v[44:47] offset:52224
    ds_write_b128 v2, v[64:67] offset:16384
    ds_write_b128 v2, v[68:71] offset:17408
    ds_write_b128 v2, v[72:75] offset:18432
    ds_write_b128 v2, v[76:79] offset:19456
    s_waitcnt lgkmcnt(0)
    v_add_u32 v28, 65536, v25
    ds_read_b64_tr_b16 v[32:33], v28 offset:0
    ds_read_b64_tr_b16 v[34:35], v28 offset:512
    ds_read_b64_tr_b16 v[36:37], v28 offset:8192
    ds_read_b64_tr_b16 v[38:39], v28 offset:8704
    v_xor_b32 v28, 32, v28
    ds_read_b64_tr_b16 v[40:41], v28 offset:0
    ds_read_b64_tr_b16 v[42:43], v28 offset:512
    ds_read_b64_tr_b16 v[44:45], v28 offset:8192
    ds_read_b64_tr_b16 v[46:47], v28 offset:8704
    s_waitcnt lgkmcnt(0)
    s_waitcnt vmcnt(8)
    s_barrier
    ds_write_b128 v23, v[32:35] offset:0
    ds_write_b128 v23, v[36:39] offset:1024
    ds_write_b128 v23, v[40:43] offset:2048
    ds_write_b128 v23, v[44:47] offset:3072
    s_waitcnt lgkmcnt(0)
    s_cmp_lg_u32 s52, 3
    s_cbranch_scc1 L_R_W3_18
    buffer_load_dword v113, v112, s[44:47], 0 offen sc1
L_R_W3_18:
    v_add_u32 v28, 81920, v25
    ds_read_b64_tr_b16 v[32:33], v28 offset:0
    ds_read_b64_tr_b16 v[34:35], v28 offset:512
    ds_read_b64_tr_b16 v[36:37], v28 offset:8192
    ds_read_b64_tr_b16 v[38:39], v28 offset:8704
    v_xor_b32 v28, 32, v28
    ds_read_b64_tr_b16 v[40:41], v28 offset:0
    ds_read_b64_tr_b16 v[42:43], v28 offset:512
    ds_read_b64_tr_b16 v[44:45], v28 offset:8192
    ds_read_b64_tr_b16 v[46:47], v28 offset:8704
    s_waitcnt lgkmcnt(0)
    s_waitcnt vmcnt(4)
    s_barrier
    ds_write_b128 v23, v[32:35] offset:16384
    ds_write_b128 v23, v[36:39] offset:17408
    ds_write_b128 v23, v[40:43] offset:18432
    ds_write_b128 v23, v[44:47] offset:19456
    s_waitcnt lgkmcnt(0)
    s_cmp_lg_u32 s52, 3
    s_cbranch_scc1 L_R_W3_19
    v_readlane_b32 s61, v115, 0
    s_nop 0
    s_cmp_eq_u32 s61, 0
    s_cbranch_scc1 L_R_NOE0
    s_lshl_b32 s61, s53, 13
    s_add_u32 s71, s61, 16777216
    s_mov_b32 m0, 139264
    s_nop 0
    buffer_load_dwordx4 v1, s[48:51], s71 offen offset:0 sc1 lds
    buffer_load_dwordx4 v1, s[48:51], s71 offen offset:1024 sc1 lds
    buffer_load_dwordx4 v1, s[48:51], s71 offen offset:2048 sc1 lds
    buffer_load_dwordx4 v1, s[48:51], s71 offen offset:3072 sc1 lds
    s_add_u32 s71, s61, 16781312
    s_mov_b32 m0, 143360
    s_nop 0
    buffer_load_dwordx4 v1, s[48:51], s71 offen offset:0 sc1 lds
    buffer_load_dwordx4 v1, s[48:51], s71 offen offset:1024 sc1 lds
    buffer_load_dwordx4 v1, s[48:51], s71 offen offset:2048 sc1 lds
    buffer_load_dwordx4 v1, s[48:51], s71 offen offset:3072 sc1 lds
    s_add_u32 s71, s61, 33554432
    s_mov_b32 m0, 147456
    s_nop 0
    buffer_load_dwordx4 v1, s[48:51], s71 offen offset:0 sc1 lds
    buffer_load_dwordx4 v1, s[48:51], s71 offen offset:1024 sc1 lds
    buffer_load_dwordx4 v1, s[48:51], s71 offen offset:2048 sc1 lds
    buffer_load_dwordx4 v1, s[48:51], s71 offen offset:3072 sc1 lds
    s_add_u32 s71, s61, 33558528
    s_mov_b32 m0, 151552
    s_nop 0
    buffer_load_dwordx4 v1, s[48:51], s71 offen offset:0 sc1 lds
    buffer_load_dwordx4 v1, s[48:51], s71 offen offset:1024 sc1 lds
    buffer_load_dwordx4 v1, s[48:51], s71 offen offset:2048 sc1 lds
    buffer_load_dwordx4 v1, s[48:51], s71 offen offset:3072 sc1 lds
    s_mov_b32 s93, 1
L_R_NOE0:
L_R_W3_19:
    v_add_u32 v28, 98304, v25
    ds_read_b64_tr_b16 v[32:33], v28 offset:0
    ds_read_b64_tr_b16 v[34:35], v28 offset:512
    ds_read_b64_tr_b16 v[36:37], v28 offset:8192
    ds_read_b64_tr_b16 v[38:39], v28 offset:8704
    v_xor_b32 v28, 32, v28
    ds_read_b64_tr_b16 v[40:41], v28 offset:0
    ds_read_b64_tr_b16 v[42:43], v28 offset:512
    ds_read_b64_tr_b16 v[44:45], v28 offset:8192
    ds_read_b64_tr_b16 v[46:47], v28 offset:8704
    s_waitcnt lgkmcnt(0)
    s_waitcnt vmcnt(16)
    s_cmp_eq_u32 s93, 1
    s_cbranch_scc1 L_R_LW
    s_waitcnt vmcnt(0)
L_R_LW:
    s_barrier
    ds_write_b128 v23, v[32:35] offset:32768
    ds_write_b128 v23, v[36:39] offset:33792
    ds_write_b128 v23, v[40:43] offset:34816
    ds_write_b128 v23, v[44:47] offset:35840
    s_waitcnt lgkmcnt(0)
    v_add_u32 v28, 114688, v25
    ds_read_b64_tr_b16 v[32:33], v28 offset:0
    ds_read_b64_tr_b16 v[34:35], v28 offset:512
    ds_read_b64_tr_b16 v[36:37], v28 offset:8192
    ds_read_b64_tr_b16 v[38:39], v28 offset:8704
    v_xor_b32 v28, 32, v28
    ds_read_b64_tr_b16 v[40:41], v28 offset:0
    ds_read_b64_tr_b16 v[42:43], v28 offset:512
    ds_read_b64_tr_b16 v[44:45], v28 offset:8192
    ds_read_b64_tr_b16 v[46:47], v28 offset:8704
    s_waitcnt lgkmcnt(0)
    s_barrier
    ds_write_b128 v23, v[32:35] offset:49152
    ds_write_b128 v23, v[36:39] offset:50176
    ds_write_b128 v23, v[40:43] offset:51200
    ds_write_b128 v23, v[44:47] offset:52224
    s_waitcnt lgkmcnt(0)
    s_mov_b32 s56, 0
    v_mov_b32 v15, 139260
    s_cmp_lg_u32 s52, 3
    s_cbranch_scc1 L_R_STB
L_R_ST:
    v_readlane_b32 s61, v113, 12
    v_readlane_b32 s62, v113, 41
    v_readlane_b32 s70, v113, 56
    s_lshl_b32 s62, s62, 3
    s_min_u32 s61, s61, s62
    s_cmp_ge_u32 s61, 256
    s_cbranch_scc1 L_R_STOK
    s_add_u32 s56, s56, 1
    s_cmp_gt_u32 s56, 60000
    s_cbranch_scc1 L_TIMEOUT_2
    s_sleep 8
    buffer_load_dword v113, v112, s[44:47], 0 offen sc1
    s_waitcnt vmcnt(0)
    s_branch L_R_ST
.p2align 5
L_R_STOK:
    v_mov_b32 v14, s70
    ds_write_b32 v15, v14
    s_waitcnt lgkmcnt(0)
L_R_STB:
    s_barrier
    ds_read_b32 v14, v15
    s_waitcnt lgkmcnt(0)
    v_readfirstlane_b32 s70, v14
    s_mov_b32 s64, 0
    s_lshl_b32 s65, s52, 16
    s_add_u32 s65, s65, 524288
    s_lshl_b32 s3, s53, 7
    s_add_u32 s65, s65, s3
    s_lshl_b32 s66, s53, 13
    s_add_u32 s66, s66, 524288
    s_mov_b32 s68, 65536
    s_mov_b32 s67, 73728
    s_lshl_b32 s82, s53, 13
    s_cmp_lt_u32 s52, 2
    s_cselect_b32 s34, 0, 0x100000
    s_add_u32 s34, s34, 4194304
    s_mov_b32 s83, 139264
    s_mov_b32 s84, 147456
    s_mov_b32 s85, 155648
    s_mov_b32 s69, 1
    s_mov_b32 s92, 150929408
    s_add_u32 s87, s65, 4096
    s_add_u32 s72, s66, s91
    s_lshl_b32 s73, s53, 7
    s_add_u32 s73, s73, 0
    v_and_b32 v14, 3, v0
    v_lshlrev_b32 v14, 3, v14
    v_lshl_add_u32 v15, v5, 1, v14
    v_and_b32 v14, 8, v14
    v_add_u32 v5, v5, v14
    v_add_u32 v5, 137216, v5
    v_lshrrev_b32 v14, 1, v0
    v_and_b32 v14, 8, v14
    v_xor_b32 v15, v15, v14
    v_add_u32 v0, 131072, v15
    v_xor_b32 v5, 16, v0
    s_mov_b32 s36, 0xcccccccc
    s_mov_b32 s37, 0xcccccccc
    s_cmp_lt_u32 s52, 2
    s_cselect_b64 s[38:39], s[76:77], 0
    s_cbranch_scc1 L_R_NOSIDE
    v_lshlrev_b32 v18, 8, v1
    v_and_b32 v18, 0x3fff, v18
L_R_NOSIDE:
    s_cmp_lt_u32 s70, 32
    s_cbranch_scc1 L_R_SLOW_ENTRY
L_RFAST_ENTRY:
    ds_read_b128 v[56:59], v2 offset:32768
    ds_read_b128 v[60:63], v2 offset:33792
    ds_read_b128 v[64:67], v2 offset:34816
    ds_read_b128 v[68:71], v2 offset:35840
    ds_read_b128 v[72:75], v2 offset:49152
    ds_read_b128 v[76:79], v2 offset:50176
    ds_read_b128 v[80:83], v2 offset:51200
    ds_read_b128 v[84:87], v2 offset:52224
    v_mov_b32 v14, 0
    s_nop 1
    v_mfma_f32_32x32x2_f32 v[88:103], v14, v14, 0
    v_mfma_f32_16x16x4_f32 v[104:107], v14, v14, 0
    v_mfma_f32_16x16x4_f32 v[108:111], v14, v14, 0
    v_add_u32 v6, s83, v21
    v_add_u32 v7, s84, v22
    s_add_u32 s88, s68, s90
    s_add_u32 s75, s88, 4096
    s_mov_b32 s94, s89
    s_cmp_ge_u32 s52, 2
    s_cselect_b64 s[42:43], -1, 0
    s_add_u32 s95, s82, s94
    s_mov_b32 s86, 64
    s_cmp_lg_u32 s52, 3
    s_cbranch_scc1 L_RFAST_GATHER
    s_mov_b32 s86, 0
    s_cmp_eq_u32 s93, 1
    s_cbranch_scc1 L_RFAST_E1
    s_add_u32 s62, s64, 0
    s_min_u32 s62, s62, 62
    s_mov_b32 s56, 0
L_RFASTN0_CHK:
    s_cmp_gt_u32 s86, s62
    s_cbranch_scc1 L_RFASTN0_OK
    buffer_load_dword v16, v18, s[48:51], s73 offen sc1
    s_waitcnt vmcnt(0)
    v_readlane_b32 s61, v16, 0
    s_nop 0
    s_mul_i32 s61, s61, 4
    s_mov_b32 s86, s61
    v_readlane_b32 s61, v16, 1
    s_nop 0
    s_mul_i32 s61, s61, 4
    s_add_u32 s61, s61, 1
    s_min_u32 s86, s86, s61
    v_readlane_b32 s61, v16, 2
    s_nop 0
    s_mul_i32 s61, s61, 4
    s_add_u32 s61, s61, 2
    s_min_u32 s86, s86, s61
    v_readlane_b32 s61, v16, 3
    s_nop 0
    s_mul_i32 s61, s61, 4
    s_add_u32 s61, s61, 3
    s_min_u32 s86, s86, s61
    s_add_u32 s56, s56, 1
    s_cmp_gt_u32 s56, 60000
    s_cbranch_scc1 L_TIMEOUT_3
    s_branch L_RFASTN0_CHK
.p2align 5
L_RFASTN0_OK:
    s_lshl_b32 s61, s53, 13
    s_add_u32 s71, s61, 16777216
    s_mov_b32 m0, 139264
    s_nop 0
    buffer_load_dwordx4 v1, s[48:51], s71 offen offset:0 sc1 lds
    buffer_load_dwordx4 v1, s[48:51], s71 offen offset:1024 sc1 lds
    buffer_load_dwordx4 v1, s[48:51], s71 offen offset:2048 sc1 lds
    buffer_load_dwordx4 v1, s[48:51], s71 offen offset:3072 sc1 lds
    s_add_u32 s71, s61, 16781312
    s_mov_b32 m0, 143360
    s_nop 0
    buffer_load_dwordx4 v1, s[48:51], s71 offen offset:0 sc1 lds
    buffer_load_dwordx4 v1, s[48:51], s71 offen offset:1024 sc1 lds
    buffer_load_dwordx4 v1, s[48:51], s71 offen offset:2048 sc1 lds
    buffer_load_dwordx4 v1, s[48:51], s71 offen offset:3072 sc1 lds
    s_add_u32 s71, s61, 33554432
    s_mov_b32 m0, 147456
    s_nop 0
    buffer_load_dwordx4 v1, s[48:51], s71 offen offset:0 sc1 lds
    buffer_load_dwordx4 v1, s[48:51], s71 offen offset:1024 sc1 lds
    buffer_load_dwordx4 v1, s[48:51], s71 offen offset:2048 sc1 lds
    buffer_load_dwordx4 v1, s[48:51], s71 offen offset:3072 sc1 lds
    s_add_u32 s71, s61, 33558528
    s_mov_b32 m0, 151552
    s_nop 0
    buffer_load_dwordx4 v1, s[48:51], s71 offen offset:0 sc1 lds
    buffer_load_dwordx4 v1, s[48:51], s71 offen offset:1024 sc1 lds
    buffer_load_dwordx4 v1, s[48:51], s71 offen offset:2048 sc1 lds
    buffer_load_dwordx4 v1, s[48:51], s71 offen offset:3072 sc1 lds
    s_branch L_RFAST_E2
.p2align 5
L_RFAST_E1:
    v_mov_b32 v16, v115
    s_nop 0
    v_readlane_b32 s61, v16, 0
    s_nop 0
    s_mul_i32 s61, s61, 4
    s_mov_b32 s86, s61
    v_readlane_b32 s61, v16, 1
    s_nop 0
    s_mul_i32 s61, s61, 4
    s_add_u32 s61, s61, 1
    s_min_u32 s86, s86, s61
    v_readlane_b32 s61, v16, 2
    s_nop 0
    s_mul_i32 s61, s61, 4
    s_add_u32 s61, s61, 2
    s_min_u32 s86, s86, s61
    v_readlane_b32 s61, v16, 3
    s_nop 0
    s_mul_i32 s61, s61, 4
    s_add_u32 s61, s61, 3
    s_min_u32 s86, s86, s61
L_RFAST_E2:
    s_add_u32 s62, s64, 1
    s_min_u32 s62, s62, 62
    s_mov_b32 s56, 0
L_RFASTN1_CHK:
    s_cmp_gt_u32 s86, s62
    s_cbranch_scc1 L_RFASTN1_OK
    buffer_load_dword v16, v18, s[48:51], s73 offen sc1
    s_waitcnt vmcnt(0)
    v_readlane_b32 s61, v16, 0
    s_nop 0
    s_mul_i32 s61, s61, 4
    s_mov_b32 s86, s61
    v_readlane_b32 s61, v16, 1
    s_nop 0
    s_mul_i32 s61, s61, 4
    s_add_u32 s61, s61, 1
    s_min_u32 s86, s86, s61
    v_readlane_b32 s61, v16, 2
    s_nop 0
    s_mul_i32 s61, s61, 4
    s_add_u32 s61, s61, 2
    s_min_u32 s86, s86, s61
    v_readlane_b32 s61, v16, 3
    s_nop 0
    s_mul_i32 s61, s61, 4
    s_add_u32 s61, s61, 3
    s_min_u32 s86, s86, s61
    s_add_u32 s56, s56, 1
    s_cmp_gt_u32 s56, 60000
    s_cbranch_scc1 L_TIMEOUT_3
    s_branch L_RFASTN1_CHK
.p2align 5
L_RFASTN1_OK:
    s_branch L_RFAST_GATHER
.p2align 6
    s_nop 0
    s_nop 0
    s_nop 0
    s_nop 0
    s_nop 0
L_RFAST_GATHER:
    s_mov_b32 s56, 0
L_RFAST_GAG:
    buffer_load_dwordx4 v[52:55], v1, s[48:51], s88 offen sc1
    s_nop 15
    s_nop 15
    s_nop 7
    buffer_load_dwordx4 v[48:51], v1, s[48:51], s88 offen sc1
L_RFAST_GL:
    s_waitcnt vmcnt(1)
    ds_write_b128 v13, v[52:55]
    v_fma_f32 v14, v52, v53, v54
    v_cmp_u_f32 vcc, v14, v55
    s_cbranch_vccnz L_RFAST_GR
L_RFAST_GOK:
    buffer_load_dwordx4 v[52:55], v1, s[48:51], s75 offen sc1
    s_waitcnt lgkmcnt(0)
    s_barrier
    ds_read_b128 v[24:27], v3 offset:0
    ds_read_b128 v[28:31], v3 offset:1024
    ds_read_b128 v[32:35], v3 offset:2048
    ds_read_b128 v[36:39], v3 offset:3072
    s_mov_b32 s56, 0
    s_mov_b64 exec, s[76:77]
    s_cmp_lt_u32 s86, 63
    s_cbranch_scc1 L_RFAST_FLG
    buffer_store_dword v124, v11, s[48:51], s92 offen sc1
L_RFAST_FLB:
    s_mov_b64 exec, -1
    s_waitcnt lgkmcnt(3)
    v_smfmac_f32_16x16x64_bf16 v[88:91], v[24:27], v[56:63], v12
    ds_read_b128 v[56:59], v23 offset:0
    v_smfmac_f32_16x16x64_bf16 v[92:95], v[24:27], v[64:71], v12
    ds_read_b128 v[60:63], v23 offset:1024
    s_waitcnt lgkmcnt(4)
    v_smfmac_f32_16x16x64_bf16 v[88:91], v[28:31], v[72:79], v12
    ds_read_b128 v[64:67], v23 offset:2048
    v_smfmac_f32_16x16x64_bf16 v[92:95], v[28:31], v[80:87], v12
    ds_read_b128 v[68:71], v23 offset:3072
    s_waitcnt lgkmcnt(5)
    v_smfmac_f32_16x16x64_bf16 v[88:91], v[32:35], a[224:231], v12
    ds_read_b128 v[72:75], v23 offset:16384
    v_smfmac_f32_16x16x64_bf16 v[92:95], v[32:35], a[232:239], v12
    ds_read_b128 v[76:79], v23 offset:17408
    s_waitcnt lgkmcnt(6)
    v_smfmac_f32_16x16x64_bf16 v[88:91], v[36:39], a[240:247], v12
    ds_read_b128 v[80:83], v23 offset:18432
    v_smfmac_f32_16x16x64_bf16 v[92:95], v[36:39], a[248:255], v12
    ds_read_b128 v[84:87], v23 offset:19456
    v_smfmac_f32_16x16x64_bf16 v[96:99], v[24:27], v[192:199], v12
    s_add_u32 s71, s95, 17039360
    s_add_u32 m0, s94, s85
    v_smfmac_f32_16x16x64_bf16 v[100:103], v[24:27], v[200:207], v12
    s_waitcnt vmcnt(1)
    ds_write_b128 v13, v[52:55] offset:4096
    v_smfmac_f32_16x16x64_bf16 v[96:99], v[28:31], v[208:215], v12
    v_fma_f32 v14, v52, v53, v54
    v_smfmac_f32_16x16x64_bf16 v[100:103], v[28:31], v[216:223], v12
    s_waitcnt lgkmcnt(5)
    v_cmp_u_f32 vcc, v14, v55
    v_smfmac_f32_16x16x64_bf16 v[96:99], v[32:35], v[56:63], v12
    ds_read_b128 v[56:59], v23 offset:32768
    s_cbranch_vccnz L_RFAST_G1RETRY
L_RFAST_G1OK:
    v_smfmac_f32_16x16x64_bf16 v[100:103], v[32:35], v[64:71], v12
    ds_read_b128 v[60:63], v23 offset:33792
    s_waitcnt lgkmcnt(3)
    v_smfmac_f32_16x16x64_bf16 v[96:99], v[36:39], v[72:79], v12
    v_smfmac_f32_16x16x64_bf16 v[100:103], v[36:39], v[80:87], v12
    s_waitcnt lgkmcnt(2)
    s_barrier
    ds_read_b128 v[40:43], v3 offset:4096
    v_smfmac_f32_16x16x64_bf16 v[104:107], v[24:27], a[96:103], v12
    ds_read_b128 v[44:47], v3 offset:5120
    v_smfmac_f32_16x16x64_bf16 v[108:111], v[24:27], a[104:111], v12
    ds_read_b128 v[48:51], v3 offset:6144
    v_smfmac_f32_16x16x64_bf16 v[104:107], v[28:31], a[112:119], v12
    ds_read_b128 v[52:55], v3 offset:7168
    v_smfmac_f32_16x16x64_bf16 v[108:111], v[28:31], a[120:127], v12
    ds_read_b128 v[64:67], v23 offset:34816
    s_waitcnt lgkmcnt(4)
    v_smfmac_f32_16x16x64_bf16 v[88:91], v[40:43], v[128:135], v12
    ds_read_b128 v[68:71], v23 offset:35840
    v_smfmac_f32_16x16x64_bf16 v[92:95], v[40:43], v[136:143], v12
    ds_read_b128 v[72:75], v23 offset:49152
    s_waitcnt lgkmcnt(5)
    v_smfmac_f32_16x16x64_bf16 v[88:91], v[44:47], v[144:151], v12
    ds_read_b128 v[76:79], v23 offset:50176
    v_smfmac_f32_16x16x64_bf16 v[92:95], v[44:47], v[152:159], v12
    ds_read_b128 v[80:83], v23 offset:51200
    s_waitcnt lgkmcnt(6)
    v_smfmac_f32_16x16x64_bf16 v[88:91], v[48:51], v[160:167], v12
    ds_read_b128 v[84:87], v23 offset:52224
    v_smfmac_f32_16x16x64_bf16 v[92:95], v[48:51], v[168:175], v12
    s_waitcnt lgkmcnt(6)
    v_smfmac_f32_16x16x64_bf16 v[88:91], v[52:55], v[176:183], v12
    v_smfmac_f32_16x16x64_bf16 v[92:95], v[52:55], v[184:191], v12
    s_waitcnt lgkmcnt(4)
    v_smfmac_f32_16x16x64_bf16 v[96:99], v[40:43], v[56:63], v12
    ds_read_b128 v[56:59], v6 offset:0
    v_smfmac_f32_16x16x64_bf16 v[100:103], v[40:43], v[64:71], v12
    ds_read_b128 v[60:63], v6 offset:256
    s_waitcnt lgkmcnt(2)
    v_smfmac_f32_16x16x64_bf16 v[96:99], v[44:47], v[72:79], v12
    ds_read_b128 v[64:67], v6 offset:2048
    v_add_f32 v88, v88, v90
    v_add_f32 v89, v89, v91
    v_smfmac_f32_16x16x64_bf16 v[100:103], v[44:47], v[80:87], v12
    ds_read_b128 v[68:71], v6 offset:2304
    v_mul_f32 v88, s78, v88
    v_mul_f32 v89, s78, v89
    v_smfmac_f32_16x16x64_bf16 v[96:99], v[48:51], v[224:231], v12
    ds_read_b128 v[72:75], v6 offset:4096
    v_cvt_pk_bf16_f32 v91, v88, v89
    v_smfmac_f32_16x16x64_bf16 v[100:103], v[48:51], v[232:239], v12
    ds_read_b128 v[76:79], v6 offset:4352
    v_add_f32 v92, v92, v94
    v_smfmac_f32_16x16x64_bf16 v[96:99], v[52:55], v[240:247], v12
    ds_read_b128 v[80:83], v6 offset:6144
    v_add_f32 v93, v93, v95
    v_smfmac_f32_16x16x64_bf16 v[100:103], v[52:55], v[248:255], v12
    ds_read_b128 v[84:87], v6 offset:6400
    v_mul_f32 v92, s78, v92
    v_smfmac_f32_16x16x64_bf16 v[104:107], v[32:35], a[128:135], v12
    v_mul_f32 v93, s78, v93
    v_smfmac_f32_16x16x64_bf16 v[108:111], v[32:35], a[136:143], v12
    v_cvt_pk_bf16_f32 v95, v92, v93
    v_smfmac_f32_16x16x64_bf16 v[104:107], v[36:39], a[144:151], v12
    v_add_f32 v96, v96, v98
    v_add_f32 v97, v97, v99
    v_cvt_pk_bf16_f32 v90, v96, v97
    v_smfmac_f32_16x16x64_bf16 v[108:111], v[36:39], a[152:159], v12
    buffer_load_dwordx4 v1, s[48:51], s71 offen offset:0 sc1 lds
    v_add_f32 v100, v100, v102
    v_add_f32 v101, v101, v103
    v_cvt_pk_bf16_f32 v94, v100, v101
    v_smfmac_f32_16x16x64_bf16 v[104:107], v[40:43], a[160:167], v12
    buffer_load_dwordx4 v1, s[48:51], s71 offen offset:1024 sc1 lds
    ds_write2_b64 v9, v[90:91], v[94:95] offset0:0 offset1:64
    v_smfmac_f32_16x16x64_bf16 v[108:111], v[40:43], a[168:175], v12
    v_mov_b32 v36, 0x3f803f80
    v_smfmac_f32_16x16x64_bf16 v[104:107], v[44:47], a[176:183], v12
    s_add_u32 s71, s95, 33816576
    s_add_u32 m0, s94, s83
    v_mov_b32 v37, 0x3f803f80
    v_smfmac_f32_16x16x64_bf16 v[108:111], v[44:47], a[184:191], v12
    v_mov_b32 v38, 0x3f803f80
    s_waitcnt lgkmcnt(0)
    s_barrier
    v_smfmac_f32_16x16x64_bf16 v[104:107], v[48:51], a[192:199], v12
    ds_read_b64_tr_b16 v[112:113], v0 offset:0
    ds_read_b64_tr_b16 v[114:115], v5 offset:256
    v_mov_b32 v39, 0x3f803f80
    v_smfmac_f32_16x16x64_bf16 v[108:111], v[48:51], a[200:207], v12
    ds_read_b64_tr_b16 v[116:117], v0 offset:1024
    ds_read_b64_tr_b16 v[118:119], v5 offset:1280
    v_smfmac_f32_16x16x64_bf16 v[104:107], v[52:55], a[208:215], v12
    ds_read_b64_tr_b16 v[120:121], v0 offset:2048
    ds_read_b64_tr_b16 v[122:123], v5 offset:2304
    v_smfmac_f32_16x16x64_bf16 v[108:111], v[52:55], a[216:223], v12
    ds_read_b64_tr_b16 v[124:125], v0 offset:3072
    ds_read_b64_tr_b16 v[126:127], v5 offset:3328
    s_waitcnt lgkmcnt(6)
    v_mfma_f32_16x16x32_bf16 v[32:35], v[112:115], v[112:115], 0
    buffer_load_dwordx4 v1, s[48:51], s71 offen offset:0 sc1 lds
    s_waitcnt lgkmcnt(4)
    v_mfma_f32_16x16x32_bf16 v[32:35], v[116:119], v[116:119], v[32:35]
    buffer_load_dwordx4 v1, s[48:51], s71 offen offset:1024 sc1 lds
    s_waitcnt lgkmcnt(2)
    v_mfma_f32_16x16x32_bf16 v[32:35], v[120:123], v[120:123], v[32:35]
    ds_read_b128 v[44:47], v7 offset:0
    s_waitcnt lgkmcnt(1)
    v_mov_b32 v40, 0x3f803f80
    v_mov_b32 v41, 0
    v_mfma_f32_16x16x32_bf16 v[32:35], v[124:127], v[124:127], v[32:35]
    ds_read_b128 v[48:51], v7 offset:256
    v_cvt_pk_bf16_f32 v104, v104, v105
    v_cvt_pk_bf16_f32 v105, v106, v107
    v_mfma_f32_16x16x32_bf16 v[24:27], v[56:59], v[112:115], 0
    v_cvt_pk_bf16_f32 v106, v108, v109
    v_cvt_pk_bf16_f32 v107, v110, v111
    v_mfma_f32_16x16x32_bf16 v[24:27], v[64:67], v[116:119], v[24:27]
    v_mov_b64 v[88:89], 0
    v_mov_b64 v[90:91], 0
    v_mfma_f32_16x16x32_bf16 v[24:27], v[72:75], v[120:123], v[24:27]
    v_exp_f32 v34, v32
    v_mfma_f32_16x16x32_bf16 v[24:27], v[80:83], v[124:127], v[24:27]
    v_exp_f32 v35, v33
    v_mfma_f32_16x16x32_bf16 v[28:31], v[60:63], v[112:115], 0
    v_cvt_pk_bf16_f32 v42, v34, v35
    v_cvt_pk_bf16_f32 v43, v34, v35
    v_mfma_f32_16x16x32_bf16 v[28:31], v[68:71], v[116:119], v[28:31]
    v_max_f32 v109, |v32|, |v33|
    v_mov_b64 v[92:93], 0
    v_mfma_f32_16x16x32_bf16 v[28:31], v[76:79], v[120:123], v[28:31]
    v_exp_f32 v96, v24
    v_mfma_f32_16x16x32_bf16 v[28:31], v[84:87], v[124:127], v[28:31]
    v_exp_f32 v97, v25
    v_mfma_f32_16x16x16_bf16 v[120:123], v[40:41], v[42:43], 0
    v_exp_f32 v98, v26
    v_mfma_f32_16x16x16_bf16 v[112:115], v[104:105], v[42:43], 0
    v_exp_f32 v99, v27
    v_mfma_f32_16x16x16_bf16 v[116:119], v[106:107], v[42:43], 0
    v_cvt_pk_bf16_f32 v52, v96, v97
    v_cvt_pk_bf16_f32 v53, v98, v99
    v_exp_f32 v100, v28
    v_exp_f32 v101, v29
    v_exp_f32 v102, v30
    v_exp_f32 v103, v31
    v_cvt_pk_bf16_f32 v54, v100, v101
    v_cvt_pk_bf16_f32 v55, v102, v103
    v_max3_f32 v108, |v24|, |v25|, |v26|
    s_waitcnt lgkmcnt(0)
    s_mov_b32 s56, 0
    v_mfma_f32_16x16x32_bf16 v[120:123], v[36:39], v[52:55], v[120:123]
    v_max3_f32 v109, v109, |v27|, |v28|
    v_max3_f32 v108, v108, |v29|, |v30|
    v_mfma_f32_16x16x32_bf16 v[112:115], v[44:47], v[52:55], v[112:115]
    v_max3_f32 v108, v108, v109, |v31|
    v_cmp_nge_f32 vcc, 0x41f00000, v108
    v_mfma_f32_16x16x32_bf16 v[116:119], v[48:51], v[52:55], v[116:119]
    v_xor_b32 v76, 512, v8
    s_and_b64 vcc, vcc, s[36:37]
    s_cbranch_scc1 L_RFAST_BIGMEM
L_RFAST_SMOK:
    s_mov_b64 exec, s[36:37]
    v_rcp_f32 v70, v120
    s_nop 0
    v_pk_mul_f32 v[112:113], v[112:113], v[70:71] op_sel_hi:[1,0]
    v_pk_mul_f32 v[114:115], v[114:115], v[70:71] op_sel_hi:[1,0]
    v_cvt_pk_bf16_f32 v64, v112, v113
    v_cvt_pk_bf16_f32 v65, v114, v115
    ds_write_b64 v8, v[64:65] offset:0
    v_pk_mul_f32 v[116:117], v[116:117], v[70:71] op_sel_hi:[1,0]
    v_pk_mul_f32 v[118:119], v[118:119], v[70:71] op_sel_hi:[1,0]
    v_cvt_pk_bf16_f32 v66, v116, v117
    v_cvt_pk_bf16_f32 v67, v118, v119
    ds_write_b64 v8, v[66:67] offset:8
    s_mov_b64 exec, -1
    v_mov_b32_dpp v68, v64 quad_perm:[2,3,2,3] row_mask:0xf bank_mask:0xf
    v_mov_b32_dpp v69, v65 quad_perm:[2,3,2,3] row_mask:0xf bank_mask:0xf
    v_mov_b32_dpp v70, v66 quad_perm:[2,3,2,3] row_mask:0xf bank_mask:0xf
    v_mov_b32_dpp v71, v67 quad_perm:[2,3,2,3] row_mask:0xf bank_mask:0xf
    v_xor_b32 v77, 1024, v8
    v_xor_b32 v78, 1536, v8
    v_mov_b64 v[94:95], 0
    v_mov_b64 v[96:97], 0
    v_mov_b64 v[98:99], 0
    v_mov_b64 v[100:101], 0
    v_mov_b64 v[102:103], 0
    v_smfmac_f32_16x16x64_bf16 v[88:91], v[68:71], a[0:7], v12
    s_waitcnt lgkmcnt(0)
    s_barrier
    ds_read_b128 v[56:59], v76
    ds_read_b128 v[60:63], v77
    ds_read_b128 v[72:75], v78
    v_smfmac_f32_16x16x64_bf16 v[92:95], v[68:71], a[32:39], v12
    ds_read_b128 v[24:27], v2 offset:0
    v_smfmac_f32_16x16x64_bf16 v[96:99], v[68:71], a[64:71], v12
    ds_read_b128 v[28:31], v2 offset:1024
    v_smfmac_f32_16x16x64_bf16 v[100:103], v[68:71], a[88:95], v12
    ds_read_b128 v[32:35], v2 offset:2048
    s_waitcnt lgkmcnt(5)
    v_smfmac_f32_16x16x64_bf16 v[88:91], v[56:59], a[8:15], v12
    ds_read_b128 v[36:39], v2 offset:3072
    s_waitcnt lgkmcnt(5)
    v_smfmac_f32_16x16x64_bf16 v[88:91], v[60:63], a[16:23], v12
    ds_read_b128 v[40:43], v2 offset:16384
    s_waitcnt lgkmcnt(5)
    v_smfmac_f32_16x16x64_bf16 v[88:91], v[72:75], a[24:31], v12
    ds_read_b128 v[44:47], v2 offset:17408
    v_smfmac_f32_16x16x64_bf16 v[92:95], v[56:59], a[40:47], v12
    ds_read_b128 v[48:51], v2 offset:18432
    v_smfmac_f32_16x16x64_bf16 v[92:95], v[60:63], a[48:55], v12
    ds_read_b128 v[52:55], v2 offset:19456
    v_smfmac_f32_16x16x64_bf16 v[92:95], v[72:75], a[56:63], v12
    s_nop 1
    v_cvt_pk_bf16_f32 v80, v88, v89
    v_smfmac_f32_16x16x64_bf16 v[96:99], v[56:59], a[72:79], v12
    v_cvt_pk_bf16_f32 v81, v90, v91
    v_smfmac_f32_16x16x64_bf16 v[96:99], v[60:63], a[80:87], v12
    s_waitcnt lgkmcnt(6)
    v_and_or_b32 v80, v80, -2, s69
    v_smfmac_f32_16x16x64_bf16 v[96:99], v[72:75], v[24:31], v12
    s_waitcnt lgkmcnt(4)
    v_cvt_pk_bf16_f32 v82, v92, v93
    v_cvt_pk_bf16_f32 v83, v94, v95
    buffer_store_dwordx4 v[80:83], v10, s[48:51], s65 offen
    v_smfmac_f32_16x16x64_bf16 v[100:103], v[56:59], v[32:39], v12
    s_waitcnt lgkmcnt(2)
    v_smfmac_f32_16x16x64_bf16 v[100:103], v[60:63], v[40:47], v12
    s_waitcnt lgkmcnt(0)
    v_smfmac_f32_16x16x64_bf16 v[100:103], v[72:75], v[48:55], v12
    v_cvt_pk_bf16_f32 v84, v96, v97
    v_cvt_pk_bf16_f32 v85, v98, v99
    v_and_or_b32 v84, v84, -2, s69
    s_nop 4
    v_cvt_pk_bf16_f32 v86, v100, v101
    v_cvt_pk_bf16_f32 v87, v102, v103
    buffer_store_dwordx4 v[84:87], v10, s[48:51], s87 offen
    s_cmp_lt_u32 s52, 2
    s_cbranch_scc1 L_RFAST_W01
    s_cmp_eq_u32 s64, 62
    s_cbranch_scc1 L_RFAST_FIN23
    v_mov_b32 v14, 0
    s_nop 1
    v_mfma_f32_32x32x2_f32 v[88:103], v14, v14, 0
    v_mfma_f32_16x16x4_f32 v[104:107], v14, v14, 0
    v_mfma_f32_16x16x4_f32 v[108:111], v14, v14, 0
    ds_read_b128 v[56:59], v2 offset:32768
    ds_read_b128 v[60:63], v2 offset:33792
    ds_read_b128 v[64:67], v2 offset:34816
    ds_read_b128 v[68:71], v2 offset:35840
    ds_read_b128 v[72:75], v2 offset:49152
    ds_read_b128 v[76:79], v2 offset:50176
    ds_read_b128 v[80:83], v2 offset:51200
    ds_read_b128 v[84:87], v2 offset:52224
    s_xor_b32 s69, s69, 1
    s_cmp_ge_u32 s86, 63
    s_cbranch_scc1 L_RFAST_W2
    s_sleep 6
    s_nop 3
    s_waitcnt vmcnt(6)
    v_readlane_b32 s61, v16, 0
    s_nop 0
    s_mul_i32 s61, s61, 4
    s_mov_b32 s86, s61
    v_readlane_b32 s61, v16, 1
    s_nop 0
    s_mul_i32 s61, s61, 4
    s_add_u32 s61, s61, 1
    s_min_u32 s86, s86, s61
    v_readlane_b32 s61, v16, 2
    s_nop 0
    s_mul_i32 s61, s61, 4
    s_add_u32 s61, s61, 2
    s_min_u32 s86, s86, s61
    v_readlane_b32 s61, v16, 3
    s_nop 0
    s_mul_i32 s61, s61, 4
    s_add_u32 s61, s61, 3
    s_min_u32 s86, s86, s61
    s_add_u32 s62, s64, 2
    s_min_u32 s62, s62, 62
    s_mov_b32 s56, 0
L_RFASTN2_CHK:
    s_cmp_gt_u32 s86, s62
    s_cbranch_scc1 L_RFASTN2_OK
    buffer_load_dword v16, v18, s[48:51], s73 offen sc1
    s_waitcnt vmcnt(0)
    v_readlane_b32 s61, v16, 0
    s_nop 0
    s_mul_i32 s61, s61, 4
    s_mov_b32 s86, s61
    v_readlane_b32 s61, v16, 1
    s_nop 0
    s_mul_i32 s61, s61, 4
    s_add_u32 s61, s61, 1
    s_min_u32 s86, s86, s61
    v_readlane_b32 s61, v16, 2
    s_nop 0
    s_mul_i32 s61, s61, 4
    s_add_u32 s61, s61, 2
    s_min_u32 s86, s86, s61
    v_readlane_b32 s61, v16, 3
    s_nop 0
    s_mul_i32 s61, s61, 4
    s_add_u32 s61, s61, 3
    s_min_u32 s86, s86, s61
    s_add_u32 s56, s56, 1
    s_cmp_gt_u32 s56, 60000
    s_cbranch_scc1 L_TIMEOUT_3
    s_branch L_RFASTN2_CHK
.p2align 5
L_RFASTN2_OK:
    s_add_u32 s64, s64, 1
    s_mov_b32 s68, s67
    s_add_u32 s67, s67, 8192
    s_cmp_eq_u32 s67, 90112
    s_cselect_b32 s67, 65536, s67
    s_add_u32 s95, s95, 262144
    s_lshl_b32 s92, s64, 13
    s_add_u32 s92, s92, s34
    s_mov_b32 s3, s84
    s_mov_b32 s84, s83
    s_mov_b32 s83, s85
    s_mov_b32 s85, s3
    s_add_u32 s88, s68, s90
    s_add_u32 s75, s88, 4096
    v_add_u32 v6, s83, v21
    v_add_u32 v7, s84, v22
    s_branch L_RFAST_GATHER
.p2align 5
L_RFAST_W2:
    s_add_u32 s64, s64, 1
    s_mov_b32 s68, s67
    s_add_u32 s67, s67, 8192
    s_cmp_eq_u32 s67, 90112
    s_cselect_b32 s67, 65536, s67
    s_add_u32 s95, s95, 262144
    s_lshl_b32 s92, s64, 13
    s_add_u32 s92, s92, s34
    s_mov_b32 s3, s84
    s_mov_b32 s84, s83
    s_mov_b32 s83, s85
    s_mov_b32 s85, s3
    s_add_u32 s88, s68, s90
    s_add_u32 s75, s88, 4096
    v_add_u32 v6, s83, v21
    v_add_u32 v7, s84, v22
    s_sleep 7
    s_nop 7
    s_branch L_RFAST_GATHER
.p2align 5
L_RFAST_W01:
    s_mov_b32 s61, s67
    s_mov_b32 s62, s68
    ds_read_b128 v[56:59], v2 offset:32768
    ds_read_b128 v[60:63], v2 offset:33792
    ds_read_b128 v[64:67], v2 offset:34816
    ds_read_b128 v[68:71], v2 offset:35840
    ds_read_b128 v[72:75], v2 offset:49152
    ds_read_b128 v[76:79], v2 offset:50176
    ds_read_b128 v[80:83], v2 offset:51200
    ds_read_b128 v[84:87], v2 offset:52224
    s_add_u32 s64, s64, 1
    s_mov_b32 s68, s67
    s_add_u32 s67, s67, 8192
    s_cmp_eq_u32 s67, 90112
    s_cselect_b32 s67, 65536, s67
    s_add_u32 s95, s95, 262144
    s_lshl_b32 s92, s64, 13
    s_add_u32 s92, s92, s34
    s_mov_b32 s3, s84
    s_mov_b32 s84, s83
    s_mov_b32 s83, s85
    s_mov_b32 s85, s3
    s_add_u32 s88, s68, s90
    s_add_u32 s75, s88, 4096
    v_add_u32 v6, s83, v21
    v_add_u32 v7, s84, v22
    s_nop 3
    s_cmp_eq_u32 s52, 0
    s_cbranch_scc1 L_RFAST_RL0
    s_nop 15
    s_nop 15
    s_nop 11
L_RFAST_RL0:
    buffer_load_dwordx4 v[24:27], v1, s[48:51], s72 offen offset:0 sc1
    buffer_load_dwordx4 v[28:31], v1, s[48:51], s72 offen offset:1024 sc1
    buffer_load_dwordx4 v[32:35], v1, s[48:51], s72 offen offset:2048 sc1
    buffer_load_dwordx4 v[36:39], v1, s[48:51], s72 offen offset:3072 sc1
    v_mov_b32 v14, 0
    s_nop 1
    v_mfma_f32_32x32x2_f32 v[88:103], v14, v14, 0
    v_mfma_f32_16x16x4_f32 v[104:107], v14, v14, 0
    v_mfma_f32_16x16x4_f32 v[108:111], v14, v14, 0
    buffer_load_dwordx4 v[40:43], v1, s[48:51], s72 offen offset:0 sc1
    buffer_load_dwordx4 v[44:47], v1, s[48:51], s72 offen offset:1024 sc1
    buffer_load_dwordx4 v[48:51], v1, s[48:51], s72 offen offset:2048 sc1
    buffer_load_dwordx4 v[52:55], v1, s[48:51], s72 offen offset:3072 sc1
L_RFAST_RC:
    s_waitcnt vmcnt(7)
    v_mfma_f32_16x16x32_bf16 v[116:119], v[24:27], v[16:19], 0
    s_waitcnt vmcnt(6)
    v_mfma_f32_16x16x32_bf16 v[116:119], v[28:31], v[16:19], v[116:119]
    v_bitop3_b32 v14, v24, v28, s69 bitop3:0x7e
    s_waitcnt vmcnt(5)
    v_mfma_f32_16x16x32_bf16 v[116:119], v[32:35], v[16:19], v[116:119]
    s_waitcnt vmcnt(4)
    v_mfma_f32_16x16x32_bf16 v[116:119], v[36:39], v[16:19], v[116:119]
    v_bitop3_b32 v15, v32, v36, s69 bitop3:0x7e
    v_bitop3_b32 v14, v14, v15, 1 bitop3:0xa8
    v_cmp_ne_u32 vcc, 0, v14
    s_cbranch_vccnz L_RFAST_RF1
    s_nop 3
    v_permlane32_swap_b32 v116, v118
    v_permlane32_swap_b32 v117, v119
    v_add_f32 v116, v116, v118
    v_add_f32 v117, v117, v119
    s_mov_b64 exec, s[76:77]
    v_cvt_pk_bf16_f32 v124, v116, v117
    buffer_store_dword v124, v11, s[48:51], s61 offen
L_RFAST_ROK:
    s_cmp_eq_u32 s64, 63
    s_cbranch_scc1 L_RFAST_LAST
    buffer_store_dword v20, v11, s[48:51], s62 offen
    s_mov_b64 exec, -1
    s_xor_b32 s69, s69, 1
    s_cmp_eq_u32 s52, 1
    s_cbranch_scc1 L_RFAST_GATHER
    s_nop 7
    s_branch L_RFAST_GATHER
.p2align 5
L_RFAST_FLG:
    buffer_load_dword v16, v18, s[48:51], s73 offen sc1
    s_branch L_RFAST_FLB
.p2align 5
L_RFAST_GR:
    buffer_load_dwordx4 v[52:55], v1, s[48:51], s88 offen sc1
    s_waitcnt vmcnt(1)
    ds_write_b128 v13, v[48:51]
    v_fma_f32 v14, v48, v49, v50
    v_cmp_u_f32 vcc, v14, v51
    s_cbranch_vccz L_RFAST_GOK
    s_add_u32 s56, s56, 1
    s_cmp_gt_u32 s56, 60000
    s_cbranch_scc1 L_TIMEOUT_4
    s_and_b32 s3, s56, 63
    s_cbranch_scc1 L_RFAST_GNX
    s_mov_b64 s[96:97], 0
    v_cmp_eq_u32 vcc, v48, v20
    s_nop 0
    s_or_b64 s[96:97], s[96:97], vcc
    v_cmp_eq_u32 vcc, v49, v20
    s_nop 0
    s_or_b64 s[96:97], s[96:97], vcc
    v_cmp_eq_u32 vcc, v50, v20
    s_nop 0
    s_or_b64 s[96:97], s[96:97], vcc
    v_cmp_eq_u32 vcc, v51, v20
    s_nop 0
    s_or_b64 s[96:97], s[96:97], vcc
    s_cbranch_scc0 L_RFAST_GOK
L_RFAST_GNX:
    buffer_load_dwordx4 v[48:51], v1, s[48:51], s88 offen sc1
    s_branch L_RFAST_GL
.p2align 5
L_RFAST_RF1:
    s_waitcnt vmcnt(3)
    v_mfma_f32_16x16x32_bf16 v[116:119], v[40:43], v[16:19], 0
    s_waitcnt vmcnt(2)
    v_mfma_f32_16x16x32_bf16 v[116:119], v[44:47], v[16:19], v[116:119]
    v_bitop3_b32 v14, v40, v44, s69 bitop3:0x7e
    s_waitcnt vmcnt(1)
    v_mfma_f32_16x16x32_bf16 v[116:119], v[48:51], v[16:19], v[116:119]
    s_waitcnt vmcnt(0)
    v_mfma_f32_16x16x32_bf16 v[116:119], v[52:55], v[16:19], v[116:119]
    v_bitop3_b32 v15, v48, v52, s69 bitop3:0x7e
    v_bitop3_b32 v14, v14, v15, 1 bitop3:0xa8
    v_cmp_ne_u32 vcc, 0, v14
    s_cbranch_vccnz L_RFAST_RF2
    s_nop 3
    v_permlane32_swap_b32 v116, v118
    v_permlane32_swap_b32 v117, v119
    v_add_f32 v116, v116, v118
    v_add_f32 v117, v117, v119
    s_mov_b64 exec, s[76:77]
    v_cvt_pk_bf16_f32 v124, v116, v117
    buffer_store_dword v124, v11, s[48:51], s61 offen
    s_branch L_RFAST_ROK
.p2align 5
L_RFAST_RF2:
    buffer_load_dwordx4 v[24:27], v1, s[48:51], s72 offen offset:0 sc1
    buffer_load_dwordx4 v[28:31], v1, s[48:51], s72 offen offset:1024 sc1
    buffer_load_dwordx4 v[32:35], v1, s[48:51], s72 offen offset:2048 sc1
    buffer_load_dwordx4 v[36:39], v1, s[48:51], s72 offen offset:3072 sc1
    s_nop 15
    s_nop 15
    buffer_load_dwordx4 v[40:43], v1, s[48:51], s72 offen offset:0 sc1
    buffer_load_dwordx4 v[44:47], v1, s[48:51], s72 offen offset:1024 sc1
    buffer_load_dwordx4 v[48:51], v1, s[48:51], s72 offen offset:2048 sc1
    buffer_load_dwordx4 v[52:55], v1, s[48:51], s72 offen offset:3072 sc1
    s_add_u32 s56, s56, 1
    s_cmp_gt_u32 s56, 60000
    s_cbranch_scc1 L_TIMEOUT_5
    s_branch L_RFAST_RC
.p2align 5
L_RFAST_G1RETRY:
    s_add_u32 s56, s56, 1
    s_cmp_gt_u32 s56, 60000
    s_cbranch_scc1 L_TIMEOUT_9
    s_and_b32 s3, s56, 63
    s_cbranch_scc1 L_RFAST_G1L
    s_mov_b64 s[96:97], 0
    v_cmp_eq_u32 vcc, v52, v20
    s_nop 0
    s_or_b64 s[96:97], s[96:97], vcc
    v_cmp_eq_u32 vcc, v53, v20
    s_nop 0
    s_or_b64 s[96:97], s[96:97], vcc
    v_cmp_eq_u32 vcc, v54, v20
    s_nop 0
    s_or_b64 s[96:97], s[96:97], vcc
    v_cmp_eq_u32 vcc, v55, v20
    s_nop 0
    s_or_b64 s[96:97], s[96:97], vcc
    s_cbranch_scc0 L_RFAST_G1OK
L_RFAST_G1L:
    buffer_load_dwordx4 v[52:55], v1, s[48:51], s75 offen sc1
    s_sleep 3
    s_waitcnt vmcnt(0)
    ds_write_b128 v13, v[52:55] offset:4096
    v_fma_f32 v14, v52, v53, v54
    v_cmp_u_f32 vcc, v14, v55
    s_waitcnt lgkmcnt(0)
    s_cbranch_vccnz L_RFAST_G1RETRY
    s_branch L_RFAST_G1OK
.p2align 5
L_RFAST_BIGMEM:
    v_max3_f32 v70, v24, v25, v26
    v_max3_f32 v71, v27, v28, v29
    v_max3_f32 v70, v70, v30, v31
    v_max3_f32 v71, v71, v32, v33
    v_max_f32 v70, v70, v71
    v_mov_b32 v71, v70
    s_nop 1
    v_permlane16_swap_b32 v70, v71
    v_max_f32 v70, v70, v71
    v_mov_b32 v71, v70
    s_nop 1
    v_permlane32_swap_b32 v70, v71
    v_max_f32 v70, v70, v71
    v_sub_f32 v96, v24, v70
    v_sub_f32 v97, v25, v70
    v_sub_f32 v98, v26, v70
    v_sub_f32 v99, v27, v70
    v_sub_f32 v100, v28, v70
    v_sub_f32 v101, v29, v70
    v_sub_f32 v102, v30, v70
    v_sub_f32 v103, v31, v70
    v_sub_f32 v34, v32, v70
    v_sub_f32 v35, v33, v70
    v_exp_f32 v96, v96
    v_exp_f32 v97, v97
    v_exp_f32 v98, v98
    v_exp_f32 v99, v99
    v_exp_f32 v100, v100
    v_exp_f32 v101, v101
    v_exp_f32 v102, v102
    v_exp_f32 v103, v103
    v_exp_f32 v34, v34
    v_exp_f32 v35, v35
    v_cvt_pk_bf16_f32 v52, v96, v97
    v_cvt_pk_bf16_f32 v53, v98, v99
    v_cvt_pk_bf16_f32 v54, v100, v101
    v_cvt_pk_bf16_f32 v55, v102, v103
    v_cvt_pk_bf16_f32 v42, v34, v35
    v_cvt_pk_bf16_f32 v43, v34, v35
    s_nop 1
    v_mfma_f32_16x16x16_bf16 v[120:123], v[40:41], v[42:43], 0
    v_mfma_f32_16x16x16_bf16 v[112:115], v[104:105], v[42:43], 0
    v_mfma_f32_16x16x16_bf16 v[116:119], v[106:107], v[42:43], 0
    v_mfma_f32_16x16x32_bf16 v[120:123], v[36:39], v[52:55], v[120:123]
    v_mfma_f32_16x16x32_bf16 v[112:115], v[44:47], v[52:55], v[112:115]
    v_mfma_f32_16x16x32_bf16 v[116:119], v[48:51], v[52:55], v[116:119]
    s_nop 7
    s_branch L_RFAST_SMOK
.p2align 5
L_RFAST_FIN23:
    v_mov_b32 v14, 0
    s_nop 1
    v_mfma_f32_32x32x2_f32 v[88:103], v14, v14, 0
    v_mfma_f32_16x16x4_f32 v[104:107], v14, v14, 0
    v_mfma_f32_16x16x4_f32 v[108:111], v14, v14, 0
    s_add_u32 s64, s64, 1
    s_mov_b32 s68, s67
    s_add_u32 s67, s67, 8192
    s_cmp_eq_u32 s67, 90112
    s_cselect_b32 s67, 65536, s67
    s_add_u32 s95, s95, 262144
    s_lshl_b32 s92, s64, 13
    s_add_u32 s92, s92, s34
    s_mov_b32 s3, s84
    s_mov_b32 s84, s83
    s_mov_b32 s83, s85
    s_mov_b32 s85, s3
    s_add_u32 s88, s68, s90
    s_add_u32 s75, s88, 4096
    s_sleep 7
    s_nop 7
    s_branch L_RFAST_FIN
.p2align 5
L_RFAST_LAST:
    s_mov_b64 exec, -1
L_RFAST_FIN:
    s_waitcnt lgkmcnt(0)
    ds_read_b128 v[56:59], v23 offset:0
    ds_read_b128 v[60:63], v23 offset:1024
    ds_read_b128 v[64:67], v23 offset:2048
    ds_read_b128 v[68:71], v23 offset:3072
    ds_read_b128 v[72:75], v23 offset:16384
    ds_read_b128 v[76:79], v23 offset:17408
    ds_read_b128 v[80:83], v23 offset:18432
    ds_read_b128 v[84:87], v23 offset:19456
    s_mov_b32 s56, 0
L_RFAST_FG:
    buffer_load_dwordx4 v[48:51], v1, s[48:51], s88 offen sc1
    buffer_load_dwordx4 v[52:55], v1, s[48:51], s75 offen sc1
    s_waitcnt vmcnt(0)
    ds_write_b128 v13, v[48:51]
    ds_write_b128 v13, v[52:55] offset:4096
    v_fma_f32 v14, v48, v49, v50
    v_fma_f32 v14, v51, v52, v14
    v_fma_f32 v14, v53, v54, v14
    v_cmp_u_f32 vcc, v14, v55
    s_cbranch_vccz L_RFAST_FOK
    s_add_u32 s56, s56, 1
    s_cmp_gt_u32 s56, 60000
    s_cbranch_scc1 L_TIMEOUT_4
    s_and_b32 s3, s56, 63
    s_cbranch_scc1 L_RFAST_FG
    s_mov_b64 s[96:97], 0
    v_cmp_eq_u32 vcc, v48, v20
    s_nop 0
    s_or_b64 s[96:97], s[96:97], vcc
    v_cmp_eq_u32 vcc, v49, v20
    s_nop 0
    s_or_b64 s[96:97], s[96:97], vcc
    v_cmp_eq_u32 vcc, v50, v20
    s_nop 0
    s_or_b64 s[96:97], s[96:97], vcc
    v_cmp_eq_u32 vcc, v51, v20
    s_nop 0
    s_or_b64 s[96:97], s[96:97], vcc
    v_cmp_eq_u32 vcc, v52, v20
    s_nop 0
    s_or_b64 s[96:97], s[96:97], vcc
    v_cmp_eq_u32 vcc, v53, v20
    s_nop 0
    s_or_b64 s[96:97], s[96:97], vcc
    v_cmp_eq_u32 vcc, v54, v20
    s_nop 0
    s_or_b64 s[96:97], s[96:97], vcc
    v_cmp_eq_u32 vcc, v55, v20
    s_nop 0
    s_or_b64 s[96:97], s[96:97], vcc
    s_cbranch_scc0 L_RFAST_FOK
    s_branch L_RFAST_FG
.p2align 5
L_RFAST_FOK:
    s_waitcnt lgkmcnt(0)
    s_barrier
    ds_read_b128 v[32:35], v3 offset:2048
    ds_read_b128 v[36:39], v3 offset:3072
    ds_read_b128 v[24:27], v3 offset:0
    ds_read_b128 v[28:31], v3 offset:1024
    ds_read_b128 v[40:43], v3 offset:4096
    ds_read_b128 v[44:47], v3 offset:5120
    ds_read_b128 v[48:51], v3 offset:6144
    ds_read_b128 v[52:55], v3 offset:7168
    s_mov_b64 exec, s[38:39]
    buffer_store_dword v124, v11, s[48:51], s92 offen sc1
    s_mov_b64 exec, -1
    s_waitcnt lgkmcnt(7)
    v_smfmac_f32_16x16x64_bf16 v[96:99], v[32:35], v[56:63], v12
    ds_read_b128 v[56:59], v23 offset:32768
    ds_read_b128 v[60:63], v23 offset:33792
    v_smfmac_f32_16x16x64_bf16 v[100:103], v[32:35], v[64:71], v12
    ds_read_b128 v[64:67], v23 offset:34816
    ds_read_b128 v[68:71], v23 offset:35840
    s_waitcnt lgkmcnt(10)
    v_smfmac_f32_16x16x64_bf16 v[96:99], v[36:39], v[72:79], v12
    ds_read_b128 v[72:75], v23 offset:49152
    ds_read_b128 v[76:79], v23 offset:50176
    v_smfmac_f32_16x16x64_bf16 v[100:103], v[36:39], v[80:87], v12
    ds_read_b128 v[80:83], v23 offset:51200
    ds_read_b128 v[84:87], v23 offset:52224
    s_waitcnt lgkmcnt(13)
    v_smfmac_f32_16x16x64_bf16 v[96:99], v[24:27], v[192:199], v12
    v_smfmac_f32_16x16x64_bf16 v[100:103], v[24:27], v[200:207], v12
    s_waitcnt lgkmcnt(12)
    v_smfmac_f32_16x16x64_bf16 v[96:99], v[28:31], v[208:215], v12
    v_smfmac_f32_16x16x64_bf16 v[100:103], v[28:31], v[216:223], v12
    s_waitcnt lgkmcnt(9)
    v_smfmac_f32_16x16x64_bf16 v[96:99], v[48:51], v[224:231], v12
    v_smfmac_f32_16x16x64_bf16 v[100:103], v[48:51], v[232:239], v12
    s_waitcnt lgkmcnt(8)
    v_smfmac_f32_16x16x64_bf16 v[96:99], v[52:55], v[240:247], v12
    v_smfmac_f32_16x16x64_bf16 v[100:103], v[52:55], v[248:255], v12
    s_waitcnt lgkmcnt(6)
    v_smfmac_f32_16x16x64_bf16 v[96:99], v[40:43], v[56:63], v12
    s_waitcnt lgkmcnt(4)
    v_smfmac_f32_16x16x64_bf16 v[100:103], v[40:43], v[64:71], v12
    s_waitcnt lgkmcnt(2)
    v_smfmac_f32_16x16x64_bf16 v[96:99], v[44:47], v[72:79], v12
    s_waitcnt lgkmcnt(0)
    v_smfmac_f32_16x16x64_bf16 v[100:103], v[44:47], v[80:87], v12
    v_smfmac_f32_16x16x64_bf16 v[104:107], v[24:27], a[96:103], v12
    v_smfmac_f32_16x16x64_bf16 v[108:111], v[24:27], a[104:111], v12
    v_smfmac_f32_16x16x64_bf16 v[104:107], v[28:31], a[112:119], v12
    v_smfmac_f32_16x16x64_bf16 v[108:111], v[28:31], a[120:127], v12
    s_barrier
    s_nop 0
    v_add_f32 v96, v96, v98
    v_add_f32 v97, v97, v99
    v_cvt_pk_bf16_f32 v90, v96, v97
    v_add_f32 v100, v100, v102
    v_add_f32 v101, v101, v103
    v_cvt_pk_bf16_f32 v94, v100, v101
    ds_write2_b32 v9, v90, v94 offset0:0 offset1:128
    v_add_u32 v14, s90, v0
    v_add_u32 v119, s90, v5
    v_smfmac_f32_16x16x64_bf16 v[104:107], v[40:43], a[160:167], v12
    v_smfmac_f32_16x16x64_bf16 v[108:111], v[40:43], a[168:175], v12
    v_smfmac_f32_16x16x64_bf16 v[104:107], v[44:47], a[176:183], v12
    v_smfmac_f32_16x16x64_bf16 v[108:111], v[44:47], a[184:191], v12
    s_waitcnt lgkmcnt(0)
    s_barrier
    ds_read_b64_tr_b16 v[112:113], v14 offset:0
    ds_read_b64_tr_b16 v[114:115], v119 offset:256
    v_lshrrev_b32 v15, 4, v1
    v_bfe_u32 v116, v15, 0, 1
    v_mul_u32_u24 v116, 16, v116
    v_bfe_u32 v118, v15, 2, 4
    v_mul_u32_u24 v118, 32, v118
    v_add_u32 v116, v116, v118
    v_bfe_u32 v117, v15, 0, 4
    v_mul_u32_u24 v117, 8, v117
    v_bfe_u32 v118, v15, 4, 1
    v_mul_u32_u24 v118, 4, v118
    v_add_u32 v117, v117, v118
    v_bfe_u32 v118, v15, 5, 1
    v_mul_u32_u24 v118, 256, v118
    v_add_u32 v117, v117, v118
    s_lshl_b32 s61, s53, 12
    s_lshr_b32 s3, s90, 1
    s_add_u32 s61, s61, s3
    s_add_u32 s62, s61, 16646144
    s_add_u32 s61, s61, 58589184
    v_smfmac_f32_16x16x64_bf16 v[104:107], v[48:51], a[192:199], v12
    v_smfmac_f32_16x16x64_bf16 v[108:111], v[48:51], a[200:207], v12
    v_smfmac_f32_16x16x64_bf16 v[104:107], v[52:55], a[208:215], v12
    v_smfmac_f32_16x16x64_bf16 v[108:111], v[52:55], a[216:223], v12
    s_waitcnt lgkmcnt(0)
    s_mov_b64 exec, s[80:81]
    buffer_store_dwordx4 v[112:115], v116, s[48:51], s61 offen sc1
    s_mov_b64 exec, -1
    v_smfmac_f32_16x16x64_bf16 v[104:107], v[32:35], a[128:135], v12
    v_smfmac_f32_16x16x64_bf16 v[108:111], v[32:35], a[136:143], v12
    v_smfmac_f32_16x16x64_bf16 v[104:107], v[36:39], a[144:151], v12
    v_smfmac_f32_16x16x64_bf16 v[108:111], v[36:39], a[152:159], v12
    s_nop 6
    v_add_f32 v104, v104, v106
    v_add_f32 v105, v105, v107
    v_cvt_pk_bf16_f32 v104, v104, v105
    buffer_store_dword v104, v117, s[48:51], s62 offen offset:0 sc1
    v_add_f32 v108, v108, v110
    v_add_f32 v109, v109, v111
    v_cvt_pk_bf16_f32 v108, v108, v109
    buffer_store_dword v108, v117, s[48:51], s62 offen offset:128 sc1
L_RFAST_EXIT:
    s_endpgm
.p2align 5
L_R_SLOW_ENTRY:
    ds_read_b128 v[56:59], v2 offset:32768
    ds_read_b128 v[60:63], v2 offset:33792
    ds_read_b128 v[64:67], v2 offset:34816
    ds_read_b128 v[68:71], v2 offset:35840
    ds_read_b128 v[72:75], v2 offset:49152
    ds_read_b128 v[76:79], v2 offset:50176
    ds_read_b128 v[80:83], v2 offset:51200
    ds_read_b128 v[84:87], v2 offset:52224
    v_mov_b32 v14, 0
    s_nop 1
    v_mfma_f32_32x32x2_f32 v[88:103], v14, v14, 0
    v_mfma_f32_16x16x4_f32 v[104:107], v14, v14, 0
    v_mfma_f32_16x16x4_f32 v[108:111], v14, v14, 0
    v_add_u32 v6, s83, v21
    v_add_u32 v7, s84, v22
    s_add_u32 s88, s68, s90
    s_add_u32 s75, s88, 4096
    s_mov_b32 s94, s89
    s_cmp_ge_u32 s52, 2
    s_cselect_b64 s[42:43], -1, 0
    s_add_u32 s95, s82, s94
    s_mov_b32 s86, 64
    s_cmp_lg_u32 s52, 3
    s_cbranch_scc1 L_RSLOW_GATHER
    s_mov_b32 s86, 0
    s_cmp_eq_u32 s93, 1
    s_cbranch_scc1 L_RSLOW_E1
    s_add_u32 s62, s64, 0
    s_min_u32 s62, s62, 62
    s_mov_b32 s56, 0
L_RSLOWN0_CHK:
    s_cmp_gt_u32 s86, s62
    s_cbranch_scc1 L_RSLOWN0_OK
    buffer_load_dword v16, v18, s[48:51], s73 offen sc1
    s_waitcnt vmcnt(0)
    v_readlane_b32 s61, v16, 0
    s_nop 0
    s_mul_i32 s61, s61, 4
    s_mov_b32 s86, s61
    v_readlane_b32 s61, v16, 1
    s_nop 0
    s_mul_i32 s61, s61, 4
    s_add_u32 s61, s61, 1
    s_min_u32 s86, s86, s61
    v_readlane_b32 s61, v16, 2
    s_nop 0
    s_mul_i32 s61, s61, 4
    s_add_u32 s61, s61, 2
    s_min_u32 s86, s86, s61
    v_readlane_b32 s61, v16, 3
    s_nop 0
    s_mul_i32 s61, s61, 4
    s_add_u32 s61, s61, 3
    s_min_u32 s86, s86, s61
    s_add_u32 s56, s56, 1
    s_cmp_gt_u32 s56, 60000
    s_cbranch_scc1 L_TIMEOUT_3
    s_branch L_RSLOWN0_CHK
.p2align 5
L_RSLOWN0_OK:
    s_lshl_b32 s61, s53, 13
    s_add_u32 s71, s61, 16777216
    s_mov_b32 m0, 139264
    s_nop 0
    buffer_load_dwordx4 v1, s[48:51], s71 offen offset:0 sc1 lds
    buffer_load_dwordx4 v1, s[48:51], s71 offen offset:1024 sc1 lds
    buffer_load_dwordx4 v1, s[48:51], s71 offen offset:2048 sc1 lds
    buffer_load_dwordx4 v1, s[48:51], s71 offen offset:3072 sc1 lds
    s_add_u32 s71, s61, 16781312
    s_mov_b32 m0, 143360
    s_nop 0
    buffer_load_dwordx4 v1, s[48:51], s71 offen offset:0 sc1 lds
    buffer_load_dwordx4 v1, s[48:51], s71 offen offset:1024 sc1 lds
    buffer_load_dwordx4 v1, s[48:51], s71 offen offset:2048 sc1 lds
    buffer_load_dwordx4 v1, s[48:51], s71 offen offset:3072 sc1 lds
    s_add_u32 s71, s61, 33554432
    s_mov_b32 m0, 147456
    s_nop 0
    buffer_load_dwordx4 v1, s[48:51], s71 offen offset:0 sc1 lds
    buffer_load_dwordx4 v1, s[48:51], s71 offen offset:1024 sc1 lds
    buffer_load_dwordx4 v1, s[48:51], s71 offen offset:2048 sc1 lds
    buffer_load_dwordx4 v1, s[48:51], s71 offen offset:3072 sc1 lds
    s_add_u32 s71, s61, 33558528
    s_mov_b32 m0, 151552
    s_nop 0
    buffer_load_dwordx4 v1, s[48:51], s71 offen offset:0 sc1 lds
    buffer_load_dwordx4 v1, s[48:51], s71 offen offset:1024 sc1 lds
    buffer_load_dwordx4 v1, s[48:51], s71 offen offset:2048 sc1 lds
    buffer_load_dwordx4 v1, s[48:51], s71 offen offset:3072 sc1 lds
    s_branch L_RSLOW_E2
.p2align 5
L_RSLOW_E1:
    v_mov_b32 v16, v115
    s_nop 0
    v_readlane_b32 s61, v16, 0
    s_nop 0
    s_mul_i32 s61, s61, 4
    s_mov_b32 s86, s61
    v_readlane_b32 s61, v16, 1
    s_nop 0
    s_mul_i32 s61, s61, 4
    s_add_u32 s61, s61, 1
    s_min_u32 s86, s86, s61
    v_readlane_b32 s61, v16, 2
    s_nop 0
    s_mul_i32 s61, s61, 4
    s_add_u32 s61, s61, 2
    s_min_u32 s86, s86, s61
    v_readlane_b32 s61, v16, 3
    s_nop 0
    s_mul_i32 s61, s61, 4
    s_add_u32 s61, s61, 3
    s_min_u32 s86, s86, s61
L_RSLOW_E2:
    s_add_u32 s62, s64, 1
    s_min_u32 s62, s62, 62
    s_mov_b32 s56, 0
L_RSLOWN1_CHK:
    s_cmp_gt_u32 s86, s62
    s_cbranch_scc1 L_RSLOWN1_OK
    buffer_load_dword v16, v18, s[48:51], s73 offen sc1
    s_waitcnt vmcnt(0)
    v_readlane_b32 s61, v16, 0
    s_nop 0
    s_mul_i32 s61, s61, 4
    s_mov_b32 s86, s61
    v_readlane_b32 s61, v16, 1
    s_nop 0
    s_mul_i32 s61, s61, 4
    s_add_u32 s61, s61, 1
    s_min_u32 s86, s86, s61
    v_readlane_b32 s61, v16, 2
    s_nop 0
    s_mul_i32 s61, s61, 4
    s_add_u32 s61, s61, 2
    s_min_u32 s86, s86, s61
    v_readlane_b32 s61, v16, 3
    s_nop 0
    s_mul_i32 s61, s61, 4
    s_add_u32 s61, s61, 3
    s_min_u32 s86, s86, s61
    s_add_u32 s56, s56, 1
    s_cmp_gt_u32 s56, 60000
    s_cbranch_scc1 L_TIMEOUT_3
    s_branch L_RSLOWN1_CHK
.p2align 5
L_RSLOWN1_OK:
    s_branch L_RSLOW_GATHER
.p2align 6
    s_nop 0
    s_nop 0
    s_nop 0
    s_nop 0
    s_nop 0
L_RSLOW_GATHER:
    s_mov_b32 s56, 0
L_RSLOW_GAG:
    buffer_load_dwordx4 v[52:55], v1, s[48:51], s88 offen sc1
    s_nop 15
    s_nop 15
    s_nop 7
    buffer_load_dwordx4 v[48:51], v1, s[48:51], s88 offen sc1
L_RSLOW_GL:
    s_waitcnt vmcnt(1)
    ds_write_b128 v13, v[52:55]
    v_fma_f32 v14, v52, v53, v54
    v_cmp_u_f32 vcc, v14, v55
    s_cbranch_vccnz L_RSLOW_GR
L_RSLOW_GOK:
    buffer_load_dwordx4 v[52:55], v1, s[48:51], s75 offen sc1
    s_waitcnt lgkmcnt(0)
    s_barrier
    ds_read_b128 v[24:27], v3 offset:0
    ds_read_b128 v[28:31], v3 offset:1024
    ds_read_b128 v[32:35], v3 offset:2048
    ds_read_b128 v[36:39], v3 offset:3072
    s_mov_b32 s56, 0
    s_mov_b64 exec, s[76:77]
    s_cmp_lt_u32 s86, 63
    s_cbranch_scc1 L_RSLOW_FLG
    buffer_store_dword v124, v11, s[48:51], s92 offen sc1
L_RSLOW_FLB:
    s_mov_b64 exec, -1
    s_waitcnt lgkmcnt(3)
    v_smfmac_f32_16x16x64_bf16 v[88:91], v[24:27], v[56:63], v12
    ds_read_b128 v[56:59], v23 offset:0
    v_smfmac_f32_16x16x64_bf16 v[92:95], v[24:27], v[64:71], v12
    ds_read_b128 v[60:63], v23 offset:1024
    s_waitcnt lgkmcnt(4)
    v_smfmac_f32_16x16x64_bf16 v[88:91], v[28:31], v[72:79], v12
    ds_read_b128 v[64:67], v23 offset:2048
    v_smfmac_f32_16x16x64_bf16 v[92:95], v[28:31], v[80:87], v12
    ds_read_b128 v[68:71], v23 offset:3072
    s_waitcnt lgkmcnt(5)
    v_smfmac_f32_16x16x64_bf16 v[88:91], v[32:35], a[224:231], v12
    ds_read_b128 v[72:75], v23 offset:16384
    v_smfmac_f32_16x16x64_bf16 v[92:95], v[32:35], a[232:239], v12
    ds_read_b128 v[76:79], v23 offset:17408
    s_waitcnt lgkmcnt(6)
    v_smfmac_f32_16x16x64_bf16 v[88:91], v[36:39], a[240:247], v12
    ds_read_b128 v[80:83], v23 offset:18432
    v_smfmac_f32_16x16x64_bf16 v[92:95], v[36:39], a[248:255], v12
    ds_read_b128 v[84:87], v23 offset:19456
    v_smfmac_f32_16x16x64_bf16 v[96:99], v[24:27], v[192:199], v12
    s_add_u32 s71, s95, 17039360
    s_add_u32 m0, s94, s85
    v_smfmac_f32_16x16x64_bf16 v[100:103], v[24:27], v[200:207], v12
    s_waitcnt vmcnt(1)
    ds_write_b128 v13, v[52:55] offset:4096
    v_smfmac_f32_16x16x64_bf16 v[96:99], v[28:31], v[208:215], v12
    v_fma_f32 v14, v52, v53, v54
    v_smfmac_f32_16x16x64_bf16 v[100:103], v[28:31], v[216:223], v12
    s_waitcnt lgkmcnt(5)
    v_cmp_u_f32 vcc, v14, v55
    v_smfmac_f32_16x16x64_bf16 v[96:99], v[32:35], v[56:63], v12
    ds_read_b128 v[56:59], v23 offset:32768
    s_cbranch_vccnz L_RSLOW_G1RETRY
L_RSLOW_G1OK:
    v_smfmac_f32_16x16x64_bf16 v[100:103], v[32:35], v[64:71], v12
    ds_read_b128 v[60:63], v23 offset:33792
    s_waitcnt lgkmcnt(3)
    v_smfmac_f32_16x16x64_bf16 v[96:99], v[36:39], v[72:79], v12
    v_smfmac_f32_16x16x64_bf16 v[100:103], v[36:39], v[80:87], v12
    s_waitcnt lgkmcnt(2)
    s_barrier
    ds_read_b128 v[40:43], v3 offset:4096
    v_smfmac_f32_16x16x64_bf16 v[104:107], v[24:27], a[96:103], v12
    ds_read_b128 v[44:47], v3 offset:5120
    v_smfmac_f32_16x16x64_bf16 v[108:111], v[24:27], a[104:111], v12
    ds_read_b128 v[48:51], v3 offset:6144
    v_smfmac_f32_16x16x64_bf16 v[104:107], v[28:31], a[112:119], v12
    ds_read_b128 v[52:55], v3 offset:7168
    v_smfmac_f32_16x16x64_bf16 v[108:111], v[28:31], a[120:127], v12
    ds_read_b128 v[64:67], v23 offset:34816
    s_waitcnt lgkmcnt(4)
    v_smfmac_f32_16x16x64_bf16 v[88:91], v[40:43], v[128:135], v12
    ds_read_b128 v[68:71], v23 offset:35840
    v_smfmac_f32_16x16x64_bf16 v[92:95], v[40:43], v[136:143], v12
    ds_read_b128 v[72:75], v23 offset:49152
    s_waitcnt lgkmcnt(5)
    v_smfmac_f32_16x16x64_bf16 v[88:91], v[44:47], v[144:151], v12
    ds_read_b128 v[76:79], v23 offset:50176
    v_smfmac_f32_16x16x64_bf16 v[92:95], v[44:47], v[152:159], v12
    ds_read_b128 v[80:83], v23 offset:51200
    s_waitcnt lgkmcnt(6)
    v_smfmac_f32_16x16x64_bf16 v[88:91], v[48:51], v[160:167], v12
    ds_read_b128 v[84:87], v23 offset:52224
    v_smfmac_f32_16x16x64_bf16 v[92:95], v[48:51], v[168:175], v12
    s_waitcnt lgkmcnt(6)
    v_smfmac_f32_16x16x64_bf16 v[88:91], v[52:55], v[176:183], v12
    v_smfmac_f32_16x16x64_bf16 v[92:95], v[52:55], v[184:191], v12
    s_waitcnt lgkmcnt(4)
    v_smfmac_f32_16x16x64_bf16 v[96:99], v[40:43], v[56:63], v12
    ds_read_b128 v[56:59], v6 offset:0
    v_smfmac_f32_16x16x64_bf16 v[100:103], v[40:43], v[64:71], v12
    ds_read_b128 v[60:63], v6 offset:256
    s_waitcnt lgkmcnt(2)
    v_smfmac_f32_16x16x64_bf16 v[96:99], v[44:47], v[72:79], v12
    ds_read_b128 v[64:67], v6 offset:2048
    v_add_f32 v88, v88, v90
    v_add_f32 v89, v89, v91
    v_smfmac_f32_16x16x64_bf16 v[100:103], v[44:47], v[80:87], v12
    ds_read_b128 v[68:71], v6 offset:2304
    v_mul_f32 v88, s78, v88
    v_mul_f32 v89, s78, v89
    v_smfmac_f32_16x16x64_bf16 v[96:99], v[48:51], v[224:231], v12
    ds_read_b128 v[72:75], v6 offset:4096
    v_cvt_pk_bf16_f32 v91, v88, v89
    v_smfmac_f32_16x16x64_bf16 v[100:103], v[48:51], v[232:239], v12
    ds_read_b128 v[76:79], v6 offset:4352
    v_add_f32 v92, v92, v94
    v_smfmac_f32_16x16x64_bf16 v[96:99], v[52:55], v[240:247], v12
    ds_read_b128 v[80:83], v6 offset:6144
    v_add_f32 v93, v93, v95
    v_smfmac_f32_16x16x64_bf16 v[100:103], v[52:55], v[248:255], v12
    ds_read_b128 v[84:87], v6 offset:6400
    v_mul_f32 v92, s78, v92
    v_smfmac_f32_16x16x64_bf16 v[104:107], v[32:35], a[128:135], v12
    v_mul_f32 v93, s78, v93
    v_smfmac_f32_16x16x64_bf16 v[108:111], v[32:35], a[136:143], v12
    v_cvt_pk_bf16_f32 v95, v92, v93
    v_smfmac_f32_16x16x64_bf16 v[104:107], v[36:39], a[144:151], v12
    v_add_f32 v96, v96, v98
    v_add_f32 v97, v97, v99
    v_cvt_pk_bf16_f32 v90, v96, v97
    v_smfmac_f32_16x16x64_bf16 v[108:111], v[36:39], a[152:159], v12
    buffer_load_dwordx4 v1, s[48:51], s71 offen offset:0 sc1 lds
    v_add_f32 v100, v100, v102
    v_add_f32 v101, v101, v103
    v_cvt_pk_bf16_f32 v94, v100, v101
    v_smfmac_f32_16x16x64_bf16 v[104:107], v[40:43], a[160:167], v12
    buffer_load_dwordx4 v1, s[48:51], s71 offen offset:1024 sc1 lds
    ds_write2_b64 v9, v[90:91], v[94:95] offset0:0 offset1:64
    v_smfmac_f32_16x16x64_bf16 v[108:111], v[40:43], a[168:175], v12
    v_mov_b32 v36, 0x3f803f80
    v_smfmac_f32_16x16x64_bf16 v[104:107], v[44:47], a[176:183], v12
    s_add_u32 s71, s95, 33816576
    s_add_u32 m0, s94, s83
    v_mov_b32 v37, 0x3f803f80
    v_smfmac_f32_16x16x64_bf16 v[108:111], v[44:47], a[184:191], v12
    v_mov_b32 v38, 0x3f803f80
    s_waitcnt lgkmcnt(0)
    s_barrier
    v_smfmac_f32_16x16x64_bf16 v[104:107], v[48:51], a[192:199], v12
    ds_read_b64_tr_b16 v[112:113], v0 offset:0
    ds_read_b64_tr_b16 v[114:115], v5 offset:256
    v_mov_b32 v39, 0x3f803f80
    v_smfmac_f32_16x16x64_bf16 v[108:111], v[48:51], a[200:207], v12
    ds_read_b64_tr_b16 v[116:117], v0 offset:1024
    ds_read_b64_tr_b16 v[118:119], v5 offset:1280
    v_smfmac_f32_16x16x64_bf16 v[104:107], v[52:55], a[208:215], v12
    ds_read_b64_tr_b16 v[120:121], v0 offset:2048
    ds_read_b64_tr_b16 v[122:123], v5 offset:2304
    v_smfmac_f32_16x16x64_bf16 v[108:111], v[52:55], a[216:223], v12
    ds_read_b64_tr_b16 v[124:125], v0 offset:3072
    ds_read_b64_tr_b16 v[126:127], v5 offset:3328
    s_waitcnt lgkmcnt(6)
    v_mfma_f32_16x16x32_bf16 v[32:35], v[112:115], v[112:115], 0
    buffer_load_dwordx4 v1, s[48:51], s71 offen offset:0 sc1 lds
    s_waitcnt lgkmcnt(4)
    v_mfma_f32_16x16x32_bf16 v[32:35], v[116:119], v[116:119], v[32:35]
    buffer_load_dwordx4 v1, s[48:51], s71 offen offset:1024 sc1 lds
    s_waitcnt lgkmcnt(2)
    v_mfma_f32_16x16x32_bf16 v[32:35], v[120:123], v[120:123], v[32:35]
    ds_read_b128 v[44:47], v7 offset:0
    s_waitcnt lgkmcnt(1)
    v_mov_b32 v40, 0x3f803f80
    v_mov_b32 v41, 0
    v_mfma_f32_16x16x32_bf16 v[32:35], v[124:127], v[124:127], v[32:35]
    ds_read_b128 v[48:51], v7 offset:256
    v_cvt_pk_bf16_f32 v104, v104, v105
    v_cvt_pk_bf16_f32 v105, v106, v107
    v_mfma_f32_16x16x32_bf16 v[24:27], v[56:59], v[112:115], 0
    v_cvt_pk_bf16_f32 v106, v108, v109
    v_cvt_pk_bf16_f32 v107, v110, v111
    v_mfma_f32_16x16x32_bf16 v[24:27], v[64:67], v[116:119], v[24:27]
    v_mov_b64 v[88:89], 0
    v_mov_b64 v[90:91], 0
    v_mfma_f32_16x16x32_bf16 v[24:27], v[72:75], v[120:123], v[24:27]
    v_exp_f32 v34, v32
    v_mfma_f32_16x16x32_bf16 v[24:27], v[80:83], v[124:127], v[24:27]
    v_exp_f32 v35, v33
    v_mfma_f32_16x16x32_bf16 v[28:31], v[60:63], v[112:115], 0
    v_cvt_pk_bf16_f32 v42, v34, v35
    v_cvt_pk_bf16_f32 v43, v34, v35
    v_mfma_f32_16x16x32_bf16 v[28:31], v[68:71], v[116:119], v[28:31]
    v_max_f32 v109, |v32|, |v33|
    v_mov_b64 v[92:93], 0
    v_mfma_f32_16x16x32_bf16 v[28:31], v[76:79], v[120:123], v[28:31]
    v_exp_f32 v96, v24
    v_mfma_f32_16x16x32_bf16 v[28:31], v[84:87], v[124:127], v[28:31]
    v_exp_f32 v97, v25
    v_mfma_f32_16x16x16_bf16 v[120:123], v[40:41], v[42:43], 0
    v_exp_f32 v98, v26
    v_mfma_f32_16x16x16_bf16 v[112:115], v[104:105], v[42:43], 0
    v_exp_f32 v99, v27
    v_mfma_f32_16x16x16_bf16 v[116:119], v[106:107], v[42:43], 0
    v_cvt_pk_bf16_f32 v52, v96, v97
    v_cvt_pk_bf16_f32 v53, v98, v99
    v_exp_f32 v100, v28
    v_exp_f32 v101, v29
    v_exp_f32 v102, v30
    v_exp_f32 v103, v31
    v_cvt_pk_bf16_f32 v54, v100, v101
    v_cvt_pk_bf16_f32 v55, v102, v103
    v_max3_f32 v108, |v24|, |v25|, |v26|
    s_waitcnt lgkmcnt(0)
    s_mov_b32 s56, 0
    v_mfma_f32_16x16x32_bf16 v[120:123], v[36:39], v[52:55], v[120:123]
    v_max3_f32 v109, v109, |v27|, |v28|
    v_max3_f32 v108, v108, |v29|, |v30|
    v_mfma_f32_16x16x32_bf16 v[112:115], v[44:47], v[52:55], v[112:115]
    v_max3_f32 v108, v108, v109, |v31|
    v_cmp_nge_f32 vcc, 0x41f00000, v108
    v_mfma_f32_16x16x32_bf16 v[116:119], v[48:51], v[52:55], v[116:119]
    v_xor_b32 v76, 512, v8
    s_and_b64 vcc, vcc, s[36:37]
    s_cbranch_scc1 L_RSLOW_BIGMEM
L_RSLOW_SMOK:
    s_mov_b64 exec, s[36:37]
    v_rcp_f32 v70, v120
    s_nop 0
    v_pk_mul_f32 v[112:113], v[112:113], v[70:71] op_sel_hi:[1,0]
    v_pk_mul_f32 v[114:115], v[114:115], v[70:71] op_sel_hi:[1,0]
    v_cvt_pk_bf16_f32 v64, v112, v113
    v_cvt_pk_bf16_f32 v65, v114, v115
    ds_write_b64 v8, v[64:65] offset:0
    v_pk_mul_f32 v[116:117], v[116:117], v[70:71] op_sel_hi:[1,0]
    v_pk_mul_f32 v[118:119], v[118:119], v[70:71] op_sel_hi:[1,0]
    v_cvt_pk_bf16_f32 v66, v116, v117
    v_cvt_pk_bf16_f32 v67, v118, v119
    ds_write_b64 v8, v[66:67] offset:8
    s_mov_b64 exec, -1
    v_mov_b32_dpp v68, v64 quad_perm:[2,3,2,3] row_mask:0xf bank_mask:0xf
    v_mov_b32_dpp v69, v65 quad_perm:[2,3,2,3] row_mask:0xf bank_mask:0xf
    v_mov_b32_dpp v70, v66 quad_perm:[2,3,2,3] row_mask:0xf bank_mask:0xf
    v_mov_b32_dpp v71, v67 quad_perm:[2,3,2,3] row_mask:0xf bank_mask:0xf
    v_xor_b32 v77, 1024, v8
    v_xor_b32 v78, 1536, v8
    v_mov_b64 v[94:95], 0
    v_mov_b64 v[96:97], 0
    v_mov_b64 v[98:99], 0
    v_mov_b64 v[100:101], 0
    v_mov_b64 v[102:103], 0
    v_smfmac_f32_16x16x64_bf16 v[88:91], v[68:71], a[0:7], v12
    s_waitcnt lgkmcnt(0)
    s_barrier
    ds_read_b128 v[56:59], v76
    ds_read_b128 v[60:63], v77
    ds_read_b128 v[72:75], v78
    v_smfmac_f32_16x16x64_bf16 v[92:95], v[68:71], a[32:39], v12
    ds_read_b128 v[24:27], v2 offset:0
    v_smfmac_f32_16x16x64_bf16 v[96:99], v[68:71], a[64:71], v12
    ds_read_b128 v[28:31], v2 offset:1024
    v_smfmac_f32_16x16x64_bf16 v[100:103], v[68:71], a[88:95], v12
    ds_read_b128 v[32:35], v2 offset:2048
    s_waitcnt lgkmcnt(5)
    v_smfmac_f32_16x16x64_bf16 v[88:91], v[56:59], a[8:15], v12
    ds_read_b128 v[36:39], v2 offset:3072
    s_waitcnt lgkmcnt(5)
    v_smfmac_f32_16x16x64_bf16 v[88:91], v[60:63], a[16:23], v12
    ds_read_b128 v[40:43], v2 offset:16384
    s_waitcnt lgkmcnt(5)
    v_smfmac_f32_16x16x64_bf16 v[88:91], v[72:75], a[24:31], v12
    ds_read_b128 v[44:47], v2 offset:17408
    v_smfmac_f32_16x16x64_bf16 v[92:95], v[56:59], a[40:47], v12
    ds_read_b128 v[48:51], v2 offset:18432
    v_smfmac_f32_16x16x64_bf16 v[92:95], v[60:63], a[48:55], v12
    ds_read_b128 v[52:55], v2 offset:19456
    v_smfmac_f32_16x16x64_bf16 v[92:95], v[72:75], a[56:63], v12
    s_nop 1
    v_cvt_pk_bf16_f32 v80, v88, v89
    v_smfmac_f32_16x16x64_bf16 v[96:99], v[56:59], a[72:79], v12
    v_cvt_pk_bf16_f32 v81, v90, v91
    v_smfmac_f32_16x16x64_bf16 v[96:99], v[60:63], a[80:87], v12
    s_waitcnt lgkmcnt(6)
    v_and_or_b32 v80, v80, -2, s69
    v_smfmac_f32_16x16x64_bf16 v[96:99], v[72:75], v[24:31], v12
    s_waitcnt lgkmcnt(4)
    v_cvt_pk_bf16_f32 v82, v92, v93
    v_cvt_pk_bf16_f32 v83, v94, v95
    buffer_store_dwordx4 v[80:83], v10, s[48:51], s65 offen sc1
    v_smfmac_f32_16x16x64_bf16 v[100:103], v[56:59], v[32:39], v12
    s_waitcnt lgkmcnt(2)
    v_smfmac_f32_16x16x64_bf16 v[100:103], v[60:63], v[40:47], v12
    s_waitcnt lgkmcnt(0)
    v_smfmac_f32_16x16x64_bf16 v[100:103], v[72:75], v[48:55], v12
    v_cvt_pk_bf16_f32 v84, v96, v97
    v_cvt_pk_bf16_f32 v85, v98, v99
    v_and_or_b32 v84, v84, -2, s69
    s_nop 4
    v_cvt_pk_bf16_f32 v86, v100, v101
    v_cvt_pk_bf16_f32 v87, v102, v103
    buffer_store_dwordx4 v[84:87], v10, s[48:51], s87 offen sc1
    s_cmp_lt_u32 s52, 2
    s_cbranch_scc1 L_RSLOW_W01
    s_cmp_eq_u32 s64, 62
    s_cbranch_scc1 L_RSLOW_FIN23
    v_mov_b32 v14, 0
    s_nop 1
    v_mfma_f32_32x32x2_f32 v[88:103], v14, v14, 0
    v_mfma_f32_16x16x4_f32 v[104:107], v14, v14, 0
    v_mfma_f32_16x16x4_f32 v[108:111], v14, v14, 0
    ds_read_b128 v[56:59], v2 offset:32768
    ds_read_b128 v[60:63], v2 offset:33792
    ds_read_b128 v[64:67], v2 offset:34816
    ds_read_b128 v[68:71], v2 offset:35840
    ds_read_b128 v[72:75], v2 offset:49152
    ds_read_b128 v[76:79], v2 offset:50176
    ds_read_b128 v[80:83], v2 offset:51200
    ds_read_b128 v[84:87], v2 offset:52224
    s_xor_b32 s69, s69, 1
    s_cmp_ge_u32 s86, 63
    s_cbranch_scc1 L_RSLOW_W2
    s_sleep 6
    s_nop 3
    s_waitcnt vmcnt(6)
    v_readlane_b32 s61, v16, 0
    s_nop 0
    s_mul_i32 s61, s61, 4
    s_mov_b32 s86, s61
    v_readlane_b32 s61, v16, 1
    s_nop 0
    s_mul_i32 s61, s61, 4
    s_add_u32 s61, s61, 1
    s_min_u32 s86, s86, s61
    v_readlane_b32 s61, v16, 2
    s_nop 0
    s_mul_i32 s61, s61, 4
    s_add_u32 s61, s61, 2
    s_min_u32 s86, s86, s61
    v_readlane_b32 s61, v16, 3
    s_nop 0
    s_mul_i32 s61, s61, 4
    s_add_u32 s61, s61, 3
    s_min_u32 s86, s86, s61
    s_add_u32 s62, s64, 2
    s_min_u32 s62, s62, 62
    s_mov_b32 s56, 0
L_RSLOWN2_CHK:
    s_cmp_gt_u32 s86, s62
    s_cbranch_scc1 L_RSLOWN2_OK
    buffer_load_dword v16, v18, s[48:51], s73 offen sc1
    s_waitcnt vmcnt(0)
    v_readlane_b32 s61, v16, 0
    s_nop 0
    s_mul_i32 s61, s61, 4
    s_mov_b32 s86, s61
    v_readlane_b32 s61, v16, 1
    s_nop 0
    s_mul_i32 s61, s61, 4
    s_add_u32 s61, s61, 1
    s_min_u32 s86, s86, s61
    v_readlane_b32 s61, v16, 2
    s_nop 0
    s_mul_i32 s61, s61, 4
    s_add_u32 s61, s61, 2
    s_min_u32 s86, s86, s61
    v_readlane_b32 s61, v16, 3
    s_nop 0
    s_mul_i32 s61, s61, 4
    s_add_u32 s61, s61, 3
    s_min_u32 s86, s86, s61
    s_add_u32 s56, s56, 1
    s_cmp_gt_u32 s56, 60000
    s_cbranch_scc1 L_TIMEOUT_3
    s_branch L_RSLOWN2_CHK
.p2align 5
L_RSLOWN2_OK:
    s_add_u32 s64, s64, 1
    s_mov_b32 s68, s67
    s_add_u32 s67, s67, 8192
    s_cmp_eq_u32 s67, 90112
    s_cselect_b32 s67, 65536, s67
    s_add_u32 s95, s95, 262144
    s_lshl_b32 s92, s64, 13
    s_add_u32 s92, s92, s34
    s_mov_b32 s3, s84
    s_mov_b32 s84, s83
    s_mov_b32 s83, s85
    s_mov_b32 s85, s3
    s_add_u32 s88, s68, s90
    s_add_u32 s75, s88, 4096
    v_add_u32 v6, s83, v21
    v_add_u32 v7, s84, v22
    s_branch L_RSLOW_GATHER
.p2align 5
L_RSLOW_W2:
    s_add_u32 s64, s64, 1
    s_mov_b32 s68, s67
    s_add_u32 s67, s67, 8192
    s_cmp_eq_u32 s67, 90112
    s_cselect_b32 s67, 65536, s67
    s_add_u32 s95, s95, 262144
    s_lshl_b32 s92, s64, 13
    s_add_u32 s92, s92, s34
    s_mov_b32 s3, s84
    s_mov_b32 s84, s83
    s_mov_b32 s83, s85
    s_mov_b32 s85, s3
    s_add_u32 s88, s68, s90
    s_add_u32 s75, s88, 4096
    v_add_u32 v6, s83, v21
    v_add_u32 v7, s84, v22
    s_sleep 7
    s_nop 7
    s_branch L_RSLOW_GATHER
.p2align 5
L_RSLOW_W01:
    s_mov_b32 s61, s67
    s_mov_b32 s62, s68
    ds_read_b128 v[56:59], v2 offset:32768
    ds_read_b128 v[60:63], v2 offset:33792
    ds_read_b128 v[64:67], v2 offset:34816
    ds_read_b128 v[68:71], v2 offset:35840
    ds_read_b128 v[72:75], v2 offset:49152
    ds_read_b128 v[76:79], v2 offset:50176
    ds_read_b128 v[80:83], v2 offset:51200
    ds_read_b128 v[84:87], v2 offset:52224
    s_add_u32 s64, s64, 1
    s_mov_b32 s68, s67
    s_add_u32 s67, s67, 8192
    s_cmp_eq_u32 s67, 90112
    s_cselect_b32 s67, 65536, s67
    s_add_u32 s95, s95, 262144
    s_lshl_b32 s92, s64, 13
    s_add_u32 s92, s92, s34
    s_mov_b32 s3, s84
    s_mov_b32 s84, s83
    s_mov_b32 s83, s85
    s_mov_b32 s85, s3
    s_add_u32 s88, s68, s90
    s_add_u32 s75, s88, 4096
    v_add_u32 v6, s83, v21
    v_add_u32 v7, s84, v22
    s_nop 3
    s_cmp_eq_u32 s52, 0
    s_cbranch_scc1 L_RSLOW_RL0
    s_nop 15
    s_nop 15
    s_nop 11
L_RSLOW_RL0:
    buffer_load_dwordx4 v[24:27], v1, s[48:51], s72 offen offset:0 sc1
    buffer_load_dwordx4 v[28:31], v1, s[48:51], s72 offen offset:1024 sc1
    buffer_load_dwordx4 v[32:35], v1, s[48:51], s72 offen offset:2048 sc1
    buffer_load_dwordx4 v[36:39], v1, s[48:51], s72 offen offset:3072 sc1
    v_mov_b32 v14, 0
    s_nop 1
    v_mfma_f32_32x32x2_f32 v[88:103], v14, v14, 0
    v_mfma_f32_16x16x4_f32 v[104:107], v14, v14, 0
    v_mfma_f32_16x16x4_f32 v[108:111], v14, v14, 0
    buffer_load_dwordx4 v[40:43], v1, s[48:51], s72 offen offset:0 sc1
    buffer_load_dwordx4 v[44:47], v1, s[48:51], s72 offen offset:1024 sc1
    buffer_load_dwordx4 v[48:51], v1, s[48:51], s72 offen offset:2048 sc1
    buffer_load_dwordx4 v[52:55], v1, s[48:51], s72 offen offset:3072 sc1
L_RSLOW_RC:
    s_waitcnt vmcnt(7)
    v_mfma_f32_16x16x32_bf16 v[116:119], v[24:27], v[16:19], 0
    s_waitcnt vmcnt(6)
    v_mfma_f32_16x16x32_bf16 v[116:119], v[28:31], v[16:19], v[116:119]
    v_bitop3_b32 v14, v24, v28, s69 bitop3:0x7e
    s_waitcnt vmcnt(5)
    v_mfma_f32_16x16x32_bf16 v[116:119], v[32:35], v[16:19], v[116:119]
    s_waitcnt vmcnt(4)
    v_mfma_f32_16x16x32_bf16 v[116:119], v[36:39], v[16:19], v[116:119]
    v_bitop3_b32 v15, v32, v36, s69 bitop3:0x7e
    v_bitop3_b32 v14, v14, v15, 1 bitop3:0xa8
    v_cmp_ne_u32 vcc, 0, v14
    s_cbranch_vccnz L_RSLOW_RF1
    s_nop 3
    v_permlane32_swap_b32 v116, v118
    v_permlane32_swap_b32 v117, v119
    v_add_f32 v116, v116, v118
    v_add_f32 v117, v117, v119
    s_mov_b64 exec, s[76:77]
    v_cvt_pk_bf16_f32 v124, v116, v117
    buffer_store_dword v124, v11, s[48:51], s61 offen sc1
L_RSLOW_ROK:
    s_cmp_eq_u32 s64, 63
    s_cbranch_scc1 L_RSLOW_LAST
    buffer_store_dword v20, v11, s[48:51], s62 offen sc1
    s_mov_b64 exec, -1
    s_xor_b32 s69, s69, 1
    s_cmp_eq_u32 s52, 1
    s_cbranch_scc1 L_RSLOW_GATHER
    s_nop 7
    s_branch L_RSLOW_GATHER
.p2align 5
L_RSLOW_FLG:
    buffer_load_dword v16, v18, s[48:51], s73 offen sc1
    s_branch L_RSLOW_FLB
.p2align 5
L_RSLOW_GR:
    buffer_load_dwordx4 v[52:55], v1, s[48:51], s88 offen sc1
    s_waitcnt vmcnt(1)
    ds_write_b128 v13, v[48:51]
    v_fma_f32 v14, v48, v49, v50
    v_cmp_u_f32 vcc, v14, v51
    s_cbranch_vccz L_RSLOW_GOK
    s_add_u32 s56, s56, 1
    s_cmp_gt_u32 s56, 60000
    s_cbranch_scc1 L_TIMEOUT_4
    s_and_b32 s3, s56, 63
    s_cbranch_scc1 L_RSLOW_GNX
    s_mov_b64 s[96:97], 0
    v_cmp_eq_u32 vcc, v48, v20
    s_nop 0
    s_or_b64 s[96:97], s[96:97], vcc
    v_cmp_eq_u32 vcc, v49, v20
    s_nop 0
    s_or_b64 s[96:97], s[96:97], vcc
    v_cmp_eq_u32 vcc, v50, v20
    s_nop 0
    s_or_b64 s[96:97], s[96:97], vcc
    v_cmp_eq_u32 vcc, v51, v20
    s_nop 0
    s_or_b64 s[96:97], s[96:97], vcc
    s_cbranch_scc0 L_RSLOW_GOK
L_RSLOW_GNX:
    buffer_load_dwordx4 v[48:51], v1, s[48:51], s88 offen sc1
    s_branch L_RSLOW_GL
.p2align 5
L_RSLOW_RF1:
    s_waitcnt vmcnt(3)
    v_mfma_f32_16x16x32_bf16 v[116:119], v[40:43], v[16:19], 0
    s_waitcnt vmcnt(2)
    v_mfma_f32_16x16x32_bf16 v[116:119], v[44:47], v[16:19], v[116:119]
    v_bitop3_b32 v14, v40, v44, s69 bitop3:0x7e
    s_waitcnt vmcnt(1)
    v_mfma_f32_16x16x32_bf16 v[116:119], v[48:51], v[16:19], v[116:119]
    s_waitcnt vmcnt(0)
    v_mfma_f32_16x16x32_bf16 v[116:119], v[52:55], v[16:19], v[116:119]
    v_bitop3_b32 v15, v48, v52, s69 bitop3:0x7e
    v_bitop3_b32 v14, v14, v15, 1 bitop3:0xa8
    v_cmp_ne_u32 vcc, 0, v14
    s_cbranch_vccnz L_RSLOW_RF2
    s_nop 3
    v_permlane32_swap_b32 v116, v118
    v_permlane32_swap_b32 v117, v119
    v_add_f32 v116, v116, v118
    v_add_f32 v117, v117, v119
    s_mov_b64 exec, s[76:77]
    v_cvt_pk_bf16_f32 v124, v116, v117
    buffer_store_dword v124, v11, s[48:51], s61 offen sc1
    s_branch L_RSLOW_ROK
.p2align 5
L_RSLOW_RF2:
    buffer_load_dwordx4 v[24:27], v1, s[48:51], s72 offen offset:0 sc1
    buffer_load_dwordx4 v[28:31], v1, s[48:51], s72 offen offset:1024 sc1
    buffer_load_dwordx4 v[32:35], v1, s[48:51], s72 offen offset:2048 sc1
    buffer_load_dwordx4 v[36:39], v1, s[48:51], s72 offen offset:3072 sc1
    s_nop 15
    s_nop 15
    buffer_load_dwordx4 v[40:43], v1, s[48:51], s72 offen offset:0 sc1
    buffer_load_dwordx4 v[44:47], v1, s[48:51], s72 offen offset:1024 sc1
    buffer_load_dwordx4 v[48:51], v1, s[48:51], s72 offen offset:2048 sc1
    buffer_load_dwordx4 v[52:55], v1, s[48:51], s72 offen offset:3072 sc1
    s_add_u32 s56, s56, 1
    s_cmp_gt_u32 s56, 60000
    s_cbranch_scc1 L_TIMEOUT_5
    s_branch L_RSLOW_RC
.p2align 5
L_RSLOW_G1RETRY:
    s_add_u32 s56, s56, 1
    s_cmp_gt_u32 s56, 60000
    s_cbranch_scc1 L_TIMEOUT_9
    s_and_b32 s3, s56, 63
    s_cbranch_scc1 L_RSLOW_G1L
    s_mov_b64 s[96:97], 0
    v_cmp_eq_u32 vcc, v52, v20
    s_nop 0
    s_or_b64 s[96:97], s[96:97], vcc
    v_cmp_eq_u32 vcc, v53, v20
    s_nop 0
    s_or_b64 s[96:97], s[96:97], vcc
    v_cmp_eq_u32 vcc, v54, v20
    s_nop 0
    s_or_b64 s[96:97], s[96:97], vcc
    v_cmp_eq_u32 vcc, v55, v20
    s_nop 0
    s_or_b64 s[96:97], s[96:97], vcc
    s_cbranch_scc0 L_RSLOW_G1OK
L_RSLOW_G1L:
    buffer_load_dwordx4 v[52:55], v1, s[48:51], s75 offen sc1
    s_sleep 3
    s_waitcnt vmcnt(0)
    ds_write_b128 v13, v[52:55] offset:4096
    v_fma_f32 v14, v52, v53, v54
    v_cmp_u_f32 vcc, v14, v55
    s_waitcnt lgkmcnt(0)
    s_cbranch_vccnz L_RSLOW_G1RETRY
    s_branch L_RSLOW_G1OK
.p2align 5
L_RSLOW_BIGMEM:
    v_max3_f32 v70, v24, v25, v26
    v_max3_f32 v71, v27, v28, v29
    v_max3_f32 v70, v70, v30, v31
    v_max3_f32 v71, v71, v32, v33
    v_max_f32 v70, v70, v71
    v_mov_b32 v71, v70
    s_nop 1
    v_permlane16_swap_b32 v70, v71
    v_max_f32 v70, v70, v71
    v_mov_b32 v71, v70
    s_nop 1
    v_permlane32_swap_b32 v70, v71
    v_max_f32 v70, v70, v71
    v_sub_f32 v96, v24, v70
    v_sub_f32 v97, v25, v70
    v_sub_f32 v98, v26, v70
    v_sub_f32 v99, v27, v70
    v_sub_f32 v100, v28, v70
    v_sub_f32 v101, v29, v70
    v_sub_f32 v102, v30, v70
    v_sub_f32 v103, v31, v70
    v_sub_f32 v34, v32, v70
    v_sub_f32 v35, v33, v70
    v_exp_f32 v96, v96
    v_exp_f32 v97, v97
    v_exp_f32 v98, v98
    v_exp_f32 v99, v99
    v_exp_f32 v100, v100
    v_exp_f32 v101, v101
    v_exp_f32 v102, v102
    v_exp_f32 v103, v103
    v_exp_f32 v34, v34
    v_exp_f32 v35, v35
    v_cvt_pk_bf16_f32 v52, v96, v97
    v_cvt_pk_bf16_f32 v53, v98, v99
    v_cvt_pk_bf16_f32 v54, v100, v101
    v_cvt_pk_bf16_f32 v55, v102, v103
    v_cvt_pk_bf16_f32 v42, v34, v35
    v_cvt_pk_bf16_f32 v43, v34, v35
    s_nop 1
    v_mfma_f32_16x16x16_bf16 v[120:123], v[40:41], v[42:43], 0
    v_mfma_f32_16x16x16_bf16 v[112:115], v[104:105], v[42:43], 0
    v_mfma_f32_16x16x16_bf16 v[116:119], v[106:107], v[42:43], 0
    v_mfma_f32_16x16x32_bf16 v[120:123], v[36:39], v[52:55], v[120:123]
    v_mfma_f32_16x16x32_bf16 v[112:115], v[44:47], v[52:55], v[112:115]
    v_mfma_f32_16x16x32_bf16 v[116:119], v[48:51], v[52:55], v[116:119]
    s_nop 7
    s_branch L_RSLOW_SMOK
.p2align 5
L_RSLOW_FIN23:
    v_mov_b32 v14, 0
    s_nop 1
    v_mfma_f32_32x32x2_f32 v[88:103], v14, v14, 0
    v_mfma_f32_16x16x4_f32 v[104:107], v14, v14, 0
    v_mfma_f32_16x16x4_f32 v[108:111], v14, v14, 0
    s_add_u32 s64, s64, 1
    s_mov_b32 s68, s67
    s_add_u32 s67, s67, 8192
    s_cmp_eq_u32 s67, 90112
    s_cselect_b32 s67, 65536, s67
    s_add_u32 s95, s95, 262144
    s_lshl_b32 s92, s64, 13
    s_add_u32 s92, s92, s34
    s_mov_b32 s3, s84
    s_mov_b32 s84, s83
    s_mov_b32 s83, s85
    s_mov_b32 s85, s3
    s_add_u32 s88, s68, s90
    s_add_u32 s75, s88, 4096
    s_sleep 7
    s_nop 7
    s_branch L_RSLOW_FIN
.p2align 5
L_RSLOW_LAST:
    s_mov_b64 exec, -1
L_RSLOW_FIN:
    s_waitcnt lgkmcnt(0)
    ds_read_b128 v[56:59], v23 offset:0
    ds_read_b128 v[60:63], v23 offset:1024
    ds_read_b128 v[64:67], v23 offset:2048
    ds_read_b128 v[68:71], v23 offset:3072
    ds_read_b128 v[72:75], v23 offset:16384
    ds_read_b128 v[76:79], v23 offset:17408
    ds_read_b128 v[80:83], v23 offset:18432
    ds_read_b128 v[84:87], v23 offset:19456
    s_mov_b32 s56, 0
L_RSLOW_FG:
    buffer_load_dwordx4 v[48:51], v1, s[48:51], s88 offen sc1
    buffer_load_dwordx4 v[52:55], v1, s[48:51], s75 offen sc1
    s_waitcnt vmcnt(0)
    ds_write_b128 v13, v[48:51]
    ds_write_b128 v13, v[52:55] offset:4096
    v_fma_f32 v14, v48, v49, v50
    v_fma_f32 v14, v51, v52, v14
    v_fma_f32 v14, v53, v54, v14
    v_cmp_u_f32 vcc, v14, v55
    s_cbranch_vccz L_RSLOW_FOK
    s_add_u32 s56, s56, 1
    s_cmp_gt_u32 s56, 60000
    s_cbranch_scc1 L_TIMEOUT_4
    s_and_b32 s3, s56, 63
    s_cbranch_scc1 L_RSLOW_FG
    s_mov_b64 s[96:97], 0
    v_cmp_eq_u32 vcc, v48, v20
    s_nop 0
    s_or_b64 s[96:97], s[96:97], vcc
    v_cmp_eq_u32 vcc, v49, v20
    s_nop 0
    s_or_b64 s[96:97], s[96:97], vcc
    v_cmp_eq_u32 vcc, v50, v20
    s_nop 0
    s_or_b64 s[96:97], s[96:97], vcc
    v_cmp_eq_u32 vcc, v51, v20
    s_nop 0
    s_or_b64 s[96:97], s[96:97], vcc
    v_cmp_eq_u32 vcc, v52, v20
    s_nop 0
    s_or_b64 s[96:97], s[96:97], vcc
    v_cmp_eq_u32 vcc, v53, v20
    s_nop 0
    s_or_b64 s[96:97], s[96:97], vcc
    v_cmp_eq_u32 vcc, v54, v20
    s_nop 0
    s_or_b64 s[96:97], s[96:97], vcc
    v_cmp_eq_u32 vcc, v55, v20
    s_nop 0
    s_or_b64 s[96:97], s[96:97], vcc
    s_cbranch_scc0 L_RSLOW_FOK
    s_branch L_RSLOW_FG
.p2align 5
L_RSLOW_FOK:
    s_waitcnt lgkmcnt(0)
    s_barrier
    ds_read_b128 v[32:35], v3 offset:2048
    ds_read_b128 v[36:39], v3 offset:3072
    ds_read_b128 v[24:27], v3 offset:0
    ds_read_b128 v[28:31], v3 offset:1024
    ds_read_b128 v[40:43], v3 offset:4096
    ds_read_b128 v[44:47], v3 offset:5120
    ds_read_b128 v[48:51], v3 offset:6144
    ds_read_b128 v[52:55], v3 offset:7168
    s_mov_b64 exec, s[38:39]
    buffer_store_dword v124, v11, s[48:51], s92 offen sc1
    s_mov_b64 exec, -1
    s_waitcnt lgkmcnt(7)
    v_smfmac_f32_16x16x64_bf16 v[96:99], v[32:35], v[56:63], v12
    ds_read_b128 v[56:59], v23 offset:32768
    ds_read_b128 v[60:63], v23 offset:33792
    v_smfmac_f32_16x16x64_bf16 v[100:103], v[32:35], v[64:71], v12
    ds_read_b128 v[64:67], v23 offset:34816
    ds_read_b128 v[68:71], v23 offset:35840
    s_waitcnt lgkmcnt(10)
    v_smfmac_f32_16x16x64_bf16 v[96:99], v[36:39], v[72:79], v12
    ds_read_b128 v[72:75], v23 offset:49152
    ds_read_b128 v[76:79], v23 offset:50176
    v_smfmac_f32_16x16x64_bf16 v[100:103], v[36:39], v[80:87], v12
    ds_read_b128 v[80:83], v23 offset:51200
    ds_read_b128 v[84:87], v23 offset:52224
    s_waitcnt lgkmcnt(13)
    v_smfmac_f32_16x16x64_bf16 v[96:99], v[24:27], v[192:199], v12
    v_smfmac_f32_16x16x64_bf16 v[100:103], v[24:27], v[200:207], v12
    s_waitcnt lgkmcnt(12)
    v_smfmac_f32_16x16x64_bf16 v[96:99], v[28:31], v[208:215], v12
    v_smfmac_f32_16x16x64_bf16 v[100:103], v[28:31], v[216:223], v12
    s_waitcnt lgkmcnt(9)
    v_smfmac_f32_16x16x64_bf16 v[96:99], v[48:51], v[224:231], v12
    v_smfmac_f32_16x16x64_bf16 v[100:103], v[48:51], v[232:239], v12
    s_waitcnt lgkmcnt(8)
    v_smfmac_f32_16x16x64_bf16 v[96:99], v[52:55], v[240:247], v12
    v_smfmac_f32_16x16x64_bf16 v[100:103], v[52:55], v[248:255], v12
    s_waitcnt lgkmcnt(6)
    v_smfmac_f32_16x16x64_bf16 v[96:99], v[40:43], v[56:63], v12
    s_waitcnt lgkmcnt(4)
    v_smfmac_f32_16x16x64_bf16 v[100:103], v[40:43], v[64:71], v12
    s_waitcnt lgkmcnt(2)
    v_smfmac_f32_16x16x64_bf16 v[96:99], v[44:47], v[72:79], v12
    s_waitcnt lgkmcnt(0)
    v_smfmac_f32_16x16x64_bf16 v[100:103], v[44:47], v[80:87], v12
    v_smfmac_f32_16x16x64_bf16 v[104:107], v[24:27], a[96:103], v12
    v_smfmac_f32_16x16x64_bf16 v[108:111], v[24:27], a[104:111], v12
    v_smfmac_f32_16x16x64_bf16 v[104:107], v[28:31], a[112:119], v12
    v_smfmac_f32_16x16x64_bf16 v[108:111], v[28:31], a[120:127], v12
    s_barrier
    s_nop 0
    v_add_f32 v96, v96, v98
    v_add_f32 v97, v97, v99
    v_cvt_pk_bf16_f32 v90, v96, v97
    v_add_f32 v100, v100, v102
    v_add_f32 v101, v101, v103
    v_cvt_pk_bf16_f32 v94, v100, v101
    ds_write2_b32 v9, v90, v94 offset0:0 offset1:128
    v_add_u32 v14, s90, v0
    v_add_u32 v119, s90, v5
    v_smfmac_f32_16x16x64_bf16 v[104:107], v[40:43], a[160:167], v12
    v_smfmac_f32_16x16x64_bf16 v[108:111], v[40:43], a[168:175], v12
    v_smfmac_f32_16x16x64_bf16 v[104:107], v[44:47], a[176:183], v12
    v_smfmac_f32_16x16x64_bf16 v[108:111], v[44:47], a[184:191], v12
    s_waitcnt lgkmcnt(0)
    s_barrier
    ds_read_b64_tr_b16 v[112:113], v14 offset:0
    ds_read_b64_tr_b16 v[114:115], v119 offset:256
    v_lshrrev_b32 v15, 4, v1
    v_bfe_u32 v116, v15, 0, 1
    v_mul_u32_u24 v116, 16, v116
    v_bfe_u32 v118, v15, 2, 4
    v_mul_u32_u24 v118, 32, v118
    v_add_u32 v116, v116, v118
    v_bfe_u32 v117, v15, 0, 4
    v_mul_u32_u24 v117, 8, v117
    v_bfe_u32 v118, v15, 4, 1
    v_mul_u32_u24 v118, 4, v118
    v_add_u32 v117, v117, v118
    v_bfe_u32 v118, v15, 5, 1
    v_mul_u32_u24 v118, 256, v118
    v_add_u32 v117, v117, v118
    s_lshl_b32 s61, s53, 12
    s_lshr_b32 s3, s90, 1
    s_add_u32 s61, s61, s3
    s_add_u32 s62, s61, 16646144
    s_add_u32 s61, s61, 58589184
    v_smfmac_f32_16x16x64_bf16 v[104:107], v[48:51], a[192:199], v12
    v_smfmac_f32_16x16x64_bf16 v[108:111], v[48:51], a[200:207], v12
    v_smfmac_f32_16x16x64_bf16 v[104:107], v[52:55], a[208:215], v12
    v_smfmac_f32_16x16x64_bf16 v[108:111], v[52:55], a[216:223], v12
    s_waitcnt lgkmcnt(0)
    s_mov_b64 exec, s[80:81]
    buffer_store_dwordx4 v[112:115], v116, s[48:51], s61 offen sc1
    s_mov_b64 exec, -1
    v_smfmac_f32_16x16x64_bf16 v[104:107], v[32:35], a[128:135], v12
    v_smfmac_f32_16x16x64_bf16 v[108:111], v[32:35], a[136:143], v12
    v_smfmac_f32_16x16x64_bf16 v[104:107], v[36:39], a[144:151], v12
    v_smfmac_f32_16x16x64_bf16 v[108:111], v[36:39], a[152:159], v12
    s_nop 6
    v_add_f32 v104, v104, v106
    v_add_f32 v105, v105, v107
    v_cvt_pk_bf16_f32 v104, v104, v105
    buffer_store_dword v104, v117, s[48:51], s62 offen offset:0 sc1
    v_add_f32 v108, v108, v110
    v_add_f32 v109, v109, v111
    v_cvt_pk_bf16_f32 v108, v108, v109
    buffer_store_dword v108, v117, s[48:51], s62 offen offset:128 sc1
L_RSLOW_EXIT:
    s_endpgm
.p2align 5
L_ROLE_QA:
    s_sub_u32 s66, 67, s54
    s_lshr_b32 s66, s66, 2
    v_lshlrev_b32 v1, 4, v0
    v_lshlrev_b32 v12, 2, v0
    s_lshl_b32 s79, s54, 22
    s_add_u32 s79, s79, 67108864
    s_lshl_b32 s61, s52, 3
    s_add_u32 s62, s61, 0
    s_and_b32 s3, s62, 15
    s_lshl_b32 s3, s3, 4
    v_xor_b32 v20, s3, v1
    s_lshl_b32 s3, s62, 10
    v_add_u32 v20, s3, v20
    s_add_u32 s62, s61, 1
    s_and_b32 s3, s62, 15
    s_lshl_b32 s3, s3, 4
    v_xor_b32 v21, s3, v1
    s_lshl_b32 s3, s62, 10
    v_add_u32 v21, s3, v21
    s_add_u32 s62, s61, 2
    s_and_b32 s3, s62, 15
    s_lshl_b32 s3, s3, 4
    v_xor_b32 v22, s3, v1
    s_lshl_b32 s3, s62, 10
    v_add_u32 v22, s3, v22
    s_add_u32 s62, s61, 3
    s_and_b32 s3, s62, 15
    s_lshl_b32 s3, s3, 4
    v_xor_b32 v23, s3, v1
    s_lshl_b32 s3, s62, 10
    v_add_u32 v23, s3, v23
    s_add_u32 s62, s61, 4
    s_and_b32 s3, s62, 15
    s_lshl_b32 s3, s3, 4
    v_xor_b32 v24, s3, v1
    s_lshl_b32 s3, s62, 10
    v_add_u32 v24, s3, v24
    s_add_u32 s62, s61, 5
    s_and_b32 s3, s62, 15
    s_lshl_b32 s3, s3, 4
    v_xor_b32 v25, s3, v1
    s_lshl_b32 s3, s62, 10
    v_add_u32 v25, s3, v25
    s_add_u32 s62, s61, 6
    s_and_b32 s3, s62, 15
    s_lshl_b32 s3, s3, 4
    v_xor_b32 v26, s3, v1
    s_lshl_b32 s3, s62, 10
    v_add_u32 v26, s3, v26
    s_add_u32 s62, s61, 7
    s_and_b32 s3, s62, 15
    s_lshl_b32 s3, s3, 4
    v_xor_b32 v27, s3, v1
    s_lshl_b32 s3, s62, 10
    v_add_u32 v27, s3, v27
    s_mov_b32 s67, s54
    s_lshl_b32 s69, s67, 15
    s_lshl_b32 s78, s52, 13
    s_add_u32 s78, s78, 0
    s_add_u32 m0, s78, 0
    s_nop 0
    buffer_load_dwordx4 v20, s[4:7], s69 offen lds
    s_add_u32 m0, s78, 1024
    s_nop 0
    buffer_load_dwordx4 v21, s[4:7], s69 offen lds
    s_add_u32 m0, s78, 2048
    s_nop 0
    buffer_load_dwordx4 v22, s[4:7], s69 offen lds
    s_add_u32 m0, s78, 3072
    s_nop 0
    buffer_load_dwordx4 v23, s[4:7], s69 offen lds
    s_add_u32 m0, s78, 4096
    s_nop 0
    buffer_load_dwordx4 v24, s[4:7], s69 offen lds
    s_add_u32 m0, s78, 5120
    s_nop 0
    buffer_load_dwordx4 v25, s[4:7], s69 offen lds
    s_add_u32 m0, s78, 6144
    s_nop 0
    buffer_load_dwordx4 v26, s[4:7], s69 offen lds
    s_add_u32 m0, s78, 7168
    s_nop 0
    buffer_load_dwordx4 v27, s[4:7], s69 offen lds
    s_add_u32 s61, s54, 4
    s_lshl_b32 s69, s61, 15
    s_lshl_b32 s78, s52, 13
    s_add_u32 s78, s78, 32768
    s_add_u32 m0, s78, 0
    s_nop 0
    buffer_load_dwordx4 v20, s[4:7], s69 offen lds
    s_add_u32 m0, s78, 1024
    s_nop 0
    buffer_load_dwordx4 v21, s[4:7], s69 offen lds
    s_add_u32 m0, s78, 2048
    s_nop 0
    buffer_load_dwordx4 v22, s[4:7], s69 offen lds
    s_add_u32 m0, s78, 3072
    s_nop 0
    buffer_load_dwordx4 v23, s[4:7], s69 offen lds
    s_add_u32 m0, s78, 4096
    s_nop 0
    buffer_load_dwordx4 v24, s[4:7], s69 offen lds
    s_add_u32 m0, s78, 5120
    s_nop 0
    buffer_load_dwordx4 v25, s[4:7], s69 offen lds
    s_add_u32 m0, s78, 6144
    s_nop 0
    buffer_load_dwordx4 v26, s[4:7], s69 offen lds
    s_add_u32 m0, s78, 7168
    s_nop 0
    buffer_load_dwordx4 v27, s[4:7], s69 offen lds
    v_bfe_u32 v2, v0, 5, 1
    v_mul_u32_u24 v2, 16, v2
    v_bfe_u32 v3, v0, 0, 4
    v_mul_u32_u24 v3, 16, v3
    v_bfe_u32 v5, v0, 0, 5
    v_mul_u32_u24 v5, 1024, v5
    v_add_u32 v4, 0, v2
    v_xor_b32 v4, v4, v3
    v_add_u32 v28, v4, v5
    v_add_u32 v4, 32, v2
    v_xor_b32 v4, v4, v3
    v_add_u32 v29, v4, v5
    v_add_u32 v4, 64, v2
    v_xor_b32 v4, v4, v3
    v_add_u32 v30, v4, v5
    v_add_u32 v4, 96, v2
    v_xor_b32 v4, v4, v3
    v_add_u32 v31, v4, v5
    v_add_u32 v4, 128, v2
    v_xor_b32 v4, v4, v3
    v_add_u32 v32, v4, v5
    v_add_u32 v4, 160, v2
    v_xor_b32 v4, v4, v3
    v_add_u32 v33, v4, v5
    v_add_u32 v4, 192, v2
    v_xor_b32 v4, v4, v3
    v_add_u32 v34, v4, v5
    v_add_u32 v4, 224, v2
    v_xor_b32 v4, v4, v3
    v_add_u32 v35, v4, v5
    s_lshl_b32 s60, s52, 12
    v_bfe_u32 v60, v0, 0, 4
    v_mul_u32_u24 v60, 16, v60
    v_bfe_u32 v2, v0, 4, 2
    v_mul_u32_u24 v2, 8192, v2
    v_add_u32 v60, v60, v2
    v_lshlrev_b32 v2, 2, v0
    v_and_b32 v2, 0xc0, v2
    v_xor_b32 v60, v60, v2
    v_bfe_u32 v61, v0, 0, 2
    v_mul_u32_u24 v61, 8, v61
    v_bfe_u32 v2, v0, 2, 2
    v_mul_u32_u24 v2, 256, v2
    v_add_u32 v61, v61, v2
    v_bfe_u32 v2, v0, 4, 1
    v_mul_u32_u24 v2, 32, v2
    v_add_u32 v61, v61, v2
    v_bfe_u32 v2, v0, 5, 1
    v_mul_u32_u24 v2, 2048, v2
    v_add_u32 v61, v61, v2
    s_lshl_b32 s3, s52, 6
    v_add_u32 v61, s3, v61
    v_lshlrev_b32 v2, 4, v0
    v_and_b32 v2, 0xc0, v2
    v_xor_b32 v61, v61, v2
    v_bfe_u32 v62, v0, 0, 4
    v_mul_u32_u24 v62, 16, v62
    v_bfe_u32 v2, v0, 4, 2
    v_mul_u32_u24 v2, 1024, v2
    v_add_u32 v62, v62, v2
    v_lshlrev_b32 v2, 2, v0
    v_and_b32 v2, 0xc0, v2
    v_xor_b32 v62, v62, v2
    v_bfe_u32 v63, v0, 0, 2
    v_mul_u32_u24 v63, 8, v63
    v_bfe_u32 v2, v0, 2, 2
    v_mul_u32_u24 v2, 256, v2
    v_add_u32 v63, v63, v2
    v_bfe_u32 v2, v0, 4, 1
    v_mul_u32_u24 v2, 32, v2
    v_add_u32 v63, v63, v2
    v_bfe_u32 v2, v0, 5, 1
    v_mul_u32_u24 v2, 1024, v2
    v_add_u32 v63, v63, v2
    v_lshlrev_b32 v2, 4, v0
    v_and_b32 v2, 0xc0, v2
    v_xor_b32 v63, v63, v2
    v_add_u32 v63, s60, v63
    s_lshl_b32 s64, s53, 8
    s_lshl_b32 s3, s52, 17
    s_add_u32 s64, s64, s3
    s_lshl_b32 s74, s53, 17
    s_lshl_b32 s3, s52, 8
    s_add_u32 s74, s74, s3
    s_lshl_b32 s63, s53, 14
    s_add_u32 s63, s63, s3
    s_add_u32 m0, s60, 65536
    s_add_u32 s62, s64, 0
    buffer_load_dwordx4 v60, s[12:15], s62 offen lds
    s_add_u32 m0, s60, 66560
    s_add_u32 s62, s64, 32768
    buffer_load_dwordx4 v60, s[12:15], s62 offen lds
    s_add_u32 m0, s60, 67584
    s_add_u32 s62, s64, 65536
    buffer_load_dwordx4 v60, s[12:15], s62 offen lds
    s_add_u32 m0, s60, 68608
    s_add_u32 s62, s64, 98304
    buffer_load_dwordx4 v60, s[12:15], s62 offen lds
    s_add_u32 m0, s60, 81920
    s_add_u32 s62, s64, 524288
    buffer_load_dwordx4 v60, s[12:15], s62 offen lds
    s_add_u32 m0, s60, 82944
    s_add_u32 s62, s64, 557056
    buffer_load_dwordx4 v60, s[12:15], s62 offen lds
    s_add_u32 m0, s60, 83968
    s_add_u32 s62, s64, 589824
    buffer_load_dwordx4 v60, s[12:15], s62 offen lds
    s_add_u32 m0, s60, 84992
    s_add_u32 s62, s64, 622592
    buffer_load_dwordx4 v60, s[12:15], s62 offen lds
    s_add_u32 m0, s60, 98304
    s_add_u32 s62, s64, 1048576
    buffer_load_dwordx4 v60, s[12:15], s62 offen lds
    s_add_u32 m0, s60, 99328
    s_add_u32 s62, s64, 1081344
    buffer_load_dwordx4 v60, s[12:15], s62 offen lds
    s_add_u32 m0, s60, 100352
    s_add_u32 s62, s64, 1114112
    buffer_load_dwordx4 v60, s[12:15], s62 offen lds
    s_add_u32 m0, s60, 101376
    s_add_u32 s62, s64, 1146880
    buffer_load_dwordx4 v60, s[12:15], s62 offen lds
    s_add_u32 m0, s60, 114688
    s_add_u32 s62, s64, 1572864
    buffer_load_dwordx4 v60, s[12:15], s62 offen lds
    s_add_u32 m0, s60, 115712
    s_add_u32 s62, s64, 1605632
    buffer_load_dwordx4 v60, s[12:15], s62 offen lds
    s_add_u32 m0, s60, 116736
    s_add_u32 s62, s64, 1638400
    buffer_load_dwordx4 v60, s[12:15], s62 offen lds
    s_add_u32 m0, s60, 117760
    s_add_u32 s62, s64, 1671168
    buffer_load_dwordx4 v60, s[12:15], s62 offen lds
    s_add_u32 m0, s60, 131072
    s_add_u32 s62, s64, 2097152
    buffer_load_dwordx4 v60, s[12:15], s62 offen lds
    s_add_u32 m0, s60, 132096
    s_add_u32 s62, s64, 2129920
    buffer_load_dwordx4 v60, s[12:15], s62 offen lds
    s_add_u32 m0, s60, 133120
    s_add_u32 s62, s64, 2162688
    buffer_load_dwordx4 v60, s[12:15], s62 offen lds
    s_add_u32 m0, s60, 134144
    s_add_u32 s62, s64, 2195456
    buffer_load_dwordx4 v60, s[12:15], s62 offen lds
    s_add_u32 m0, s60, 147456
    s_add_u32 s62, s64, 2621440
    buffer_load_dwordx4 v60, s[12:15], s62 offen lds
    s_add_u32 m0, s60, 148480
    s_add_u32 s62, s64, 2654208
    buffer_load_dwordx4 v60, s[12:15], s62 offen lds
    s_add_u32 m0, s60, 149504
    s_add_u32 s62, s64, 2686976
    buffer_load_dwordx4 v60, s[12:15], s62 offen lds
    s_add_u32 m0, s60, 150528
    s_add_u32 s62, s64, 2719744
    buffer_load_dwordx4 v60, s[12:15], s62 offen lds
    s_waitcnt vmcnt(20)
    s_barrier
    v_add_u32 v64, 65536, v61
    ds_read_b64_tr_b16 a[0:1], v64 offset:0
    ds_read_b64_tr_b16 a[2:3], v64 offset:1024
    ds_read_b64_tr_b16 a[4:5], v64 offset:4096
    ds_read_b64_tr_b16 a[6:7], v64 offset:5120
    ds_read_b64_tr_b16 a[8:9], v64 offset:8192
    ds_read_b64_tr_b16 a[10:11], v64 offset:9216
    ds_read_b64_tr_b16 a[12:13], v64 offset:12288
    ds_read_b64_tr_b16 a[14:15], v64 offset:13312
    s_waitcnt lgkmcnt(0)
    s_waitcnt vmcnt(16)
    s_barrier
    s_add_u32 m0, s60, 65536
    s_add_u32 s62, s64, 3145728
    buffer_load_dwordx4 v60, s[12:15], s62 offen lds
    s_add_u32 m0, s60, 66560
    s_add_u32 s62, s64, 3178496
    buffer_load_dwordx4 v60, s[12:15], s62 offen lds
    s_add_u32 m0, s60, 67584
    s_add_u32 s62, s64, 3211264
    buffer_load_dwordx4 v60, s[12:15], s62 offen lds
    s_add_u32 m0, s60, 68608
    s_add_u32 s62, s64, 3244032
    buffer_load_dwordx4 v60, s[12:15], s62 offen lds
    v_add_u32 v64, 81920, v61
    ds_read_b64_tr_b16 a[16:17], v64 offset:0
    ds_read_b64_tr_b16 a[18:19], v64 offset:1024
    ds_read_b64_tr_b16 a[20:21], v64 offset:4096
    ds_read_b64_tr_b16 a[22:23], v64 offset:5120
    ds_read_b64_tr_b16 a[24:25], v64 offset:8192
    ds_read_b64_tr_b16 a[26:27], v64 offset:9216
    ds_read_b64_tr_b16 a[28:29], v64 offset:12288
    ds_read_b64_tr_b16 a[30:31], v64 offset:13312
    s_waitcnt lgkmcnt(0)
    s_waitcnt vmcnt(16)
    s_barrier
    s_add_u32 m0, s60, 81920
    s_add_u32 s62, s64, 3670016
    buffer_load_dwordx4 v60, s[12:15], s62 offen lds
    s_add_u32 m0, s60, 82944
    s_add_u32 s62, s64, 3702784
    buffer_load_dwordx4 v60, s[12:15], s62 offen lds
    s_add_u32 m0, s60, 83968
    s_add_u32 s62, s64, 3735552
    buffer_load_dwordx4 v60, s[12:15], s62 offen lds
    s_add_u32 m0, s60, 84992
    s_add_u32 s62, s64, 3768320
    buffer_load_dwordx4 v60, s[12:15], s62 offen lds
    v_add_u32 v64, 98304, v61
    ds_read_b64_tr_b16 a[32:33], v64 offset:0
    ds_read_b64_tr_b16 a[34:35], v64 offset:1024
    ds_read_b64_tr_b16 a[36:37], v64 offset:4096
    ds_read_b64_tr_b16 a[38:39], v64 offset:5120
    ds_read_b64_tr_b16 a[40:41], v64 offset:8192
    ds_read_b64_tr_b16 a[42:43], v64 offset:9216
    ds_read_b64_tr_b16 a[44:45], v64 offset:12288
    ds_read_b64_tr_b16 a[46:47], v64 offset:13312
    s_waitcnt lgkmcnt(0)
    s_waitcnt vmcnt(16)
    s_barrier
    s_add_u32 m0, s60, 98304
    s_add_u32 s62, s74, 0
    buffer_load_dwordx4 v62, s[24:27], s62 offen lds
    s_add_u32 m0, s60, 99328
    s_add_u32 s62, s74, 4096
    buffer_load_dwordx4 v62, s[24:27], s62 offen lds
    s_add_u32 m0, s60, 100352
    s_add_u32 s62, s74, 8192
    buffer_load_dwordx4 v62, s[24:27], s62 offen lds
    s_add_u32 m0, s60, 101376
    s_add_u32 s62, s74, 12288
    buffer_load_dwordx4 v62, s[24:27], s62 offen lds
    v_add_u32 v64, 114688, v61
    ds_read_b64_tr_b16 a[48:49], v64 offset:0
    ds_read_b64_tr_b16 a[50:51], v64 offset:1024
    ds_read_b64_tr_b16 a[52:53], v64 offset:4096
    ds_read_b64_tr_b16 a[54:55], v64 offset:5120
    ds_read_b64_tr_b16 a[56:57], v64 offset:8192
    ds_read_b64_tr_b16 a[58:59], v64 offset:9216
    ds_read_b64_tr_b16 a[60:61], v64 offset:12288
    ds_read_b64_tr_b16 a[62:63], v64 offset:13312
    s_waitcnt lgkmcnt(0)
    s_waitcnt vmcnt(16)
    s_barrier
    s_add_u32 m0, s60, 114688
    s_add_u32 s62, s74, 16384
    buffer_load_dwordx4 v62, s[24:27], s62 offen lds
    s_add_u32 m0, s60, 115712
    s_add_u32 s62, s74, 20480
    buffer_load_dwordx4 v62, s[24:27], s62 offen lds
    s_add_u32 m0, s60, 116736
    s_add_u32 s62, s74, 24576
    buffer_load_dwordx4 v62, s[24:27], s62 offen lds
    s_add_u32 m0, s60, 117760
    s_add_u32 s62, s74, 28672
    buffer_load_dwordx4 v62, s[24:27], s62 offen lds
    v_add_u32 v64, 131072, v61
    ds_read_b64_tr_b16 a[64:65], v64 offset:0
    ds_read_b64_tr_b16 a[66:67], v64 offset:1024
    ds_read_b64_tr_b16 a[68:69], v64 offset:4096
    ds_read_b64_tr_b16 a[70:71], v64 offset:5120
    ds_read_b64_tr_b16 a[72:73], v64 offset:8192
    ds_read_b64_tr_b16 a[74:75], v64 offset:9216
    ds_read_b64_tr_b16 a[76:77], v64 offset:12288
    ds_read_b64_tr_b16 a[78:79], v64 offset:13312
    s_waitcnt lgkmcnt(0)
    s_waitcnt vmcnt(16)
    s_barrier
    s_add_u32 m0, s60, 131072
    s_add_u32 s62, s74, 32768
    buffer_load_dwordx4 v62, s[24:27], s62 offen lds
    s_add_u32 m0, s60, 132096
    s_add_u32 s62, s74, 36864
    buffer_load_dwordx4 v62, s[24:27], s62 offen lds
    s_add_u32 m0, s60, 133120
    s_add_u32 s62, s74, 40960
    buffer_load_dwordx4 v62, s[24:27], s62 offen lds
    s_add_u32 m0, s60, 134144
    s_add_u32 s62, s74, 45056
    buffer_load_dwordx4 v62, s[24:27], s62 offen lds
    v_add_u32 v64, 147456, v61
    ds_read_b64_tr_b16 a[80:81], v64 offset:0
    ds_read_b64_tr_b16 a[82:83], v64 offset:1024
    ds_read_b64_tr_b16 a[84:85], v64 offset:4096
    ds_read_b64_tr_b16 a[86:87], v64 offset:5120
    ds_read_b64_tr_b16 a[88:89], v64 offset:8192
    ds_read_b64_tr_b16 a[90:91], v64 offset:9216
    ds_read_b64_tr_b16 a[92:93], v64 offset:12288
    ds_read_b64_tr_b16 a[94:95], v64 offset:13312
    s_waitcnt lgkmcnt(0)
    s_waitcnt vmcnt(16)
    s_barrier
    s_add_u32 m0, s60, 147456
    s_add_u32 s62, s74, 49152
    buffer_load_dwordx4 v62, s[24:27], s62 offen lds
    s_add_u32 m0, s60, 148480
    s_add_u32 s62, s74, 53248
    buffer_load_dwordx4 v62, s[24:27], s62 offen lds
    s_add_u32 m0, s60, 149504
    s_add_u32 s62, s74, 57344
    buffer_load_dwordx4 v62, s[24:27], s62 offen lds
    s_add_u32 m0, s60, 150528
    s_add_u32 s62, s74, 61440
    buffer_load_dwordx4 v62, s[24:27], s62 offen lds
    v_add_u32 v64, 65536, v61
    ds_read_b64_tr_b16 a[96:97], v64 offset:0
    ds_read_b64_tr_b16 a[98:99], v64 offset:1024
    ds_read_b64_tr_b16 a[100:101], v64 offset:4096
    ds_read_b64_tr_b16 a[102:103], v64 offset:5120
    ds_read_b64_tr_b16 a[104:105], v64 offset:8192
    ds_read_b64_tr_b16 a[106:107], v64 offset:9216
    ds_read_b64_tr_b16 a[108:109], v64 offset:12288
    ds_read_b64_tr_b16 a[110:111], v64 offset:13312
    s_waitcnt lgkmcnt(0)
    s_waitcnt vmcnt(16)
    s_barrier
    s_add_u32 m0, s60, 65536
    s_add_u32 s62, s74, 65536
    buffer_load_dwordx4 v62, s[24:27], s62 offen lds
    s_add_u32 m0, s60, 66560
    s_add_u32 s62, s74, 69632
    buffer_load_dwordx4 v62, s[24:27], s62 offen lds
    s_add_u32 m0, s60, 67584
    s_add_u32 s62, s74, 73728
    buffer_load_dwordx4 v62, s[24:27], s62 offen lds
    s_add_u32 m0, s60, 68608
    s_add_u32 s62, s74, 77824
    buffer_load_dwordx4 v62, s[24:27], s62 offen lds
    v_add_u32 v64, 81920, v61
    ds_read_b64_tr_b16 a[112:113], v64 offset:0
    ds_read_b64_tr_b16 a[114:115], v64 offset:1024
    ds_read_b64_tr_b16 a[116:117], v64 offset:4096
    ds_read_b64_tr_b16 a[118:119], v64 offset:5120
    ds_read_b64_tr_b16 a[120:121], v64 offset:8192
    ds_read_b64_tr_b16 a[122:123], v64 offset:9216
    ds_read_b64_tr_b16 a[124:125], v64 offset:12288
    ds_read_b64_tr_b16 a[126:127], v64 offset:13312
    s_waitcnt lgkmcnt(0)
    s_waitcnt vmcnt(16)
    s_barrier
    s_add_u32 m0, s60, 81920
    s_add_u32 s62, s74, 81920
    buffer_load_dwordx4 v62, s[24:27], s62 offen lds
    s_add_u32 m0, s60, 82944
    s_add_u32 s62, s74, 86016
    buffer_load_dwordx4 v62, s[24:27], s62 offen lds
    s_add_u32 m0, s60, 83968
    s_add_u32 s62, s74, 90112
    buffer_load_dwordx4 v62, s[24:27], s62 offen lds
    s_add_u32 m0, s60, 84992
    s_add_u32 s62, s74, 94208
    buffer_load_dwordx4 v62, s[24:27], s62 offen lds
    v_add_u32 v64, 98304, v63
    ds_read_b64_tr_b16 a[128:129], v64 offset:0
    ds_read_b64_tr_b16 a[130:131], v64 offset:2048
    v_xor_b32 v64, 64, v64
    ds_read_b64_tr_b16 a[132:133], v64 offset:0
    ds_read_b64_tr_b16 a[134:135], v64 offset:2048
    v_xor_b32 v64, 192, v64
    ds_read_b64_tr_b16 a[136:137], v64 offset:0
    ds_read_b64_tr_b16 a[138:139], v64 offset:2048
    v_xor_b32 v64, 64, v64
    ds_read_b64_tr_b16 a[140:141], v64 offset:0
    ds_read_b64_tr_b16 a[142:143], v64 offset:2048
    s_waitcnt lgkmcnt(0)
    s_waitcnt vmcnt(16)
    s_barrier
    s_add_u32 m0, s60, 98304
    s_add_u32 s62, s74, 98304
    buffer_load_dwordx4 v62, s[24:27], s62 offen lds
    s_add_u32 m0, s60, 99328
    s_add_u32 s62, s74, 102400
    buffer_load_dwordx4 v62, s[24:27], s62 offen lds
    s_add_u32 m0, s60, 100352
    s_add_u32 s62, s74, 106496
    buffer_load_dwordx4 v62, s[24:27], s62 offen lds
    s_add_u32 m0, s60, 101376
    s_add_u32 s62, s74, 110592
    buffer_load_dwordx4 v62, s[24:27], s62 offen lds
    v_add_u32 v64, 114688, v63
    ds_read_b64_tr_b16 a[144:145], v64 offset:0
    ds_read_b64_tr_b16 a[146:147], v64 offset:2048
    v_xor_b32 v64, 64, v64
    ds_read_b64_tr_b16 a[148:149], v64 offset:0
    ds_read_b64_tr_b16 a[150:151], v64 offset:2048
    v_xor_b32 v64, 192, v64
    ds_read_b64_tr_b16 a[152:153], v64 offset:0
    ds_read_b64_tr_b16 a[154:155], v64 offset:2048
    v_xor_b32 v64, 64, v64
    ds_read_b64_tr_b16 a[156:157], v64 offset:0
    ds_read_b64_tr_b16 a[158:159], v64 offset:2048
    s_waitcnt lgkmcnt(0)
    s_waitcnt vmcnt(16)
    s_barrier
    s_add_u32 m0, s60, 114688
    s_add_u32 s62, s74, 114688
    buffer_load_dwordx4 v62, s[24:27], s62 offen lds
    s_add_u32 m0, s60, 115712
    s_add_u32 s62, s74, 118784
    buffer_load_dwordx4 v62, s[24:27], s62 offen lds
    s_add_u32 m0, s60, 116736
    s_add_u32 s62, s74, 122880
    buffer_load_dwordx4 v62, s[24:27], s62 offen lds
    s_add_u32 m0, s60, 117760
    s_add_u32 s62, s74, 126976
    buffer_load_dwordx4 v62, s[24:27], s62 offen lds
    v_add_u32 v64, 131072, v63
    ds_read_b64_tr_b16 a[160:161], v64 offset:0
    ds_read_b64_tr_b16 a[162:163], v64 offset:2048
    v_xor_b32 v64, 64, v64
    ds_read_b64_tr_b16 a[164:165], v64 offset:0
    ds_read_b64_tr_b16 a[166:167], v64 offset:2048
    v_xor_b32 v64, 192, v64
    ds_read_b64_tr_b16 a[168:169], v64 offset:0
    ds_read_b64_tr_b16 a[170:171], v64 offset:2048
    v_xor_b32 v64, 64, v64
    ds_read_b64_tr_b16 a[172:173], v64 offset:0
    ds_read_b64_tr_b16 a[174:175], v64 offset:2048
    s_waitcnt lgkmcnt(0)
    s_waitcnt vmcnt(16)
    s_barrier
    s_add_u32 m0, s60, 131072
    s_add_u32 s62, s63, 0
    buffer_load_dwordx4 v62, s[32:35], s62 offen lds
    s_add_u32 m0, s60, 132096
    s_add_u32 s62, s63, 4096
    buffer_load_dwordx4 v62, s[32:35], s62 offen lds
    s_add_u32 m0, s60, 133120
    s_add_u32 s62, s63, 8192
    buffer_load_dwordx4 v62, s[32:35], s62 offen lds
    s_add_u32 m0, s60, 134144
    s_add_u32 s62, s63, 12288
    buffer_load_dwordx4 v62, s[32:35], s62 offen lds
    v_add_u32 v64, 147456, v63
    ds_read_b64_tr_b16 a[176:177], v64 offset:0
    ds_read_b64_tr_b16 a[178:179], v64 offset:2048
    v_xor_b32 v64, 64, v64
    ds_read_b64_tr_b16 a[180:181], v64 offset:0
    ds_read_b64_tr_b16 a[182:183], v64 offset:2048
    v_xor_b32 v64, 192, v64
    ds_read_b64_tr_b16 a[184:185], v64 offset:0
    ds_read_b64_tr_b16 a[186:187], v64 offset:2048
    v_xor_b32 v64, 64, v64
    ds_read_b64_tr_b16 a[188:189], v64 offset:0
    ds_read_b64_tr_b16 a[190:191], v64 offset:2048
    s_waitcnt lgkmcnt(0)
    s_waitcnt vmcnt(16)
    s_barrier
    v_add_u32 v64, 65536, v63
    ds_read_b64_tr_b16 a[192:193], v64 offset:0
    ds_read_b64_tr_b16 a[194:195], v64 offset:2048
    v_xor_b32 v64, 64, v64
    ds_read_b64_tr_b16 a[196:197], v64 offset:0
    ds_read_b64_tr_b16 a[198:199], v64 offset:2048
    v_xor_b32 v64, 192, v64
    ds_read_b64_tr_b16 a[200:201], v64 offset:0
    ds_read_b64_tr_b16 a[202:203], v64 offset:2048
    v_xor_b32 v64, 64, v64
    ds_read_b64_tr_b16 a[204:205], v64 offset:0
    ds_read_b64_tr_b16 a[206:207], v64 offset:2048
    s_waitcnt lgkmcnt(0)
    s_waitcnt vmcnt(12)
    s_barrier
    v_add_u32 v64, 81920, v63
    ds_read_b64_tr_b16 a[208:209], v64 offset:0
    ds_read_b64_tr_b16 a[210:211], v64 offset:2048
    v_xor_b32 v64, 64, v64
    ds_read_b64_tr_b16 a[212:213], v64 offset:0
    ds_read_b64_tr_b16 a[214:215], v64 offset:2048
    v_xor_b32 v64, 192, v64
    ds_read_b64_tr_b16 a[216:217], v64 offset:0
    ds_read_b64_tr_b16 a[218:219], v64 offset:2048
    v_xor_b32 v64, 64, v64
    ds_read_b64_tr_b16 a[220:221], v64 offset:0
    ds_read_b64_tr_b16 a[222:223], v64 offset:2048
    s_waitcnt lgkmcnt(0)
    s_waitcnt vmcnt(8)
    s_barrier
    v_add_u32 v64, 98304, v63
    ds_read_b64_tr_b16 a[224:225], v64 offset:0
    ds_read_b64_tr_b16 a[226:227], v64 offset:2048
    v_xor_b32 v64, 64, v64
    ds_read_b64_tr_b16 a[228:229], v64 offset:0
    ds_read_b64_tr_b16 a[230:231], v64 offset:2048
    v_xor_b32 v64, 192, v64
    ds_read_b64_tr_b16 a[232:233], v64 offset:0
    ds_read_b64_tr_b16 a[234:235], v64 offset:2048
    v_xor_b32 v64, 64, v64
    ds_read_b64_tr_b16 a[236:237], v64 offset:0
    ds_read_b64_tr_b16 a[238:239], v64 offset:2048
    s_waitcnt lgkmcnt(0)
    s_waitcnt vmcnt(4)
    s_barrier
    v_add_u32 v64, 114688, v63
    ds_read_b64_tr_b16 a[240:241], v64 offset:0
    ds_read_b64_tr_b16 a[242:243], v64 offset:2048
    v_xor_b32 v64, 64, v64
    ds_read_b64_tr_b16 a[244:245], v64 offset:0
    ds_read_b64_tr_b16 a[246:247], v64 offset:2048
    v_xor_b32 v64, 192, v64
    ds_read_b64_tr_b16 a[248:249], v64 offset:0
    ds_read_b64_tr_b16 a[250:251], v64 offset:2048
    v_xor_b32 v64, 64, v64
    ds_read_b64_tr_b16 a[252:253], v64 offset:0
    ds_read_b64_tr_b16 a[254:255], v64 offset:2048
    s_waitcnt lgkmcnt(0)
    s_waitcnt vmcnt(0)
    s_barrier
    v_add_u32 v64, 131072, v63
    ds_read_b64_tr_b16 v[240:241], v64 offset:0
    ds_read_b64_tr_b16 v[242:243], v64 offset:2048
    v_xor_b32 v64, 64, v64
    ds_read_b64_tr_b16 v[244:245], v64 offset:0
    ds_read_b64_tr_b16 v[246:247], v64 offset:2048
    v_xor_b32 v64, 192, v64
    ds_read_b64_tr_b16 v[248:249], v64 offset:0
    ds_read_b64_tr_b16 v[250:251], v64 offset:2048
    v_xor_b32 v64, 64, v64
    ds_read_b64_tr_b16 v[252:253], v64 offset:0
    ds_read_b64_tr_b16 v[254:255], v64 offset:2048
    s_waitcnt lgkmcnt(0)
    s_barrier
    v_and_b32 v2, 1, v0
    v_lshlrev_b32 v2, 4, v2
    v_mov_b32 v3, 0x3f80
    v_lshlrev_b32 v3, v2, v3
    v_bfe_u32 v2, v0, 1, 3
    v_cmp_eq_u32 vcc, 0, v2
    s_nop 1
    v_cndmask_b32 v16, 0, v3, vcc
    v_cmp_eq_u32 vcc, 1, v2
    s_nop 1
    v_cndmask_b32 v17, 0, v3, vcc
    v_cmp_eq_u32 vcc, 2, v2
    s_nop 1
    v_cndmask_b32 v18, 0, v3, vcc
    v_cmp_eq_u32 vcc, 3, v2
    s_nop 1
    v_cndmask_b32 v19, 0, v3, vcc
    v_and_b32 v2, 31, v0
    v_lshrrev_b32 v3, 5, v0
    v_lshlrev_b32 v3, 2, v3
    v_sub_u32 v2, v2, v3
    v_mov_b32 v4, 0xf149f2ca
    v_cmp_le_i32 vcc, 0, v2
    s_nop 1
    v_cndmask_b32 v44, v4, 0, vcc
    v_cmp_le_i32 vcc, 1, v2
    s_nop 1
    v_cndmask_b32 v45, v4, 0, vcc
    v_cmp_le_i32 vcc, 2, v2
    s_nop 1
    v_cndmask_b32 v46, v4, 0, vcc
    v_cmp_le_i32 vcc, 3, v2
    s_nop 1
    v_cndmask_b32 v47, v4, 0, vcc
    v_cmp_le_i32 vcc, 8, v2
    s_nop 1
    v_cndmask_b32 v48, v4, 0, vcc
    v_cmp_le_i32 vcc, 9, v2
    s_nop 1
    v_cndmask_b32 v49, v4, 0, vcc
    v_cmp_le_i32 vcc, 10, v2
    s_nop 1
    v_cndmask_b32 v50, v4, 0, vcc
    v_cmp_le_i32 vcc, 11, v2
    s_nop 1
    v_cndmask_b32 v51, v4, 0, vcc
    v_cmp_le_i32 vcc, 16, v2
    s_nop 1
    v_cndmask_b32 v52, v4, 0, vcc
    v_cmp_le_i32 vcc, 17, v2
    s_nop 1
    v_cndmask_b32 v53, v4, 0, vcc
    v_cmp_le_i32 vcc, 18, v2
    s_nop 1
    v_cndmask_b32 v54, v4, 0, vcc
    v_cmp_le_i32 vcc, 19, v2
    s_nop 1
    v_cndmask_b32 v55, v4, 0, vcc
    v_cmp_le_i32 vcc, 24, v2
    s_nop 1
    v_cndmask_b32 v56, v4, 0, vcc
    v_cmp_le_i32 vcc, 25, v2
    s_nop 1
    v_cndmask_b32 v57, v4, 0, vcc
    v_cmp_le_i32 vcc, 26, v2
    s_nop 1
    v_cndmask_b32 v58, v4, 0, vcc
    v_cmp_le_i32 vcc, 27, v2
    s_nop 1
    v_cndmask_b32 v59, v4, 0, vcc
    s_lshl_b32 s3, s52, 11
    v_add_u32 v7, s3, v1
    v_add_u32 v7, 131072, v7
    v_add_u32 v8, 131072, v1
    v_bfe_u32 v9, v0, 0, 3
    v_mul_u32_u24 v9, 16, v9
    v_bfe_u32 v2, v0, 5, 1
    v_mul_u32_u24 v2, 128, v2
    v_add_u32 v9, v9, v2
    v_lshlrev_b32 v13, 3, v0
    v_mov_b32 v214, 0
    v_mov_b32 v215, 0
    v_mov_b32 v230, 0
    v_mov_b32 v231, 0
    v_bfe_u32 v10, v0, 0, 4
    v_mul_u32_u24 v10, 16, v10
    v_bfe_u32 v2, v0, 4, 2
    v_mul_u32_u24 v2, 1024, v2
    v_add_u32 v10, v10, v2
    s_lshl_b32 s3, s52, 8
    v_add_u32 v10, s3, v10
    v_bfe_u32 v11, v0, 0, 4
    v_mul_u32_u24 v11, 1024, v11
    v_bfe_u32 v2, v0, 4, 1
    v_mul_u32_u24 v2, 16, v2
    v_add_u32 v11, v11, v2
    s_and_b32 s3, s52, 1
    s_lshl_b32 s3, s3, 14
    v_add_u32 v11, s3, v11
    s_lshr_b32 s3, s52, 1
    s_lshl_b32 s3, s3, 3
    v_add_u32 v11, s3, v11
    s_lshl_b32 s3, s53, 5
    v_add_u32 v11, s3, v11
    s_mov_b32 s73, 0x3e0293ee
    s_lshl_b32 s70, s54, 7
    s_add_u32 s70, s70, 28672
    v_bfe_u32 v238, v0, 0, 3
    v_mul_u32_u24 v238, 16, v238
    v_bfe_u32 v2, v0, 3, 1
    v_mul_u32_u24 v2, 256, v2
    v_add_u32 v238, v238, v2
    v_bfe_u32 v2, v0, 4, 1
    v_mul_u32_u24 v2, 128, v2
    v_add_u32 v238, v238, v2
    v_bfe_u32 v2, v0, 5, 1
    v_mul_u32_u24 v2, 512, v2
    v_add_u32 v238, v238, v2
    s_lshl_b32 s3, s53, 7
    s_add_u32 s61, s3, 16384
    v_mov_b32 v14, s61
    s_add_u32 s61, s3, 20480
    v_writelane_b32 v14, s61, 32
    s_add_u32 s61, s3, 24576
    v_writelane_b32 v14, s61, 33
    s_add_u32 s61, s3, 0
    v_writelane_b32 v14, s61, 35
    s_add_u32 s61, s3, 4096
    v_writelane_b32 v14, s61, 36
    s_add_u32 s61, s3, 8192
    v_writelane_b32 v14, s61, 37
    s_add_u32 s61, s3, 12288
    v_writelane_b32 v14, s61, 38
    s_waitcnt vmcnt(0)
    s_barrier
    v_mov_b32 v4, 131072
    s_cmp_lg_u32 s52, 0
    s_cbranch_scc1 L_QA_NOTK
    s_mov_b32 s56, 0
    s_add_u32 s96, s54, 42
L_QA_STP:
    buffer_load_dword v2, v12, s[44:47], 0 offen sc1
    s_waitcnt vmcnt(0)
    v_readlane_b32 s3, v2, s96
    v_readlane_b32 s97, v2, 12
    v_readlane_b32 s59, v2, s55
    s_lshl_b32 s3, s3, 3
    s_min_u32 s3, s3, s97
    s_cmp_ge_u32 s3, 256
    s_cbranch_scc1 L_QA_STOK
    s_sleep 20
    s_add_u32 s56, s56, 1
    s_cmp_gt_u32 s56, 60000
    s_cbranch_scc1 L_TIMEOUT_1
    s_branch L_QA_STP
.p2align 5
L_QA_STOK:
    v_mov_b32 v2, s59
    ds_write_b32 v4, v2
    s_waitcnt lgkmcnt(0)
L_QA_NOTK:
    s_barrier
    ds_read_b32 v2, v4
    s_waitcnt lgkmcnt(0)
    v_readfirstlane_b32 s59, v2
    s_mov_b32 s83, 0
    s_mov_b32 s89, s79
    s_add_u32 s61, s54, 8
    s_lshl_b32 s69, s61, 15
    s_lshl_b32 s78, s52, 13
    s_add_u32 s78, s78, 65536
    s_add_u32 m0, s78, 0
    s_nop 0
    buffer_load_dwordx4 v20, s[4:7], s69 offen lds
    s_add_u32 m0, s78, 1024
    s_nop 0
    buffer_load_dwordx4 v21, s[4:7], s69 offen lds
    s_add_u32 m0, s78, 2048
    s_nop 0
    buffer_load_dwordx4 v22, s[4:7], s69 offen lds
    s_add_u32 m0, s78, 3072
    s_nop 0
    buffer_load_dwordx4 v23, s[4:7], s69 offen lds
    s_add_u32 m0, s78, 4096
    s_nop 0
    buffer_load_dwordx4 v24, s[4:7], s69 offen lds
    s_add_u32 m0, s78, 5120
    s_nop 0
    buffer_load_dwordx4 v25, s[4:7], s69 offen lds
    s_add_u32 m0, s78, 6144
    s_nop 0
    buffer_load_dwordx4 v26, s[4:7], s69 offen lds
    s_add_u32 m0, s78, 7168
    s_nop 0
    buffer_load_dwordx4 v27, s[4:7], s69 offen lds
    s_mov_b32 s65, 0
    s_mov_b32 s68, 0
    s_mov_b32 s80, 0
    s_mov_b32 s81, 0
    s_mov_b32 s77, 0
L_QA_LOOP:
    s_barrier
    s_mov_b32 s56, 0
L_QA_W_20:
    s_cmp_gt_u32 s80, s67
    s_cbranch_scc1 L_QA_WD_21
    s_sleep 1
    buffer_load_dword v15, v14, s[48:51], 0 offen sc1
    s_waitcnt vmcnt(0)
    v_readlane_b32 s84, v15, 32
    v_readlane_b32 s85, v15, 33
    v_readlane_b32 s81, v15, 34
    v_readlane_b32 s86, v15, 35
    v_readlane_b32 s87, v15, 36
    v_readlane_b32 s88, v15, 37
    v_readlane_b32 s96, v15, 38
    s_add_u32 s85, s85, 24
    s_cmp_lt_u32 s84, 24
    s_cselect_b32 s80, s84, s85
    s_mul_i32 s86, s86, 4
    s_min_u32 s80, s80, s86
    s_mul_i32 s87, s87, 4
    s_add_u32 s87, s87, 1
    s_min_u32 s80, s80, s87
    s_mul_i32 s88, s88, 4
    s_add_u32 s88, s88, 2
    s_min_u32 s80, s80, s88
    s_mul_i32 s96, s96, 4
    s_add_u32 s96, s96, 3
    s_min_u32 s80, s80, s96
    s_add_u32 s56, s56, 1
    s_cmp_gt_u32 s56, 60000
    s_cbranch_scc1 L_TIMEOUT_6
    s_branch L_QA_W_20
.p2align 5
L_QA_WD_21:
    s_lshl_b32 s75, s67, 5
    s_add_u32 s75, s75, s53
    s_mov_b32 s95, 0
    s_cmp_gt_u32 s81, s67
    s_cbranch_scc0 L_QA_NOKM
    s_lshl_b32 s63, s75, 12
    s_add_u32 s62, s63, 8388608
    s_add_u32 s63, s63, 50331648
    buffer_load_dwordx4 v[140:143], v9, s[48:51], s63 offen offset:0 sc1
    buffer_load_dwordx4 v[144:147], v9, s[48:51], s63 offen offset:256 sc1
    buffer_load_dwordx4 v[148:151], v9, s[48:51], s63 offen offset:512 sc1
    buffer_load_dwordx4 v[152:155], v9, s[48:51], s63 offen offset:768 sc1
    buffer_load_dwordx4 v[156:159], v9, s[48:51], s63 offen offset:1024 sc1
    buffer_load_dwordx4 v[160:163], v9, s[48:51], s63 offen offset:1280 sc1
    buffer_load_dwordx4 v[164:167], v9, s[48:51], s63 offen offset:1536 sc1
    buffer_load_dwordx4 v[168:171], v9, s[48:51], s63 offen offset:1792 sc1
    s_lshl_b32 s3, s52, 9
    s_add_u32 s62, s62, s3
    buffer_load_dwordx2 v[212:213], v13, s[48:51], s62 offen sc1
    s_mov_b32 s95, 1
L_QA_NOKM:
    v_add_u32 v36, s68, v28
    v_add_u32 v37, s68, v29
    v_add_u32 v38, s68, v30
    v_add_u32 v39, s68, v31
    v_add_u32 v40, s68, v32
    v_add_u32 v41, s68, v33
    v_add_u32 v42, s68, v34
    v_add_u32 v43, s68, v35
    ds_read_b128 v[60:63], v36 offset:0
    ds_read_b128 v[64:67], v37 offset:0
    ds_read_b128 v[68:71], v38 offset:0
    ds_read_b128 v[72:75], v39 offset:0
    ds_read_b128 v[76:79], v40 offset:0
    ds_read_b128 v[80:83], v41 offset:0
    ds_read_b128 v[84:87], v42 offset:0
    s_add_u32 s61, s67, 12
    s_add_u32 s62, s68, 98304
    s_and_b32 s62, s62, 0x1ffff
    s_lshl_b32 s69, s61, 15
    s_lshl_b32 s78, s52, 13
    s_add_u32 s78, s78, s62
    s_lshl_b32 s90, s75, 13
    s_add_u32 s90, s90, 16777216
    s_add_u32 s91, s90, 4096
    s_lshl_b32 s3, s52, 11
    s_add_u32 s92, s90, s3
    s_add_u32 s92, s92, 16777216
    s_lshl_b32 s93, s53, 16
    s_lshl_b32 s3, s67, 10
    s_add_u32 s93, s93, s3
    s_add_u32 s93, s93, 2097152
    s_lshl_b32 s94, s53, 13
    s_lshl_b32 s3, s67, 7
    s_add_u32 s94, s94, s3
    s_add_u32 s94, s94, 1048576
    v_and_b32 v4, 0x7f, v12
    s_waitcnt lgkmcnt(6)
    v_mfma_f32_32x32x16_bf16 v[92:107], a[0:3], v[60:63], 0
    ds_read_b128 v[88:91], v43 offset:0
    buffer_load_dwordx4 v[108:111], v238, s[48:51], s90 offen offset:0 sc1
    s_waitcnt lgkmcnt(6)
    v_mfma_f32_32x32x16_bf16 v[92:107], a[4:7], v[64:67], v[92:107]
    ds_read_b128 v[60:63], v36 offset:256
    buffer_load_dwordx4 v[112:115], v238, s[48:51], s90 offen offset:1024 sc1
    s_waitcnt lgkmcnt(6)
    v_mfma_f32_32x32x16_bf16 v[92:107], a[8:11], v[68:71], v[92:107]
    ds_read_b128 v[64:67], v37 offset:256
    buffer_load_dwordx4 v[116:119], v238, s[48:51], s90 offen offset:2048 sc1
    s_waitcnt lgkmcnt(6)
    v_mfma_f32_32x32x16_bf16 v[92:107], a[12:15], v[72:75], v[92:107]
    ds_read_b128 v[68:71], v38 offset:256
    buffer_load_dwordx4 v[120:123], v238, s[48:51], s90 offen offset:3072 sc1
    s_waitcnt lgkmcnt(6)
    v_mfma_f32_32x32x16_bf16 v[92:107], a[16:19], v[76:79], v[92:107]
    ds_read_b128 v[72:75], v39 offset:256
    buffer_load_dwordx4 v[124:127], v238, s[48:51], s91 offen offset:0 sc1
    s_waitcnt lgkmcnt(6)
    v_mfma_f32_32x32x16_bf16 v[92:107], a[20:23], v[80:83], v[92:107]
    ds_read_b128 v[76:79], v40 offset:256
    buffer_load_dwordx4 v[128:131], v238, s[48:51], s91 offen offset:1024 sc1
    s_waitcnt lgkmcnt(6)
    v_mfma_f32_32x32x16_bf16 v[92:107], a[24:27], v[84:87], v[92:107]
    ds_read_b128 v[80:83], v41 offset:256
    buffer_load_dwordx4 v[132:135], v238, s[48:51], s91 offen offset:2048 sc1
    s_waitcnt lgkmcnt(6)
    v_mfma_f32_32x32x16_bf16 v[92:107], a[28:31], v[88:91], v[92:107]
    ds_read_b128 v[84:87], v42 offset:256
    buffer_load_dwordx4 v[136:139], v238, s[48:51], s91 offen offset:3072 sc1
    s_waitcnt lgkmcnt(6)
    v_mfma_f32_32x32x16_bf16 v[92:107], a[32:35], v[60:63], v[92:107]
    ds_read_b128 v[88:91], v43 offset:256
    buffer_load_dwordx4 v[204:207], v1, s[48:51], s92 offen offset:0 sc1
    s_waitcnt lgkmcnt(6)
    v_mfma_f32_32x32x16_bf16 v[92:107], a[36:39], v[64:67], v[92:107]
    ds_read_b128 v[60:63], v36 offset:512
    buffer_load_dwordx4 v[208:211], v1, s[48:51], s92 offen offset:1024 sc1
    s_waitcnt lgkmcnt(6)
    v_mfma_f32_32x32x16_bf16 v[92:107], a[40:43], v[68:71], v[92:107]
    ds_read_b128 v[64:67], v37 offset:512
    buffer_load_dwordx4 v[216:219], v1, s[48:51], s93 offen sc1
    s_waitcnt lgkmcnt(6)
    v_mfma_f32_32x32x16_bf16 v[92:107], a[44:47], v[72:75], v[92:107]
    ds_read_b128 v[68:71], v38 offset:512
    buffer_load_dword v6, v4, s[48:51], s94 offen sc1
    s_waitcnt lgkmcnt(6)
    v_mfma_f32_32x32x16_bf16 v[92:107], a[48:51], v[76:79], v[92:107]
    ds_read_b128 v[72:75], v39 offset:512
    s_add_u32 m0, s78, 0
    s_nop 0
    buffer_load_dwordx4 v20, s[4:7], s69 offen lds
    s_waitcnt lgkmcnt(6)
    v_mfma_f32_32x32x16_bf16 v[92:107], a[52:55], v[80:83], v[92:107]
    ds_read_b128 v[76:79], v40 offset:512
    s_add_u32 m0, s78, 1024
    s_nop 0
    buffer_load_dwordx4 v21, s[4:7], s69 offen lds
    s_waitcnt lgkmcnt(6)
    v_mfma_f32_32x32x16_bf16 v[92:107], a[56:59], v[84:87], v[92:107]
    ds_read_b128 v[80:83], v41 offset:512
    s_add_u32 m0, s78, 2048
    s_nop 0
    buffer_load_dwordx4 v22, s[4:7], s69 offen lds
    s_waitcnt lgkmcnt(6)
    v_mfma_f32_32x32x16_bf16 v[92:107], a[60:63], v[88:91], v[92:107]
    ds_read_b128 v[84:87], v42 offset:512
    s_add_u32 m0, s78, 3072
    s_nop 0
    buffer_load_dwordx4 v23, s[4:7], s69 offen lds
    s_waitcnt lgkmcnt(6)
    v_mfma_f32_32x32x16_bf16 v[92:107], a[64:67], v[60:63], v[92:107]
    ds_read_b128 v[88:91], v43 offset:512
    s_add_u32 m0, s78, 4096
    s_nop 0
    buffer_load_dwordx4 v24, s[4:7], s69 offen lds
    s_waitcnt lgkmcnt(6)
    v_mfma_f32_32x32x16_bf16 v[92:107], a[68:71], v[64:67], v[92:107]
    ds_read_b128 v[60:63], v36 offset:768
    s_add_u32 m0, s78, 5120
    s_nop 0
    buffer_load_dwordx4 v25, s[4:7], s69 offen lds
    s_waitcnt lgkmcnt(6)
    v_mfma_f32_32x32x16_bf16 v[92:107], a[72:75], v[68:71], v[92:107]
    ds_read_b128 v[64:67], v37 offset:768
    s_add_u32 m0, s78, 6144
    s_nop 0
    buffer_load_dwordx4 v26, s[4:7], s69 offen lds
    s_waitcnt lgkmcnt(6)
    v_mfma_f32_32x32x16_bf16 v[92:107], a[76:79], v[72:75], v[92:107]
    ds_read_b128 v[68:71], v38 offset:768
    s_add_u32 m0, s78, 7168
    s_nop 0
    buffer_load_dwordx4 v27, s[4:7], s69 offen lds
    s_waitcnt lgkmcnt(6)
    v_mfma_f32_32x32x16_bf16 v[92:107], a[80:83], v[76:79], v[92:107]
    ds_read_b128 v[72:75], v39 offset:768
    s_waitcnt lgkmcnt(6)
    v_mfma_f32_32x32x16_bf16 v[92:107], a[84:87], v[80:83], v[92:107]
    ds_read_b128 v[76:79], v40 offset:768
    s_waitcnt lgkmcnt(6)
    v_mfma_f32_32x32x16_bf16 v[92:107], a[88:91], v[84:87], v[92:107]
    ds_read_b128 v[80:83], v41 offset:768
    s_waitcnt lgkmcnt(6)
    v_mfma_f32_32x32x16_bf16 v[92:107], a[92:95], v[88:91], v[92:107]
    ds_read_b128 v[84:87], v42 offset:768
    s_waitcnt lgkmcnt(6)
    v_mfma_f32_32x32x16_bf16 v[92:107], a[96:99], v[60:63], v[92:107]
    ds_read_b128 v[88:91], v43 offset:768
    s_waitcnt lgkmcnt(6)
    v_mfma_f32_32x32x16_bf16 v[92:107], a[100:103], v[64:67], v[92:107]
    s_waitcnt lgkmcnt(5)
    v_mfma_f32_32x32x16_bf16 v[92:107], a[104:107], v[68:71], v[92:107]
    s_waitcnt lgkmcnt(4)
    v_mfma_f32_32x32x16_bf16 v[92:107], a[108:111], v[72:75], v[92:107]
    s_waitcnt lgkmcnt(3)
    v_mfma_f32_32x32x16_bf16 v[92:107], a[112:115], v[76:79], v[92:107]
    s_waitcnt lgkmcnt(2)
    v_mfma_f32_32x32x16_bf16 v[92:107], a[116:119], v[80:83], v[92:107]
    s_waitcnt lgkmcnt(1)
    v_mfma_f32_32x32x16_bf16 v[92:107], a[120:123], v[84:87], v[92:107]
    s_waitcnt lgkmcnt(0)
    v_mfma_f32_32x32x16_bf16 v[92:107], a[124:127], v[88:91], v[92:107]
    buffer_load_dword v15, v14, s[48:51], 0 offen sc1
    s_nop 10
    v_cvt_pk_bf16_f32 v220, v92, v93
    v_cvt_pk_bf16_f32 v221, v94, v95
    v_cvt_pk_bf16_f32 v222, v96, v97
    v_cvt_pk_bf16_f32 v223, v98, v99
    v_cvt_pk_bf16_f32 v224, v100, v101
    v_cvt_pk_bf16_f32 v225, v102, v103
    v_cvt_pk_bf16_f32 v226, v104, v105
    v_cvt_pk_bf16_f32 v227, v106, v107
    ds_write_b128 v7, v[220:223]
    ds_write_b128 v7, v[224:227] offset:1024
    s_waitcnt lgkmcnt(0)
    s_barrier
    ds_read_b128 v[60:63], v8 offset:0
    ds_read_b128 v[64:67], v8 offset:1024
    ds_read_b128 v[68:71], v8 offset:2048
    ds_read_b128 v[72:75], v8 offset:3072
    ds_read_b128 v[76:79], v8 offset:4096
    ds_read_b128 v[80:83], v8 offset:5120
    ds_read_b128 v[84:87], v8 offset:6144
    ds_read_b128 v[88:91], v8 offset:7168
    s_waitcnt vmcnt(9) lgkmcnt(0)
    v_mfma_f32_32x32x16_bf16 v[172:187], v[108:111], v[60:63], v[44:59]
    v_mfma_f32_32x32x16_bf16 v[172:187], v[112:115], v[64:67], v[172:187]
    v_mfma_f32_32x32x16_bf16 v[172:187], v[116:119], v[68:71], v[172:187]
    v_mfma_f32_32x32x16_bf16 v[172:187], v[120:123], v[72:75], v[172:187]
    v_mfma_f32_32x32x16_bf16 v[172:187], v[124:127], v[76:79], v[172:187]
    v_mfma_f32_32x32x16_bf16 v[172:187], v[128:131], v[80:83], v[172:187]
    v_mfma_f32_32x32x16_bf16 v[172:187], v[132:135], v[84:87], v[172:187]
    v_mfma_f32_32x32x16_bf16 v[172:187], v[136:139], v[88:91], v[172:187]
    s_nop 11
    v_max3_f32 v5, v172, v173, v174
    v_max_f32 v2, v175, v176
    v_max3_f32 v5, v5, v177, v178
    v_max3_f32 v2, v2, v179, v180
    v_max3_f32 v5, v5, v181, v182
    v_max3_f32 v2, v2, v183, v184
    v_max3_f32 v5, v5, v185, v186
    v_max3_f32 v5, v5, v2, v187
    v_mov_b32 v2, v5
    s_nop 1
    v_permlane32_swap_b32 v5, v2
    v_max_f32 v5, v5, v2
    v_mul_f32 v5, s73, v5
    v_fma_f32 v172, v172, s73, -v5
    v_fma_f32 v173, v173, s73, -v5
    v_fma_f32 v174, v174, s73, -v5
    v_fma_f32 v175, v175, s73, -v5
    v_fma_f32 v176, v176, s73, -v5
    v_fma_f32 v177, v177, s73, -v5
    v_fma_f32 v178, v178, s73, -v5
    v_fma_f32 v179, v179, s73, -v5
    v_fma_f32 v180, v180, s73, -v5
    v_fma_f32 v181, v181, s73, -v5
    v_fma_f32 v182, v182, s73, -v5
    v_fma_f32 v183, v183, s73, -v5
    v_fma_f32 v184, v184, s73, -v5
    v_fma_f32 v185, v185, s73, -v5
    v_fma_f32 v186, v186, s73, -v5
    v_fma_f32 v187, v187, s73, -v5
    v_exp_f32 v172, v172
    v_exp_f32 v173, v173
    v_exp_f32 v174, v174
    v_exp_f32 v175, v175
    v_exp_f32 v176, v176
    v_exp_f32 v177, v177
    v_exp_f32 v178, v178
    v_exp_f32 v179, v179
    v_exp_f32 v180, v180
    v_exp_f32 v181, v181
    v_exp_f32 v182, v182
    v_exp_f32 v183, v183
    v_exp_f32 v184, v184
    v_exp_f32 v185, v185
    v_exp_f32 v186, v186
    v_exp_f32 v187, v187
    v_cvt_pk_bf16_f32 v220, v172, v173
    v_cvt_pk_bf16_f32 v221, v174, v175
    v_cvt_pk_bf16_f32 v222, v176, v177
    v_cvt_pk_bf16_f32 v223, v178, v179
    v_cvt_pk_bf16_f32 v224, v180, v181
    v_cvt_pk_bf16_f32 v225, v182, v183
    v_cvt_pk_bf16_f32 v226, v184, v185
    v_cvt_pk_bf16_f32 v227, v186, v187
    v_mfma_f32_32x32x16_bf16 v[92:107], v[204:207], v[220:223], 0
    s_nop 0
    v_mfma_f32_32x32x16_bf16 v[92:107], v[208:211], v[224:227], v[92:107]
    v_add_f32 v239, v172, v173
    v_add_f32 v3, v174, v175
    v_add_f32 v239, v239, v176
    v_add_f32 v3, v3, v177
    v_add_f32 v239, v239, v178
    v_add_f32 v3, v3, v179
    v_add_f32 v239, v239, v180
    v_add_f32 v3, v3, v181
    v_add_f32 v239, v239, v182
    v_add_f32 v3, v3, v183
    v_add_f32 v239, v239, v184
    v_add_f32 v3, v3, v185
    v_add_f32 v239, v239, v186
    v_add_f32 v3, v3, v187
    v_add_f32 v239, v239, v3
    s_waitcnt vmcnt(0)
    v_readlane_b32 s84, v15, 32
    v_readlane_b32 s85, v15, 33
    v_readlane_b32 s81, v15, 34
    v_readlane_b32 s86, v15, 35
    v_readlane_b32 s87, v15, 36
    v_readlane_b32 s88, v15, 37
    v_readlane_b32 s96, v15, 38
    s_add_u32 s85, s85, 24
    s_cmp_lt_u32 s84, 24
    s_cselect_b32 s80, s84, s85
    s_mul_i32 s86, s86, 4
    s_min_u32 s80, s80, s86
    s_mul_i32 s87, s87, 4
    s_add_u32 s87, s87, 1
    s_min_u32 s80, s80, s87
    s_mul_i32 s88, s88, 4
    s_add_u32 s88, s88, 2
    s_min_u32 s80, s80, s88
    s_mul_i32 s96, s96, 4
    s_add_u32 s96, s96, 3
    s_min_u32 s80, s80, s96
    s_cmp_eq_u32 s95, 1
    s_cbranch_scc1 L_QA_HAVEKM
    s_cmp_ge_u32 s67, 32
    s_cselect_b32 s97, 3, 0
    s_sub_u32 s67, s67, s97
    s_mov_b32 s56, 0
L_QA_W_22:
    s_cmp_gt_u32 s81, s67
    s_cbranch_scc1 L_QA_WD_23
    s_sleep 1
    buffer_load_dword v15, v14, s[48:51], 0 offen sc1
    s_waitcnt vmcnt(0)
    v_readlane_b32 s84, v15, 32
    v_readlane_b32 s85, v15, 33
    v_readlane_b32 s81, v15, 34
    v_readlane_b32 s86, v15, 35
    v_readlane_b32 s87, v15, 36
    v_readlane_b32 s88, v15, 37
    v_readlane_b32 s96, v15, 38
    s_add_u32 s85, s85, 24
    s_cmp_lt_u32 s84, 24
    s_cselect_b32 s80, s84, s85
    s_mul_i32 s86, s86, 4
    s_min_u32 s80, s80, s86
    s_mul_i32 s87, s87, 4
    s_add_u32 s87, s87, 1
    s_min_u32 s80, s80, s87
    s_mul_i32 s88, s88, 4
    s_add_u32 s88, s88, 2
    s_min_u32 s80, s80, s88
    s_mul_i32 s96, s96, 4
    s_add_u32 s96, s96, 3
    s_min_u32 s80, s80, s96
    s_add_u32 s56, s56, 1
    s_cmp_gt_u32 s56, 60000
    s_cbranch_scc1 L_TIMEOUT_7
    s_branch L_QA_W_22
.p2align 5
L_QA_WD_23:
    s_add_u32 s67, s67, s97
    s_mov_b32 s56, 0
    s_cmp_gt_u32 s81, s67
    s_cbranch_scc1 L_QA_KMFL
    s_lshl_b32 s63, s75, 12
    s_add_u32 s62, s63, 8388608
    s_add_u32 s63, s63, 50331648
    buffer_load_dwordx4 v[140:143], v9, s[48:51], s63 offen offset:0 sc1
    buffer_load_dwordx4 v[144:147], v9, s[48:51], s63 offen offset:256 sc1
    buffer_load_dwordx4 v[148:151], v9, s[48:51], s63 offen offset:512 sc1
    buffer_load_dwordx4 v[152:155], v9, s[48:51], s63 offen offset:768 sc1
    buffer_load_dwordx4 v[156:159], v9, s[48:51], s63 offen offset:1024 sc1
    buffer_load_dwordx4 v[160:163], v9, s[48:51], s63 offen offset:1280 sc1
    buffer_load_dwordx4 v[164:167], v9, s[48:51], s63 offen offset:1536 sc1
    buffer_load_dwordx4 v[168:171], v9, s[48:51], s63 offen offset:1792 sc1
    s_lshl_b32 s3, s52, 9
    s_add_u32 s62, s62, s3
    buffer_load_dwordx2 v[204:205], v13, s[48:51], s62 offen sc1
    s_sleep 12
    s_lshl_b32 s63, s75, 12
    s_add_u32 s62, s63, 8388608
    s_add_u32 s63, s63, 50331648
    buffer_load_dwordx4 v[108:111], v9, s[48:51], s63 offen offset:0 sc1
    buffer_load_dwordx4 v[112:115], v9, s[48:51], s63 offen offset:256 sc1
    buffer_load_dwordx4 v[116:119], v9, s[48:51], s63 offen offset:512 sc1
    buffer_load_dwordx4 v[120:123], v9, s[48:51], s63 offen offset:768 sc1
    buffer_load_dwordx4 v[124:127], v9, s[48:51], s63 offen offset:1024 sc1
    buffer_load_dwordx4 v[128:131], v9, s[48:51], s63 offen offset:1280 sc1
    buffer_load_dwordx4 v[132:135], v9, s[48:51], s63 offen offset:1536 sc1
    buffer_load_dwordx4 v[136:139], v9, s[48:51], s63 offen offset:1792 sc1
    s_lshl_b32 s3, s52, 9
    s_add_u32 s62, s62, s3
    buffer_load_dwordx2 v[206:207], v13, s[48:51], s62 offen sc1
L_QA_KMP:
    s_waitcnt vmcnt(9)
    v_fma_f32 v2, v140, v142, v204
    v_fma_f32 v3, v144, v146, v205
    v_fma_f32 v2, v148, v150, v2
    v_fma_f32 v3, v152, v154, v3
    v_fma_f32 v2, v156, v158, v2
    v_fma_f32 v3, v160, v162, v3
    v_fma_f32 v2, v164, v166, v2
    v_fma_f32 v3, v168, v170, v3
    v_cmp_u_f32 vcc, v2, v3
    s_cbranch_vccz L_QA_KMA
    s_lshl_b32 s63, s75, 12
    s_add_u32 s62, s63, 8388608
    s_add_u32 s63, s63, 50331648
    buffer_load_dwordx4 v[140:143], v9, s[48:51], s63 offen offset:0 sc1
    buffer_load_dwordx4 v[144:147], v9, s[48:51], s63 offen offset:256 sc1
    buffer_load_dwordx4 v[148:151], v9, s[48:51], s63 offen offset:512 sc1
    buffer_load_dwordx4 v[152:155], v9, s[48:51], s63 offen offset:768 sc1
    buffer_load_dwordx4 v[156:159], v9, s[48:51], s63 offen offset:1024 sc1
    buffer_load_dwordx4 v[160:163], v9, s[48:51], s63 offen offset:1280 sc1
    buffer_load_dwordx4 v[164:167], v9, s[48:51], s63 offen offset:1536 sc1
    buffer_load_dwordx4 v[168:171], v9, s[48:51], s63 offen offset:1792 sc1
    s_lshl_b32 s3, s52, 9
    s_add_u32 s62, s62, s3
    buffer_load_dwordx2 v[204:205], v13, s[48:51], s62 offen sc1
    s_waitcnt vmcnt(9)
    v_fma_f32 v2, v108, v110, v206
    v_fma_f32 v3, v112, v114, v207
    v_fma_f32 v2, v116, v118, v2
    v_fma_f32 v3, v120, v122, v3
    v_fma_f32 v2, v124, v126, v2
    v_fma_f32 v3, v128, v130, v3
    v_fma_f32 v2, v132, v134, v2
    v_fma_f32 v3, v136, v138, v3
    v_cmp_u_f32 vcc, v2, v3
    s_cbranch_vccz L_QA_KMB
    s_lshl_b32 s63, s75, 12
    s_add_u32 s62, s63, 8388608
    s_add_u32 s63, s63, 50331648
    buffer_load_dwordx4 v[108:111], v9, s[48:51], s63 offen offset:0 sc1
    buffer_load_dwordx4 v[112:115], v9, s[48:51], s63 offen offset:256 sc1
    buffer_load_dwordx4 v[116:119], v9, s[48:51], s63 offen offset:512 sc1
    buffer_load_dwordx4 v[120:123], v9, s[48:51], s63 offen offset:768 sc1
    buffer_load_dwordx4 v[124:127], v9, s[48:51], s63 offen offset:1024 sc1
    buffer_load_dwordx4 v[128:131], v9, s[48:51], s63 offen offset:1280 sc1
    buffer_load_dwordx4 v[132:135], v9, s[48:51], s63 offen offset:1536 sc1
    buffer_load_dwordx4 v[136:139], v9, s[48:51], s63 offen offset:1792 sc1
    s_lshl_b32 s3, s52, 9
    s_add_u32 s62, s62, s3
    buffer_load_dwordx2 v[206:207], v13, s[48:51], s62 offen sc1
    s_add_u32 s56, s56, 1
    s_cmp_gt_u32 s56, 60000
    s_cbranch_scc1 L_TIMEOUT_7
    s_and_b32 s3, s56, 7
    s_cbranch_scc1 L_QA_KMP
    buffer_load_dword v15, v14, s[48:51], 0 offen sc1
    s_waitcnt vmcnt(0)
    v_readlane_b32 s84, v15, 32
    v_readlane_b32 s85, v15, 33
    v_readlane_b32 s81, v15, 34
    v_readlane_b32 s86, v15, 35
    v_readlane_b32 s87, v15, 36
    v_readlane_b32 s88, v15, 37
    v_readlane_b32 s96, v15, 38
    s_add_u32 s85, s85, 24
    s_cmp_lt_u32 s84, 24
    s_cselect_b32 s80, s84, s85
    s_mul_i32 s86, s86, 4
    s_min_u32 s80, s80, s86
    s_mul_i32 s87, s87, 4
    s_add_u32 s87, s87, 1
    s_min_u32 s80, s80, s87
    s_mul_i32 s88, s88, 4
    s_add_u32 s88, s88, 2
    s_min_u32 s80, s80, s88
    s_mul_i32 s96, s96, 4
    s_add_u32 s96, s96, 3
    s_min_u32 s80, s80, s96
    s_cmp_gt_u32 s81, s67
    s_cbranch_scc1 L_QA_KMFL
    s_lshl_b32 s63, s75, 12
    s_add_u32 s62, s63, 8388608
    s_add_u32 s63, s63, 50331648
    buffer_load_dwordx4 v[140:143], v9, s[48:51], s63 offen offset:0 sc1
    buffer_load_dwordx4 v[144:147], v9, s[48:51], s63 offen offset:256 sc1
    buffer_load_dwordx4 v[148:151], v9, s[48:51], s63 offen offset:512 sc1
    buffer_load_dwordx4 v[152:155], v9, s[48:51], s63 offen offset:768 sc1
    buffer_load_dwordx4 v[156:159], v9, s[48:51], s63 offen offset:1024 sc1
    buffer_load_dwordx4 v[160:163], v9, s[48:51], s63 offen offset:1280 sc1
    buffer_load_dwordx4 v[164:167], v9, s[48:51], s63 offen offset:1536 sc1
    buffer_load_dwordx4 v[168:171], v9, s[48:51], s63 offen offset:1792 sc1
    s_lshl_b32 s3, s52, 9
    s_add_u32 s62, s62, s3
    buffer_load_dwordx2 v[204:205], v13, s[48:51], s62 offen sc1
    s_sleep 12
    s_lshl_b32 s63, s75, 12
    s_add_u32 s62, s63, 8388608
    s_add_u32 s63, s63, 50331648
    buffer_load_dwordx4 v[108:111], v9, s[48:51], s63 offen offset:0 sc1
    buffer_load_dwordx4 v[112:115], v9, s[48:51], s63 offen offset:256 sc1
    buffer_load_dwordx4 v[116:119], v9, s[48:51], s63 offen offset:512 sc1
    buffer_load_dwordx4 v[120:123], v9, s[48:51], s63 offen offset:768 sc1
    buffer_load_dwordx4 v[124:127], v9, s[48:51], s63 offen offset:1024 sc1
    buffer_load_dwordx4 v[128:131], v9, s[48:51], s63 offen offset:1280 sc1
    buffer_load_dwordx4 v[132:135], v9, s[48:51], s63 offen offset:1536 sc1
    buffer_load_dwordx4 v[136:139], v9, s[48:51], s63 offen offset:1792 sc1
    s_lshl_b32 s3, s52, 9
    s_add_u32 s62, s62, s3
    buffer_load_dwordx2 v[206:207], v13, s[48:51], s62 offen sc1
    s_branch L_QA_KMP
.p2align 5
L_QA_KMB:
    v_mov_b64 v[212:213], v[206:207]
    v_mfma_f32_32x32x16_bf16 v[188:203], v[108:111], v[60:63], 0
    v_mfma_f32_32x32x16_bf16 v[188:203], v[112:115], v[64:67], v[188:203]
    v_mfma_f32_32x32x16_bf16 v[188:203], v[116:119], v[68:71], v[188:203]
    v_mfma_f32_32x32x16_bf16 v[188:203], v[120:123], v[72:75], v[188:203]
    v_mfma_f32_32x32x16_bf16 v[188:203], v[124:127], v[76:79], v[188:203]
    v_mfma_f32_32x32x16_bf16 v[188:203], v[128:131], v[80:83], v[188:203]
    v_mfma_f32_32x32x16_bf16 v[188:203], v[132:135], v[84:87], v[188:203]
    v_mfma_f32_32x32x16_bf16 v[188:203], v[136:139], v[88:91], v[188:203]
    s_branch L_QA_KMOK
.p2align 5
L_QA_KMFL:
    s_lshl_b32 s63, s75, 12
    s_add_u32 s62, s63, 8388608
    s_add_u32 s63, s63, 50331648
    buffer_load_dwordx4 v[140:143], v9, s[48:51], s63 offen offset:0 sc1
    buffer_load_dwordx4 v[144:147], v9, s[48:51], s63 offen offset:256 sc1
    buffer_load_dwordx4 v[148:151], v9, s[48:51], s63 offen offset:512 sc1
    buffer_load_dwordx4 v[152:155], v9, s[48:51], s63 offen offset:768 sc1
    buffer_load_dwordx4 v[156:159], v9, s[48:51], s63 offen offset:1024 sc1
    buffer_load_dwordx4 v[160:163], v9, s[48:51], s63 offen offset:1280 sc1
    buffer_load_dwordx4 v[164:167], v9, s[48:51], s63 offen offset:1536 sc1
    buffer_load_dwordx4 v[168:171], v9, s[48:51], s63 offen offset:1792 sc1
    s_lshl_b32 s3, s52, 9
    s_add_u32 s62, s62, s3
    buffer_load_dwordx2 v[204:205], v13, s[48:51], s62 offen sc1
    s_waitcnt vmcnt(0)
L_QA_KMA:
    v_mov_b64 v[212:213], v[204:205]
L_QA_HAVEKM:
    v_mfma_f32_32x32x16_bf16 v[188:203], v[140:143], v[60:63], 0
    v_mfma_f32_32x32x16_bf16 v[188:203], v[144:147], v[64:67], v[188:203]
    v_mfma_f32_32x32x16_bf16 v[188:203], v[148:151], v[68:71], v[188:203]
    v_mfma_f32_32x32x16_bf16 v[188:203], v[152:155], v[72:75], v[188:203]
    v_mfma_f32_32x32x16_bf16 v[188:203], v[156:159], v[76:79], v[188:203]
    v_mfma_f32_32x32x16_bf16 v[188:203], v[160:163], v[80:83], v[188:203]
    v_mfma_f32_32x32x16_bf16 v[188:203], v[164:167], v[84:87], v[188:203]
    v_mfma_f32_32x32x16_bf16 v[188:203], v[168:171], v[88:91], v[188:203]
L_QA_KMOK:
    s_nop 11
    v_fma_f32 v188, v188, s73, -v5
    v_fma_f32 v189, v189, s73, -v5
    v_fma_f32 v190, v190, s73, -v5
    v_fma_f32 v191, v191, s73, -v5
    v_max3_f32 v2, v188, v189, 0
    v_max3_f32 v2, v2, v190, v191
    v_mov_b32 v3, v2
    s_nop 1
    v_permlane32_swap_b32 v2, v3
    v_max_f32 v2, v2, v3
    v_sub_f32 v188, v188, v2
    v_sub_f32 v189, v189, v2
    v_sub_f32 v190, v190, v2
    v_sub_f32 v191, v191, v2
    v_sub_f32 v4, 0, v2
    v_exp_f32 v188, v188
    v_exp_f32 v189, v189
    v_exp_f32 v190, v190
    v_exp_f32 v191, v191
    v_exp_f32 v4, v4
    v_cvt_pk_bf16_f32 v228, v188, v189
    v_cvt_pk_bf16_f32 v229, v190, v191
    s_nop 1
    v_mfma_f32_32x32x16_bf16 v[172:187], v[212:215], v[228:231], 0
    v_add_f32 v2, v188, v189
    v_add_f32 v3, v190, v191
    v_add_f32 v2, v2, v3
    v_fma_f32 v2, v239, v4, v2
    v_mov_b32 v3, v2
    s_nop 1
    v_permlane32_swap_b32 v2, v3
    v_add_f32 v2, v2, v3
    v_rcp_f32 v2, v2
    s_nop 0
    v_mul_f32 v2, v2, v6
    v_mul_f32 v4, v4, v2
    v_mul_f32 v92, v92, v4
    v_mul_f32 v93, v93, v4
    v_mul_f32 v94, v94, v4
    v_mul_f32 v95, v95, v4
    v_mul_f32 v96, v96, v4
    v_mul_f32 v97, v97, v4
    v_mul_f32 v98, v98, v4
    v_mul_f32 v99, v99, v4
    v_mul_f32 v100, v100, v4
    v_mul_f32 v101, v101, v4
    v_mul_f32 v102, v102, v4
    v_mul_f32 v103, v103, v4
    v_mul_f32 v104, v104, v4
    v_mul_f32 v105, v105, v4
    v_mul_f32 v106, v106, v4
    v_mul_f32 v107, v107, v4
    v_fma_f32 v92, v172, v2, v92
    v_fma_f32 v93, v173, v2, v93
    v_fma_f32 v94, v174, v2, v94
    v_fma_f32 v95, v175, v2, v95
    v_fma_f32 v96, v176, v2, v96
    v_fma_f32 v97, v177, v2, v97
    v_fma_f32 v98, v178, v2, v98
    v_fma_f32 v99, v179, v2, v99
    v_fma_f32 v100, v180, v2, v100
    v_fma_f32 v101, v181, v2, v101
    v_fma_f32 v102, v182, v2, v102
    v_fma_f32 v103, v183, v2, v103
    v_fma_f32 v104, v184, v2, v104
    v_fma_f32 v105, v185, v2, v105
    v_fma_f32 v106, v186, v2, v106
    v_fma_f32 v107, v187, v2, v107
    v_cvt_pk_bf16_f32 v220, v92, v93
    v_cvt_pk_bf16_f32 v221, v94, v95
    v_cvt_pk_bf16_f32 v222, v96, v97
    v_cvt_pk_bf16_f32 v223, v98, v99
    v_cvt_pk_bf16_f32 v224, v100, v101
    v_cvt_pk_bf16_f32 v225, v102, v103
    v_cvt_pk_bf16_f32 v226, v104, v105
    v_cvt_pk_bf16_f32 v227, v106, v107
    ds_write_b128 v7, v[220:223] offset:8192
    ds_write_b128 v7, v[224:227] offset:9216
    s_lshl_b32 s61, s53, 15
    s_add_u32 s61, s61, s89
    s_add_u32 s62, s61, 0
    buffer_load_dwordx4 v[172:175], v10, s[48:51], s62 offen sc1
    s_add_u32 s62, s61, 4096
    buffer_load_dwordx4 v[176:179], v10, s[48:51], s62 offen sc1
    s_add_u32 s62, s61, 8192
    buffer_load_dwordx4 v[180:183], v10, s[48:51], s62 offen sc1
    s_add_u32 s62, s61, 12288
    buffer_load_dwordx4 v[184:187], v10, s[48:51], s62 offen sc1
    s_add_u32 s62, s61, 16384
    buffer_load_dwordx4 v[188:191], v10, s[48:51], s62 offen sc1
    s_add_u32 s62, s61, 20480
    buffer_load_dwordx4 v[192:195], v10, s[48:51], s62 offen sc1
    s_add_u32 s62, s61, 24576
    buffer_load_dwordx4 v[196:199], v10, s[48:51], s62 offen sc1
    s_add_u32 s62, s61, 28672
    buffer_load_dwordx4 v[200:203], v10, s[48:51], s62 offen sc1
    s_waitcnt vmcnt(8) lgkmcnt(0)
    s_barrier
    ds_read_b128 v[60:63], v8 offset:8192
    ds_read_b128 v[64:67], v8 offset:9216
    ds_read_b128 v[68:71], v8 offset:10240
    ds_read_b128 v[72:75], v8 offset:11264
    ds_read_b128 v[76:79], v8 offset:12288
    ds_read_b128 v[80:83], v8 offset:13312
    ds_read_b128 v[84:87], v8 offset:14336
    ds_read_b128 v[88:91], v8 offset:15360
    s_and_b32 s95, s65, 3
    s_lshl_b32 s95, s95, 20
    s_add_u32 s95, s95, s79
    s_lshl_b32 s3, s52, 18
    s_add_u32 s76, s95, s3
    s_lshl_b32 s3, s53, 10
    s_add_u32 s76, s76, s3
    s_bfe_u32 s82, s65, 0x10002
    s_xor_b32 s82, s82, 1
    s_cmp_lt_u32 s59, 32
    s_cbranch_scc1 L_QA_WOSLOW
    s_sub_u32 s3, s67, 44
    s_cmp_lt_u32 s3, 18
    s_cbranch_scc1 L_QA_WOSLOW
    v_mfma_f32_32x32x16_bf16 v[108:123], v[240:243], v[216:219], 0
    s_waitcnt lgkmcnt(7)
    v_mfma_f32_32x32x16_bf16 v[108:123], a[128:131], v[60:63], v[108:123]
    s_waitcnt lgkmcnt(6)
    v_mfma_f32_32x32x16_bf16 v[108:123], a[144:147], v[64:67], v[108:123]
    s_waitcnt lgkmcnt(5)
    v_mfma_f32_32x32x16_bf16 v[108:123], a[160:163], v[68:71], v[108:123]
    s_waitcnt lgkmcnt(4)
    v_mfma_f32_32x32x16_bf16 v[108:123], a[176:179], v[72:75], v[108:123]
    s_waitcnt lgkmcnt(3)
    v_mfma_f32_32x32x16_bf16 v[108:123], a[192:195], v[76:79], v[108:123]
    s_waitcnt lgkmcnt(2)
    v_mfma_f32_32x32x16_bf16 v[108:123], a[208:211], v[80:83], v[108:123]
    s_waitcnt lgkmcnt(1)
    v_mfma_f32_32x32x16_bf16 v[108:123], a[224:227], v[84:87], v[108:123]
    s_waitcnt lgkmcnt(0)
    v_mfma_f32_32x32x16_bf16 v[108:123], a[240:243], v[88:91], v[108:123]
    v_mfma_f32_32x32x16_bf16 v[124:139], v[244:247], v[216:219], 0
    v_mfma_f32_32x32x16_bf16 v[124:139], a[132:135], v[60:63], v[124:139]
    v_mfma_f32_32x32x16_bf16 v[124:139], a[148:151], v[64:67], v[124:139]
    s_nop 8
    v_cvt_pk_bf16_f32 v108, v108, v109
    v_cvt_pk_bf16_f32 v109, v110, v111
    v_mfma_f32_32x32x16_bf16 v[124:139], a[164:167], v[68:71], v[124:139]
    v_cvt_pk_bf16_f32 v110, v112, v113
    v_cvt_pk_bf16_f32 v111, v114, v115
    v_mfma_f32_32x32x16_bf16 v[124:139], a[180:183], v[72:75], v[124:139]
    v_cvt_pk_bf16_f32 v112, v116, v117
    v_cvt_pk_bf16_f32 v113, v118, v119
    v_mfma_f32_32x32x16_bf16 v[124:139], a[196:199], v[76:79], v[124:139]
    v_cvt_pk_bf16_f32 v114, v120, v121
    v_cvt_pk_bf16_f32 v115, v122, v123
    v_mfma_f32_32x32x16_bf16 v[124:139], a[212:215], v[80:83], v[124:139]
    v_and_or_b32 v108, v108, -2, s82
    v_and_or_b32 v112, v112, -2, s82
    v_mfma_f32_32x32x16_bf16 v[124:139], a[228:231], v[84:87], v[124:139]
    s_add_u32 s61, s76, 0
    buffer_store_dwordx4 v[108:111], v1, s[48:51], s61 offen
    s_add_u32 s61, s76, 32768
    buffer_store_dwordx4 v[112:115], v1, s[48:51], s61 offen
    v_mfma_f32_32x32x16_bf16 v[124:139], a[244:247], v[88:91], v[124:139]
    v_mfma_f32_32x32x16_bf16 v[140:155], v[248:251], v[216:219], 0
    v_mfma_f32_32x32x16_bf16 v[140:155], a[136:139], v[60:63], v[140:155]
    v_mfma_f32_32x32x16_bf16 v[140:155], a[152:155], v[64:67], v[140:155]
    s_nop 8
    v_cvt_pk_bf16_f32 v124, v124, v125
    v_cvt_pk_bf16_f32 v125, v126, v127
    v_mfma_f32_32x32x16_bf16 v[140:155], a[168:171], v[68:71], v[140:155]
    v_cvt_pk_bf16_f32 v126, v128, v129
    v_cvt_pk_bf16_f32 v127, v130, v131
    v_mfma_f32_32x32x16_bf16 v[140:155], a[184:187], v[72:75], v[140:155]
    v_cvt_pk_bf16_f32 v128, v132, v133
    v_cvt_pk_bf16_f32 v129, v134, v135
    v_mfma_f32_32x32x16_bf16 v[140:155], a[200:203], v[76:79], v[140:155]
    v_cvt_pk_bf16_f32 v130, v136, v137
    v_cvt_pk_bf16_f32 v131, v138, v139
    v_mfma_f32_32x32x16_bf16 v[140:155], a[216:219], v[80:83], v[140:155]
    v_and_or_b32 v124, v124, -2, s82
    v_and_or_b32 v128, v128, -2, s82
    v_mfma_f32_32x32x16_bf16 v[140:155], a[232:235], v[84:87], v[140:155]
    s_add_u32 s61, s76, 65536
    buffer_store_dwordx4 v[124:127], v1, s[48:51], s61 offen
    s_add_u32 s61, s76, 98304
    buffer_store_dwordx4 v[128:131], v1, s[48:51], s61 offen
    v_mfma_f32_32x32x16_bf16 v[140:155], a[248:251], v[88:91], v[140:155]
    v_mfma_f32_32x32x16_bf16 v[156:171], v[252:255], v[216:219], 0
    v_mfma_f32_32x32x16_bf16 v[156:171], a[140:143], v[60:63], v[156:171]
    v_mfma_f32_32x32x16_bf16 v[156:171], a[156:159], v[64:67], v[156:171]
    s_nop 8
    v_cvt_pk_bf16_f32 v140, v140, v141
    v_cvt_pk_bf16_f32 v141, v142, v143
    v_mfma_f32_32x32x16_bf16 v[156:171], a[172:175], v[68:71], v[156:171]
    v_cvt_pk_bf16_f32 v142, v144, v145
    v_cvt_pk_bf16_f32 v143, v146, v147
    v_mfma_f32_32x32x16_bf16 v[156:171], a[188:191], v[72:75], v[156:171]
    v_cvt_pk_bf16_f32 v144, v148, v149
    v_cvt_pk_bf16_f32 v145, v150, v151
    v_mfma_f32_32x32x16_bf16 v[156:171], a[204:207], v[76:79], v[156:171]
    v_cvt_pk_bf16_f32 v146, v152, v153
    v_cvt_pk_bf16_f32 v147, v154, v155
    v_mfma_f32_32x32x16_bf16 v[156:171], a[220:223], v[80:83], v[156:171]
    v_and_or_b32 v140, v140, -2, s82
    v_and_or_b32 v144, v144, -2, s82
    v_mfma_f32_32x32x16_bf16 v[156:171], a[236:239], v[84:87], v[156:171]
    s_add_u32 s61, s76, 131072
    buffer_store_dwordx4 v[140:143], v1, s[48:51], s61 offen
    s_add_u32 s61, s76, 163840
    buffer_store_dwordx4 v[144:147], v1, s[48:51], s61 offen
    v_mfma_f32_32x32x16_bf16 v[156:171], a[252:255], v[88:91], v[156:171]
    s_nop 11
    v_cvt_pk_bf16_f32 v156, v156, v157
    v_cvt_pk_bf16_f32 v157, v158, v159
    v_cvt_pk_bf16_f32 v158, v160, v161
    v_cvt_pk_bf16_f32 v159, v162, v163
    v_cvt_pk_bf16_f32 v160, v164, v165
    v_cvt_pk_bf16_f32 v161, v166, v167
    v_cvt_pk_bf16_f32 v162, v168, v169
    v_cvt_pk_bf16_f32 v163, v170, v171
    v_and_or_b32 v156, v156, -2, s82
    v_and_or_b32 v160, v160, -2, s82
    s_add_u32 s61, s76, 196608
    buffer_store_dwordx4 v[156:159], v1, s[48:51], s61 offen
    s_add_u32 s61, s76, 229376
    buffer_store_dwordx4 v[160:163], v1, s[48:51], s61 offen
    s_branch L_QA_WODONE
.p2align 5
L_QA_WOSLOW:
    v_mfma_f32_32x32x16_bf16 v[108:123], v[240:243], v[216:219], 0
    s_waitcnt lgkmcnt(7)
    v_mfma_f32_32x32x16_bf16 v[108:123], a[128:131], v[60:63], v[108:123]
    s_waitcnt lgkmcnt(6)
    v_mfma_f32_32x32x16_bf16 v[108:123], a[144:147], v[64:67], v[108:123]
    s_waitcnt lgkmcnt(5)
    v_mfma_f32_32x32x16_bf16 v[108:123], a[160:163], v[68:71], v[108:123]
    s_waitcnt lgkmcnt(4)
    v_mfma_f32_32x32x16_bf16 v[108:123], a[176:179], v[72:75], v[108:123]
    s_waitcnt lgkmcnt(3)
    v_mfma_f32_32x32x16_bf16 v[108:123], a[192:195], v[76:79], v[108:123]
    s_waitcnt lgkmcnt(2)
    v_mfma_f32_32x32x16_bf16 v[108:123], a[208:211], v[80:83], v[108:123]
    s_waitcnt lgkmcnt(1)
    v_mfma_f32_32x32x16_bf16 v[108:123], a[224:227], v[84:87], v[108:123]
    s_waitcnt lgkmcnt(0)
    v_mfma_f32_32x32x16_bf16 v[108:123], a[240:243], v[88:91], v[108:123]
    v_mfma_f32_32x32x16_bf16 v[124:139], v[244:247], v[216:219], 0
    v_mfma_f32_32x32x16_bf16 v[124:139], a[132:135], v[60:63], v[124:139]
    v_mfma_f32_32x32x16_bf16 v[124:139], a[148:151], v[64:67], v[124:139]
    s_nop 8
    v_cvt_pk_bf16_f32 v108, v108, v109
    v_cvt_pk_bf16_f32 v109, v110, v111
    v_mfma_f32_32x32x16_bf16 v[124:139], a[164:167], v[68:71], v[124:139]
    v_cvt_pk_bf16_f32 v110, v112, v113
    v_cvt_pk_bf16_f32 v111, v114, v115
    v_mfma_f32_32x32x16_bf16 v[124:139], a[180:183], v[72:75], v[124:139]
    v_cvt_pk_bf16_f32 v112, v116, v117
    v_cvt_pk_bf16_f32 v113, v118, v119
    v_mfma_f32_32x32x16_bf16 v[124:139], a[196:199], v[76:79], v[124:139]
    v_cvt_pk_bf16_f32 v114, v120, v121
    v_cvt_pk_bf16_f32 v115, v122, v123
    v_mfma_f32_32x32x16_bf16 v[124:139], a[212:215], v[80:83], v[124:139]
    v_and_or_b32 v108, v108, -2, s82
    v_and_or_b32 v112, v112, -2, s82
    v_mfma_f32_32x32x16_bf16 v[124:139], a[228:231], v[84:87], v[124:139]
    s_add_u32 s61, s76, 0
    buffer_store_dwordx4 v[108:111], v1, s[48:51], s61 offen sc1
    s_add_u32 s61, s76, 32768
    buffer_store_dwordx4 v[112:115], v1, s[48:51], s61 offen sc1
    v_mfma_f32_32x32x16_bf16 v[124:139], a[244:247], v[88:91], v[124:139]
    v_mfma_f32_32x32x16_bf16 v[140:155], v[248:251], v[216:219], 0
    v_mfma_f32_32x32x16_bf16 v[140:155], a[136:139], v[60:63], v[140:155]
    v_mfma_f32_32x32x16_bf16 v[140:155], a[152:155], v[64:67], v[140:155]
    s_nop 8
    v_cvt_pk_bf16_f32 v124, v124, v125
    v_cvt_pk_bf16_f32 v125, v126, v127
    v_mfma_f32_32x32x16_bf16 v[140:155], a[168:171], v[68:71], v[140:155]
    v_cvt_pk_bf16_f32 v126, v128, v129
    v_cvt_pk_bf16_f32 v127, v130, v131
    v_mfma_f32_32x32x16_bf16 v[140:155], a[184:187], v[72:75], v[140:155]
    v_cvt_pk_bf16_f32 v128, v132, v133
    v_cvt_pk_bf16_f32 v129, v134, v135
    v_mfma_f32_32x32x16_bf16 v[140:155], a[200:203], v[76:79], v[140:155]
    v_cvt_pk_bf16_f32 v130, v136, v137
    v_cvt_pk_bf16_f32 v131, v138, v139
    v_mfma_f32_32x32x16_bf16 v[140:155], a[216:219], v[80:83], v[140:155]
    v_and_or_b32 v124, v124, -2, s82
    v_and_or_b32 v128, v128, -2, s82
    v_mfma_f32_32x32x16_bf16 v[140:155], a[232:235], v[84:87], v[140:155]
    s_add_u32 s61, s76, 65536
    buffer_store_dwordx4 v[124:127], v1, s[48:51], s61 offen sc1
    s_add_u32 s61, s76, 98304
    buffer_store_dwordx4 v[128:131], v1, s[48:51], s61 offen sc1
    v_mfma_f32_32x32x16_bf16 v[140:155], a[248:251], v[88:91], v[140:155]
    v_mfma_f32_32x32x16_bf16 v[156:171], v[252:255], v[216:219], 0
    v_mfma_f32_32x32x16_bf16 v[156:171], a[140:143], v[60:63], v[156:171]
    v_mfma_f32_32x32x16_bf16 v[156:171], a[156:159], v[64:67], v[156:171]
    s_nop 8
    v_cvt_pk_bf16_f32 v140, v140, v141
    v_cvt_pk_bf16_f32 v141, v142, v143
    v_mfma_f32_32x32x16_bf16 v[156:171], a[172:175], v[68:71], v[156:171]
    v_cvt_pk_bf16_f32 v142, v144, v145
    v_cvt_pk_bf16_f32 v143, v146, v147
    v_mfma_f32_32x32x16_bf16 v[156:171], a[188:191], v[72:75], v[156:171]
    v_cvt_pk_bf16_f32 v144, v148, v149
    v_cvt_pk_bf16_f32 v145, v150, v151
    v_mfma_f32_32x32x16_bf16 v[156:171], a[204:207], v[76:79], v[156:171]
    v_cvt_pk_bf16_f32 v146, v152, v153
    v_cvt_pk_bf16_f32 v147, v154, v155
    v_mfma_f32_32x32x16_bf16 v[156:171], a[220:223], v[80:83], v[156:171]
    v_and_or_b32 v140, v140, -2, s82
    v_and_or_b32 v144, v144, -2, s82
    v_mfma_f32_32x32x16_bf16 v[156:171], a[236:239], v[84:87], v[156:171]
    s_add_u32 s61, s76, 131072
    buffer_store_dwordx4 v[140:143], v1, s[48:51], s61 offen sc1
    s_add_u32 s61, s76, 163840
    buffer_store_dwordx4 v[144:147], v1, s[48:51], s61 offen sc1
    v_mfma_f32_32x32x16_bf16 v[156:171], a[252:255], v[88:91], v[156:171]
    s_nop 11
    v_cvt_pk_bf16_f32 v156, v156, v157
    v_cvt_pk_bf16_f32 v157, v158, v159
    v_cvt_pk_bf16_f32 v158, v160, v161
    v_cvt_pk_bf16_f32 v159, v162, v163
    v_cvt_pk_bf16_f32 v160, v164, v165
    v_cvt_pk_bf16_f32 v161, v166, v167
    v_cvt_pk_bf16_f32 v162, v168, v169
    v_cvt_pk_bf16_f32 v163, v170, v171
    v_and_or_b32 v156, v156, -2, s82
    v_and_or_b32 v160, v160, -2, s82
    s_add_u32 s61, s76, 196608
    buffer_store_dwordx4 v[156:159], v1, s[48:51], s61 offen sc1
    s_add_u32 s61, s76, 229376
    buffer_store_dwordx4 v[160:163], v1, s[48:51], s61 offen sc1
L_QA_WODONE:
    s_cmp_eq_u32 s65, 0
    s_cbranch_scc1 L_QA_NORED
    s_mov_b32 s56, 0
    s_waitcnt vmcnt(15)
    v_mfma_f32_16x16x32_bf16 v[232:235], v[16:19], v[172:175], 0
    s_waitcnt vmcnt(14)
    v_mfma_f32_16x16x32_bf16 v[232:235], v[16:19], v[176:179], v[232:235]
    s_waitcnt vmcnt(13)
    v_mfma_f32_16x16x32_bf16 v[232:235], v[16:19], v[180:183], v[232:235]
    s_waitcnt vmcnt(12)
    v_mfma_f32_16x16x32_bf16 v[232:235], v[16:19], v[184:187], v[232:235]
    s_waitcnt vmcnt(11)
    v_mfma_f32_16x16x32_bf16 v[232:235], v[16:19], v[188:191], v[232:235]
    s_waitcnt vmcnt(10)
    v_mfma_f32_16x16x32_bf16 v[232:235], v[16:19], v[192:195], v[232:235]
    s_waitcnt vmcnt(9)
    v_mfma_f32_16x16x32_bf16 v[232:235], v[16:19], v[196:199], v[232:235]
    s_waitcnt vmcnt(8)
    v_mfma_f32_16x16x32_bf16 v[232:235], v[16:19], v[200:203], v[232:235]
L_QA_RS_24:
    v_bitop3_b32 v2, v172, v176, s83 bitop3:0x7e
    v_bitop3_b32 v3, v180, v184, s83 bitop3:0x7e
    v_bitop3_b32 v4, v188, v192, s83 bitop3:0x7e
    v_bitop3_b32 v5, v196, v200, s83 bitop3:0x7e
    v_or3_b32 v2, v2, v3, v4
    v_bitop3_b32 v2, v2, v5, 1 bitop3:0xa8
    v_cmp_ne_u32 vcc, 0, v2
    s_cbranch_vccz L_QA_RD_26
    s_add_u32 s56, s56, 1
    s_cmp_gt_u32 s56, 60000
    s_cbranch_scc1 L_TIMEOUT_8
    s_lshl_b32 s61, s53, 15
    s_add_u32 s61, s61, s89
    s_add_u32 s62, s61, 0
    buffer_load_dwordx4 v[172:175], v10, s[48:51], s62 offen sc1
    s_add_u32 s62, s61, 4096
    buffer_load_dwordx4 v[176:179], v10, s[48:51], s62 offen sc1
    s_add_u32 s62, s61, 8192
    buffer_load_dwordx4 v[180:183], v10, s[48:51], s62 offen sc1
    s_add_u32 s62, s61, 12288
    buffer_load_dwordx4 v[184:187], v10, s[48:51], s62 offen sc1
    s_add_u32 s62, s61, 16384
    buffer_load_dwordx4 v[188:191], v10, s[48:51], s62 offen sc1
    s_add_u32 s62, s61, 20480
    buffer_load_dwordx4 v[192:195], v10, s[48:51], s62 offen sc1
    s_add_u32 s62, s61, 24576
    buffer_load_dwordx4 v[196:199], v10, s[48:51], s62 offen sc1
    s_add_u32 s62, s61, 28672
    buffer_load_dwordx4 v[200:203], v10, s[48:51], s62 offen sc1
    s_waitcnt vmcnt(7)
    v_mfma_f32_16x16x32_bf16 v[232:235], v[16:19], v[172:175], 0
    s_waitcnt vmcnt(6)
    v_mfma_f32_16x16x32_bf16 v[232:235], v[16:19], v[176:179], v[232:235]
    s_waitcnt vmcnt(5)
    v_mfma_f32_16x16x32_bf16 v[232:235], v[16:19], v[180:183], v[232:235]
    s_waitcnt vmcnt(4)
    v_mfma_f32_16x16x32_bf16 v[232:235], v[16:19], v[184:187], v[232:235]
    s_waitcnt vmcnt(3)
    v_mfma_f32_16x16x32_bf16 v[232:235], v[16:19], v[188:191], v[232:235]
    s_waitcnt vmcnt(2)
    v_mfma_f32_16x16x32_bf16 v[232:235], v[16:19], v[192:195], v[232:235]
    s_waitcnt vmcnt(1)
    v_mfma_f32_16x16x32_bf16 v[232:235], v[16:19], v[196:199], v[232:235]
    s_waitcnt vmcnt(0)
    v_mfma_f32_16x16x32_bf16 v[232:235], v[16:19], v[200:203], v[232:235]
    s_branch L_QA_RS_24
.p2align 5
L_QA_RD_26:
    s_lshl_b32 s61, s77, 15
    v_cvt_pk_bf16_f32 v236, v232, v233
    v_cvt_pk_bf16_f32 v237, v234, v235
    s_mov_b64 exec, 0xffffffff
    buffer_store_dwordx2 v[236:237], v11, s[40:43], s61 offen
    s_mov_b64 exec, -1
L_QA_NORED:
    s_mov_b32 s77, s67
    s_mov_b32 s83, s82
    s_mov_b32 s89, s95
    s_add_u32 s65, s65, 1
    s_add_u32 s67, s67, 4
    s_add_u32 s68, s68, 32768
    s_and_b32 s68, s68, 0x1ffff
    s_cmp_lt_u32 s65, s66
    s_cbranch_scc1 L_QA_LOOP
    s_lshl_b32 s61, s53, 15
    s_add_u32 s61, s61, s89
    s_add_u32 s62, s61, 0
    buffer_load_dwordx4 v[172:175], v10, s[48:51], s62 offen sc1
    s_add_u32 s62, s61, 4096
    buffer_load_dwordx4 v[176:179], v10, s[48:51], s62 offen sc1
    s_add_u32 s62, s61, 8192
    buffer_load_dwordx4 v[180:183], v10, s[48:51], s62 offen sc1
    s_add_u32 s62, s61, 12288
    buffer_load_dwordx4 v[184:187], v10, s[48:51], s62 offen sc1
    s_add_u32 s62, s61, 16384
    buffer_load_dwordx4 v[188:191], v10, s[48:51], s62 offen sc1
    s_add_u32 s62, s61, 20480
    buffer_load_dwordx4 v[192:195], v10, s[48:51], s62 offen sc1
    s_add_u32 s62, s61, 24576
    buffer_load_dwordx4 v[196:199], v10, s[48:51], s62 offen sc1
    s_add_u32 s62, s61, 28672
    buffer_load_dwordx4 v[200:203], v10, s[48:51], s62 offen sc1
    s_mov_b32 s56, 0
    s_waitcnt vmcnt(7)
    v_mfma_f32_16x16x32_bf16 v[232:235], v[16:19], v[172:175], 0
    s_waitcnt vmcnt(6)
    v_mfma_f32_16x16x32_bf16 v[232:235], v[16:19], v[176:179], v[232:235]
    s_waitcnt vmcnt(5)
    v_mfma_f32_16x16x32_bf16 v[232:235], v[16:19], v[180:183], v[232:235]
    s_waitcnt vmcnt(4)
    v_mfma_f32_16x16x32_bf16 v[232:235], v[16:19], v[184:187], v[232:235]
    s_waitcnt vmcnt(3)
    v_mfma_f32_16x16x32_bf16 v[232:235], v[16:19], v[188:191], v[232:235]
    s_waitcnt vmcnt(2)
    v_mfma_f32_16x16x32_bf16 v[232:235], v[16:19], v[192:195], v[232:235]
    s_waitcnt vmcnt(1)
    v_mfma_f32_16x16x32_bf16 v[232:235], v[16:19], v[196:199], v[232:235]
    s_waitcnt vmcnt(0)
    v_mfma_f32_16x16x32_bf16 v[232:235], v[16:19], v[200:203], v[232:235]
L_QA_RS_27:
    v_bitop3_b32 v2, v172, v176, s83 bitop3:0x7e
    v_bitop3_b32 v3, v180, v184, s83 bitop3:0x7e
    v_bitop3_b32 v4, v188, v192, s83 bitop3:0x7e
    v_bitop3_b32 v5, v196, v200, s83 bitop3:0x7e
    v_or3_b32 v2, v2, v3, v4
    v_bitop3_b32 v2, v2, v5, 1 bitop3:0xa8
    v_cmp_ne_u32 vcc, 0, v2
    s_cbranch_vccz L_QA_RD_29
    s_add_u32 s56, s56, 1
    s_cmp_gt_u32 s56, 60000
    s_cbranch_scc1 L_TIMEOUT_8
    s_lshl_b32 s61, s53, 15
    s_add_u32 s61, s61, s89
    s_add_u32 s62, s61, 0
    buffer_load_dwordx4 v[172:175], v10, s[48:51], s62 offen sc1
    s_add_u32 s62, s61, 4096
    buffer_load_dwordx4 v[176:179], v10, s[48:51], s62 offen sc1
    s_add_u32 s62, s61, 8192
    buffer_load_dwordx4 v[180:183], v10, s[48:51], s62 offen sc1
    s_add_u32 s62, s61, 12288
    buffer_load_dwordx4 v[184:187], v10, s[48:51], s62 offen sc1
    s_add_u32 s62, s61, 16384
    buffer_load_dwordx4 v[188:191], v10, s[48:51], s62 offen sc1
    s_add_u32 s62, s61, 20480
    buffer_load_dwordx4 v[192:195], v10, s[48:51], s62 offen sc1
    s_add_u32 s62, s61, 24576
    buffer_load_dwordx4 v[196:199], v10, s[48:51], s62 offen sc1
    s_add_u32 s62, s61, 28672
    buffer_load_dwordx4 v[200:203], v10, s[48:51], s62 offen sc1
    s_waitcnt vmcnt(7)
    v_mfma_f32_16x16x32_bf16 v[232:235], v[16:19], v[172:175], 0
    s_waitcnt vmcnt(6)
    v_mfma_f32_16x16x32_bf16 v[232:235], v[16:19], v[176:179], v[232:235]
    s_waitcnt vmcnt(5)
    v_mfma_f32_16x16x32_bf16 v[232:235], v[16:19], v[180:183], v[232:235]
    s_waitcnt vmcnt(4)
    v_mfma_f32_16x16x32_bf16 v[232:235], v[16:19], v[184:187], v[232:235]
    s_waitcnt vmcnt(3)
    v_mfma_f32_16x16x32_bf16 v[232:235], v[16:19], v[188:191], v[232:235]
    s_waitcnt vmcnt(2)
    v_mfma_f32_16x16x32_bf16 v[232:235], v[16:19], v[192:195], v[232:235]
    s_waitcnt vmcnt(1)
    v_mfma_f32_16x16x32_bf16 v[232:235], v[16:19], v[196:199], v[232:235]
    s_waitcnt vmcnt(0)
    v_mfma_f32_16x16x32_bf16 v[232:235], v[16:19], v[200:203], v[232:235]
    s_branch L_QA_RS_27
.p2align 5
L_QA_RD_29:
    s_lshl_b32 s61, s77, 15
    v_cvt_pk_bf16_f32 v236, v232, v233
    v_cvt_pk_bf16_f32 v237, v234, v235
    s_mov_b64 exec, 0xffffffff
    buffer_store_dwordx2 v[236:237], v11, s[40:43], s61 offen
    s_mov_b64 exec, -1
    s_endpgm
.p2align 5
L_ROLE_KM:
    v_lshlrev_b32 v4, 4, v0
    s_lshl_b32 s60, s52, 12
    v_bfe_u32 v1, v0, 0, 4
    v_mul_u32_u24 v1, 16, v1
    v_bfe_u32 v3, v0, 4, 2
    v_mul_u32_u24 v3, 8192, v3
    v_add_u32 v1, v1, v3
    v_lshlrev_b32 v3, 2, v0
    v_and_b32 v3, 0xc0, v3
    v_xor_b32 v1, v1, v3
    v_bfe_u32 v2, v0, 0, 2
    v_mul_u32_u24 v2, 8, v2
    v_bfe_u32 v3, v0, 2, 2
    v_mul_u32_u24 v3, 256, v3
    v_add_u32 v2, v2, v3
    v_bfe_u32 v3, v0, 4, 2
    v_mul_u32_u24 v3, 2048, v3
    v_add_u32 v2, v2, v3
    s_lshl_b32 s3, s52, 6
    v_add_u32 v2, s3, v2
    v_lshlrev_b32 v3, 4, v0
    v_and_b32 v3, 0xc0, v3
    v_xor_b32 v2, v2, v3
    s_lshl_b32 s63, s53, 8
    s_lshl_b32 s3, s52, 17
    s_add_u32 s63, s63, s3
    s_add_u32 m0, s60, 32768
    s_add_u32 s62, s63, 0
    buffer_load_dwordx4 v1, s[16:19], s62 offen lds
    s_add_u32 m0, s60, 33792
    s_add_u32 s62, s63, 32768
    buffer_load_dwordx4 v1, s[16:19], s62 offen lds
    s_add_u32 m0, s60, 34816
    s_add_u32 s62, s63, 65536
    buffer_load_dwordx4 v1, s[16:19], s62 offen lds
    s_add_u32 m0, s60, 35840
    s_add_u32 s62, s63, 98304
    buffer_load_dwordx4 v1, s[16:19], s62 offen lds
    s_add_u32 m0, s60, 49152
    s_add_u32 s62, s63, 0
    buffer_load_dwordx4 v1, s[20:23], s62 offen lds
    s_add_u32 m0, s60, 50176
    s_add_u32 s62, s63, 32768
    buffer_load_dwordx4 v1, s[20:23], s62 offen lds
    s_add_u32 m0, s60, 51200
    s_add_u32 s62, s63, 65536
    buffer_load_dwordx4 v1, s[20:23], s62 offen lds
    s_add_u32 m0, s60, 52224
    s_add_u32 s62, s63, 98304
    buffer_load_dwordx4 v1, s[20:23], s62 offen lds
    s_add_u32 m0, s60, 65536
    s_add_u32 s62, s63, 524288
    buffer_load_dwordx4 v1, s[16:19], s62 offen lds
    s_add_u32 m0, s60, 66560
    s_add_u32 s62, s63, 557056
    buffer_load_dwordx4 v1, s[16:19], s62 offen lds
    s_add_u32 m0, s60, 67584
    s_add_u32 s62, s63, 589824
    buffer_load_dwordx4 v1, s[16:19], s62 offen lds
    s_add_u32 m0, s60, 68608
    s_add_u32 s62, s63, 622592
    buffer_load_dwordx4 v1, s[16:19], s62 offen lds
    s_add_u32 m0, s60, 81920
    s_add_u32 s62, s63, 524288
    buffer_load_dwordx4 v1, s[20:23], s62 offen lds
    s_add_u32 m0, s60, 82944
    s_add_u32 s62, s63, 557056
    buffer_load_dwordx4 v1, s[20:23], s62 offen lds
    s_add_u32 m0, s60, 83968
    s_add_u32 s62, s63, 589824
    buffer_load_dwordx4 v1, s[20:23], s62 offen lds
    s_add_u32 m0, s60, 84992
    s_add_u32 s62, s63, 622592
    buffer_load_dwordx4 v1, s[20:23], s62 offen lds
    s_add_u32 m0, s60, 98304
    s_add_u32 s62, s63, 1048576
    buffer_load_dwordx4 v1, s[16:19], s62 offen lds
    s_add_u32 m0, s60, 99328
    s_add_u32 s62, s63, 1081344
    buffer_load_dwordx4 v1, s[16:19], s62 offen lds
    s_add_u32 m0, s60, 100352
    s_add_u32 s62, s63, 1114112
    buffer_load_dwordx4 v1, s[16:19], s62 offen lds
    s_add_u32 m0, s60, 101376
    s_add_u32 s62, s63, 1146880
    buffer_load_dwordx4 v1, s[16:19], s62 offen lds
    s_add_u32 m0, s60, 114688
    s_add_u32 s62, s63, 1048576
    buffer_load_dwordx4 v1, s[20:23], s62 offen lds
    s_add_u32 m0, s60, 115712
    s_add_u32 s62, s63, 1081344
    buffer_load_dwordx4 v1, s[20:23], s62 offen lds
    s_add_u32 m0, s60, 116736
    s_add_u32 s62, s63, 1114112
    buffer_load_dwordx4 v1, s[20:23], s62 offen lds
    s_add_u32 m0, s60, 117760
    s_add_u32 s62, s63, 1146880
    buffer_load_dwordx4 v1, s[20:23], s62 offen lds
    s_add_u32 m0, s60, 131072
    s_add_u32 s62, s63, 1572864
    buffer_load_dwordx4 v1, s[16:19], s62 offen lds
    s_add_u32 m0, s60, 132096
    s_add_u32 s62, s63, 1605632
    buffer_load_dwordx4 v1, s[16:19], s62 offen lds
    s_add_u32 m0, s60, 133120
    s_add_u32 s62, s63, 1638400
    buffer_load_dwordx4 v1, s[16:19], s62 offen lds
    s_add_u32 m0, s60, 134144
    s_add_u32 s62, s63, 1671168
    buffer_load_dwordx4 v1, s[16:19], s62 offen lds
    s_add_u32 m0, s60, 147456
    s_add_u32 s62, s63, 1572864
    buffer_load_dwordx4 v1, s[20:23], s62 offen lds
    s_add_u32 m0, s60, 148480
    s_add_u32 s62, s63, 1605632
    buffer_load_dwordx4 v1, s[20:23], s62 offen lds
    s_add_u32 m0, s60, 149504
    s_add_u32 s62, s63, 1638400
    buffer_load_dwordx4 v1, s[20:23], s62 offen lds
    s_add_u32 m0, s60, 150528
    s_add_u32 s62, s63, 1671168
    buffer_load_dwordx4 v1, s[20:23], s62 offen lds
    s_waitcnt vmcnt(28)
    s_barrier
    v_add_u32 v16, 32768, v2
    ds_read_b64_tr_b16 a[0:1], v16 offset:0
    ds_read_b64_tr_b16 a[2:3], v16 offset:1024
    ds_read_b64_tr_b16 a[64:65], v16 offset:32
    ds_read_b64_tr_b16 a[66:67], v16 offset:1056
    ds_read_b64_tr_b16 a[4:5], v16 offset:8192
    ds_read_b64_tr_b16 a[6:7], v16 offset:9216
    ds_read_b64_tr_b16 a[68:69], v16 offset:8224
    ds_read_b64_tr_b16 a[70:71], v16 offset:9248
    s_waitcnt lgkmcnt(0)
    s_waitcnt vmcnt(24)
    s_barrier
    s_add_u32 m0, s60, 32768
    s_add_u32 s62, s63, 2097152
    buffer_load_dwordx4 v1, s[16:19], s62 offen lds
    s_add_u32 m0, s60, 33792
    s_add_u32 s62, s63, 2129920
    buffer_load_dwordx4 v1, s[16:19], s62 offen lds
    s_add_u32 m0, s60, 34816
    s_add_u32 s62, s63, 2162688
    buffer_load_dwordx4 v1, s[16:19], s62 offen lds
    s_add_u32 m0, s60, 35840
    s_add_u32 s62, s63, 2195456
    buffer_load_dwordx4 v1, s[16:19], s62 offen lds
    v_add_u32 v16, 49152, v2
    ds_read_b64_tr_b16 a[128:129], v16 offset:0
    ds_read_b64_tr_b16 a[130:131], v16 offset:1024
    ds_read_b64_tr_b16 a[192:193], v16 offset:32
    ds_read_b64_tr_b16 a[194:195], v16 offset:1056
    ds_read_b64_tr_b16 a[132:133], v16 offset:8192
    ds_read_b64_tr_b16 a[134:135], v16 offset:9216
    ds_read_b64_tr_b16 a[196:197], v16 offset:8224
    ds_read_b64_tr_b16 a[198:199], v16 offset:9248
    s_waitcnt lgkmcnt(0)
    s_waitcnt vmcnt(24)
    s_barrier
    s_add_u32 m0, s60, 49152
    s_add_u32 s62, s63, 2097152
    buffer_load_dwordx4 v1, s[20:23], s62 offen lds
    s_add_u32 m0, s60, 50176
    s_add_u32 s62, s63, 2129920
    buffer_load_dwordx4 v1, s[20:23], s62 offen lds
    s_add_u32 m0, s60, 51200
    s_add_u32 s62, s63, 2162688
    buffer_load_dwordx4 v1, s[20:23], s62 offen lds
    s_add_u32 m0, s60, 52224
    s_add_u32 s62, s63, 2195456
    buffer_load_dwordx4 v1, s[20:23], s62 offen lds
    v_add_u32 v16, 65536, v2
    ds_read_b64_tr_b16 a[8:9], v16 offset:0
    ds_read_b64_tr_b16 a[10:11], v16 offset:1024
    ds_read_b64_tr_b16 a[72:73], v16 offset:32
    ds_read_b64_tr_b16 a[74:75], v16 offset:1056
    ds_read_b64_tr_b16 a[12:13], v16 offset:8192
    ds_read_b64_tr_b16 a[14:15], v16 offset:9216
    ds_read_b64_tr_b16 a[76:77], v16 offset:8224
    ds_read_b64_tr_b16 a[78:79], v16 offset:9248
    s_waitcnt lgkmcnt(0)
    s_waitcnt vmcnt(24)
    s_barrier
    s_add_u32 m0, s60, 65536
    s_add_u32 s62, s63, 2621440
    buffer_load_dwordx4 v1, s[16:19], s62 offen lds
    s_add_u32 m0, s60, 66560
    s_add_u32 s62, s63, 2654208
    buffer_load_dwordx4 v1, s[16:19], s62 offen lds
    s_add_u32 m0, s60, 67584
    s_add_u32 s62, s63, 2686976
    buffer_load_dwordx4 v1, s[16:19], s62 offen lds
    s_add_u32 m0, s60, 68608
    s_add_u32 s62, s63, 2719744
    buffer_load_dwordx4 v1, s[16:19], s62 offen lds
    v_add_u32 v16, 81920, v2
    ds_read_b64_tr_b16 a[136:137], v16 offset:0
    ds_read_b64_tr_b16 a[138:139], v16 offset:1024
    ds_read_b64_tr_b16 a[200:201], v16 offset:32
    ds_read_b64_tr_b16 a[202:203], v16 offset:1056
    ds_read_b64_tr_b16 a[140:141], v16 offset:8192
    ds_read_b64_tr_b16 a[142:143], v16 offset:9216
    ds_read_b64_tr_b16 a[204:205], v16 offset:8224
    ds_read_b64_tr_b16 a[206:207], v16 offset:9248
    s_waitcnt lgkmcnt(0)
    s_waitcnt vmcnt(24)
    s_barrier
    s_add_u32 m0, s60, 81920
    s_add_u32 s62, s63, 2621440
    buffer_load_dwordx4 v1, s[20:23], s62 offen lds
    s_add_u32 m0, s60, 82944
    s_add_u32 s62, s63, 2654208
    buffer_load_dwordx4 v1, s[20:23], s62 offen lds
    s_add_u32 m0, s60, 83968
    s_add_u32 s62, s63, 2686976
    buffer_load_dwordx4 v1, s[20:23], s62 offen lds
    s_add_u32 m0, s60, 84992
    s_add_u32 s62, s63, 2719744
    buffer_load_dwordx4 v1, s[20:23], s62 offen lds
    v_add_u32 v16, 98304, v2
    ds_read_b64_tr_b16 a[16:17], v16 offset:0
    ds_read_b64_tr_b16 a[18:19], v16 offset:1024
    ds_read_b64_tr_b16 a[80:81], v16 offset:32
    ds_read_b64_tr_b16 a[82:83], v16 offset:1056
    ds_read_b64_tr_b16 a[20:21], v16 offset:8192
    ds_read_b64_tr_b16 a[22:23], v16 offset:9216
    ds_read_b64_tr_b16 a[84:85], v16 offset:8224
    ds_read_b64_tr_b16 a[86:87], v16 offset:9248
    s_waitcnt lgkmcnt(0)
    s_waitcnt vmcnt(24)
    s_barrier
    s_add_u32 m0, s60, 98304
    s_add_u32 s62, s63, 3145728
    buffer_load_dwordx4 v1, s[16:19], s62 offen lds
    s_add_u32 m0, s60, 99328
    s_add_u32 s62, s63, 3178496
    buffer_load_dwordx4 v1, s[16:19], s62 offen lds
    s_add_u32 m0, s60, 100352
    s_add_u32 s62, s63, 3211264
    buffer_load_dwordx4 v1, s[16:19], s62 offen lds
    s_add_u32 m0, s60, 101376
    s_add_u32 s62, s63, 3244032
    buffer_load_dwordx4 v1, s[16:19], s62 offen lds
    v_add_u32 v16, 114688, v2
    ds_read_b64_tr_b16 a[144:145], v16 offset:0
    ds_read_b64_tr_b16 a[146:147], v16 offset:1024
    ds_read_b64_tr_b16 a[208:209], v16 offset:32
    ds_read_b64_tr_b16 a[210:211], v16 offset:1056
    ds_read_b64_tr_b16 a[148:149], v16 offset:8192
    ds_read_b64_tr_b16 a[150:151], v16 offset:9216
    ds_read_b64_tr_b16 a[212:213], v16 offset:8224
    ds_read_b64_tr_b16 a[214:215], v16 offset:9248
    s_waitcnt lgkmcnt(0)
    s_waitcnt vmcnt(24)
    s_barrier
    s_add_u32 m0, s60, 114688
    s_add_u32 s62, s63, 3145728
    buffer_load_dwordx4 v1, s[20:23], s62 offen lds
    s_add_u32 m0, s60, 115712
    s_add_u32 s62, s63, 3178496
    buffer_load_dwordx4 v1, s[20:23], s62 offen lds
    s_add_u32 m0, s60, 116736
    s_add_u32 s62, s63, 3211264
    buffer_load_dwordx4 v1, s[20:23], s62 offen lds
    s_add_u32 m0, s60, 117760
    s_add_u32 s62, s63, 3244032
    buffer_load_dwordx4 v1, s[20:23], s62 offen lds
    v_add_u32 v16, 131072, v2
    ds_read_b64_tr_b16 a[24:25], v16 offset:0
    ds_read_b64_tr_b16 a[26:27], v16 offset:1024
    ds_read_b64_tr_b16 a[88:89], v16 offset:32
    ds_read_b64_tr_b16 a[90:91], v16 offset:1056
    ds_read_b64_tr_b16 a[28:29], v16 offset:8192
    ds_read_b64_tr_b16 a[30:31], v16 offset:9216
    ds_read_b64_tr_b16 a[92:93], v16 offset:8224
    ds_read_b64_tr_b16 a[94:95], v16 offset:9248
    s_waitcnt lgkmcnt(0)
    s_waitcnt vmcnt(24)
    s_barrier
    s_add_u32 m0, s60, 131072
    s_add_u32 s62, s63, 3670016
    buffer_load_dwordx4 v1, s[16:19], s62 offen lds
    s_add_u32 m0, s60, 132096
    s_add_u32 s62, s63, 3702784
    buffer_load_dwordx4 v1, s[16:19], s62 offen lds
    s_add_u32 m0, s60, 133120
    s_add_u32 s62, s63, 3735552
    buffer_load_dwordx4 v1, s[16:19], s62 offen lds
    s_add_u32 m0, s60, 134144
    s_add_u32 s62, s63, 3768320
    buffer_load_dwordx4 v1, s[16:19], s62 offen lds
    v_add_u32 v16, 147456, v2
    ds_read_b64_tr_b16 a[152:153], v16 offset:0
    ds_read_b64_tr_b16 a[154:155], v16 offset:1024
    ds_read_b64_tr_b16 a[216:217], v16 offset:32
    ds_read_b64_tr_b16 a[218:219], v16 offset:1056
    ds_read_b64_tr_b16 a[156:157], v16 offset:8192
    ds_read_b64_tr_b16 a[158:159], v16 offset:9216
    ds_read_b64_tr_b16 a[220:221], v16 offset:8224
    ds_read_b64_tr_b16 a[222:223], v16 offset:9248
    s_waitcnt lgkmcnt(0)
    s_waitcnt vmcnt(24)
    s_barrier
    s_add_u32 m0, s60, 147456
    s_add_u32 s62, s63, 3670016
    buffer_load_dwordx4 v1, s[20:23], s62 offen lds
    s_add_u32 m0, s60, 148480
    s_add_u32 s62, s63, 3702784
    buffer_load_dwordx4 v1, s[20:23], s62 offen lds
    s_add_u32 m0, s60, 149504
    s_add_u32 s62, s63, 3735552
    buffer_load_dwordx4 v1, s[20:23], s62 offen lds
    s_add_u32 m0, s60, 150528
    s_add_u32 s62, s63, 3768320
    buffer_load_dwordx4 v1, s[20:23], s62 offen lds
    v_add_u32 v16, 32768, v2
    ds_read_b64_tr_b16 a[32:33], v16 offset:0
    ds_read_b64_tr_b16 a[34:35], v16 offset:1024
    ds_read_b64_tr_b16 a[96:97], v16 offset:32
    ds_read_b64_tr_b16 a[98:99], v16 offset:1056
    ds_read_b64_tr_b16 a[36:37], v16 offset:8192
    ds_read_b64_tr_b16 a[38:39], v16 offset:9216
    ds_read_b64_tr_b16 a[100:101], v16 offset:8224
    ds_read_b64_tr_b16 a[102:103], v16 offset:9248
    s_waitcnt lgkmcnt(0)
    s_waitcnt vmcnt(24)
    s_barrier
    v_add_u32 v16, 49152, v2
    ds_read_b64_tr_b16 a[160:161], v16 offset:0
    ds_read_b64_tr_b16 a[162:163], v16 offset:1024
    ds_read_b64_tr_b16 a[224:225], v16 offset:32
    ds_read_b64_tr_b16 a[226:227], v16 offset:1056
    ds_read_b64_tr_b16 a[164:165], v16 offset:8192
    ds_read_b64_tr_b16 a[166:167], v16 offset:9216
    ds_read_b64_tr_b16 a[228:229], v16 offset:8224
    ds_read_b64_tr_b16 a[230:231], v16 offset:9248
    s_waitcnt lgkmcnt(0)
    s_waitcnt vmcnt(20)
    s_barrier
    v_add_u32 v16, 65536, v2
    ds_read_b64_tr_b16 a[40:41], v16 offset:0
    ds_read_b64_tr_b16 a[42:43], v16 offset:1024
    ds_read_b64_tr_b16 a[104:105], v16 offset:32
    ds_read_b64_tr_b16 a[106:107], v16 offset:1056
    ds_read_b64_tr_b16 a[44:45], v16 offset:8192
    ds_read_b64_tr_b16 a[46:47], v16 offset:9216
    ds_read_b64_tr_b16 a[108:109], v16 offset:8224
    ds_read_b64_tr_b16 a[110:111], v16 offset:9248
    s_waitcnt lgkmcnt(0)
    s_waitcnt vmcnt(16)
    s_barrier
    v_add_u32 v16, 81920, v2
    ds_read_b64_tr_b16 a[168:169], v16 offset:0
    ds_read_b64_tr_b16 a[170:171], v16 offset:1024
    ds_read_b64_tr_b16 a[232:233], v16 offset:32
    ds_read_b64_tr_b16 a[234:235], v16 offset:1056
    ds_read_b64_tr_b16 a[172:173], v16 offset:8192
    ds_read_b64_tr_b16 a[174:175], v16 offset:9216
    ds_read_b64_tr_b16 a[236:237], v16 offset:8224
    ds_read_b64_tr_b16 a[238:239], v16 offset:9248
    s_waitcnt lgkmcnt(0)
    s_waitcnt vmcnt(12)
    s_barrier
    v_add_u32 v16, 98304, v2
    ds_read_b64_tr_b16 a[48:49], v16 offset:0
    ds_read_b64_tr_b16 a[50:51], v16 offset:1024
    ds_read_b64_tr_b16 a[112:113], v16 offset:32
    ds_read_b64_tr_b16 a[114:115], v16 offset:1056
    ds_read_b64_tr_b16 a[52:53], v16 offset:8192
    ds_read_b64_tr_b16 a[54:55], v16 offset:9216
    ds_read_b64_tr_b16 a[116:117], v16 offset:8224
    ds_read_b64_tr_b16 a[118:119], v16 offset:9248
    s_waitcnt lgkmcnt(0)
    s_waitcnt vmcnt(8)
    s_barrier
    v_add_u32 v16, 114688, v2
    ds_read_b64_tr_b16 a[176:177], v16 offset:0
    ds_read_b64_tr_b16 a[178:179], v16 offset:1024
    ds_read_b64_tr_b16 a[240:241], v16 offset:32
    ds_read_b64_tr_b16 a[242:243], v16 offset:1056
    ds_read_b64_tr_b16 a[180:181], v16 offset:8192
    ds_read_b64_tr_b16 a[182:183], v16 offset:9216
    ds_read_b64_tr_b16 a[244:245], v16 offset:8224
    ds_read_b64_tr_b16 a[246:247], v16 offset:9248
    s_waitcnt lgkmcnt(0)
    s_waitcnt vmcnt(4)
    s_barrier
    v_add_u32 v16, 131072, v2
    ds_read_b64_tr_b16 a[56:57], v16 offset:0
    ds_read_b64_tr_b16 a[58:59], v16 offset:1024
    ds_read_b64_tr_b16 a[120:121], v16 offset:32
    ds_read_b64_tr_b16 a[122:123], v16 offset:1056
    ds_read_b64_tr_b16 a[60:61], v16 offset:8192
    ds_read_b64_tr_b16 a[62:63], v16 offset:9216
    ds_read_b64_tr_b16 a[124:125], v16 offset:8224
    ds_read_b64_tr_b16 a[126:127], v16 offset:9248
    s_waitcnt lgkmcnt(0)
    s_waitcnt vmcnt(0)
    s_barrier
    v_add_u32 v16, 147456, v2
    ds_read_b64_tr_b16 a[184:185], v16 offset:0
    ds_read_b64_tr_b16 a[186:187], v16 offset:1024
    ds_read_b64_tr_b16 a[248:249], v16 offset:32
    ds_read_b64_tr_b16 a[250:251], v16 offset:1056
    ds_read_b64_tr_b16 a[188:189], v16 offset:8192
    ds_read_b64_tr_b16 a[190:191], v16 offset:9216
    ds_read_b64_tr_b16 a[252:253], v16 offset:8224
    ds_read_b64_tr_b16 a[254:255], v16 offset:9248
    s_waitcnt lgkmcnt(0)
    s_barrier
    v_bfe_u32 v12, v0, 0, 1
    v_mul_u32_u24 v12, 16, v12
    v_bfe_u32 v3, v0, 1, 2
    v_mul_u32_u24 v3, 256, v3
    v_add_u32 v12, v12, v3
    v_bfe_u32 v3, v0, 4, 1
    v_mul_u32_u24 v3, 128, v3
    v_add_u32 v12, v12, v3
    v_bfe_u32 v3, v0, 5, 1
    v_mul_u32_u24 v3, 32, v3
    v_add_u32 v12, v12, v3
    v_lshrrev_b32 v3, 3, v12
    v_and_b32 v3, 0x60, v3
    v_xor_b32 v12, v12, v3
    v_lshrrev_b32 v3, 3, v4
    v_and_b32 v3, 0x60, v3
    v_xor_b32 v13, v4, v3
    s_lshl_b32 s3, s52, 11
    v_add_u32 v13, s3, v13
    v_bfe_u32 v8, v0, 0, 3
    v_mul_u32_u24 v8, 16, v8
    v_bfe_u32 v3, v0, 4, 1
    v_mul_u32_u24 v3, 128, v3
    v_add_u32 v8, v8, v3
    v_bfe_u32 v3, v0, 5, 1
    v_mul_u32_u24 v3, 8, v3
    v_add_u32 v8, v8, v3
    v_bfe_u32 v9, v0, 0, 4
    v_mul_u32_u24 v9, 8, v9
    v_bfe_u32 v3, v0, 4, 1
    v_mul_u32_u24 v3, 256, v3
    v_add_u32 v9, v9, v3
    v_mov_b32 v10, 0x7f817f81
    v_mov_b32 v11, 0
    s_mov_b32 s76, 0x00ff00ff
    s_mov_b32 s77, 0x00ff00ff
    s_lshl_b32 s65, s52, 11
    s_add_u32 s65, s65, 4194304
    s_lshl_b32 s66, s53, 12
    s_lshl_b32 s3, s52, 9
    s_add_u32 s66, s66, s3
    s_lshl_b32 s67, s53, 7
    s_add_u32 s67, s67, 16384
    s_cmp_lg_u32 s52, 0
    s_cbranch_scc1 L_WD_30
    v_mov_b32 v5, 48
    s_mov_b32 s56, 0
L_poll_31:
    buffer_load_dword v3, v5, s[44:47], 0 offen sc1
    s_waitcnt vmcnt(0)
    v_readfirstlane_b32 s58, v3
    s_nop 0
    s_cmp_ge_u32 s58, 256
    s_cbranch_scc1 L_polled_32
    s_sleep 40
    s_add_u32 s56, s56, 1
    s_cmp_gt_u32 s56, 60000
    s_cbranch_scc1 L_TIMEOUT_2
    s_branch L_poll_31
.p2align 5
L_polled_32:
    v_mov_b32 v5, 164
    s_mov_b32 s56, 0
L_poll_33:
    buffer_load_dword v3, v5, s[44:47], 0 offen sc1
    s_waitcnt vmcnt(0)
    v_readfirstlane_b32 s58, v3
    s_nop 0
    s_cmp_ge_u32 s58, 32
    s_cbranch_scc1 L_polled_34
    s_sleep 40
    s_add_u32 s56, s56, 1
    s_cmp_gt_u32 s56, 60000
    s_cbranch_scc1 L_TIMEOUT_2
    s_branch L_poll_33
.p2align 5
L_polled_34:
    v_mov_b32 v5, 184
    s_mov_b32 s56, 0
L_poll_35:
    buffer_load_dword v3, v5, s[44:47], 0 offen sc1
    s_waitcnt vmcnt(0)
    v_readfirstlane_b32 s58, v3
    s_nop 0
    s_cmp_ge_u32 s58, 32
    s_cbranch_scc1 L_polled_36
    s_sleep 40
    s_add_u32 s56, s56, 1
    s_cmp_gt_u32 s56, 60000
    s_cbranch_scc1 L_TIMEOUT_2
    s_branch L_poll_35
.p2align 5
L_polled_36:
.p2align 5
L_WD_30:
    s_waitcnt vmcnt(0)
    s_barrier
    s_mov_b32 s64, 0
    s_mov_b32 s68, 0
    v_and_b32 v3, 8, v0
    v_lshlrev_b32 v5, 10, v3
    v_add_u32 v140, v12, v5
    v_lshlrev_b32 v5, 14, v3
    v_add_u32 v141, v8, v5
    v_and_b32 v3, 32, v0
    v_lshlrev_b32 v5, 12, v3
    v_add_u32 v142, v9, v5
    s_add_u32 s70, s65, 8192
    buffer_load_dwordx4 v[16:19], v4, s[48:51], s65 offen offset:0 sc1
    buffer_load_dwordx4 v[20:23], v4, s[48:51], s65 offen offset:1024 sc1
    buffer_load_dwordx4 v[24:27], v4, s[48:51], s70 offen offset:0 sc1
    buffer_load_dwordx4 v[28:31], v4, s[48:51], s70 offen offset:1024 sc1
    s_waitcnt vmcnt(0)
L_KMP_LOOP:
    v_add_u32 v6, s68, v140
    v_add_u32 v7, s68, v13
    v_xor_b32 v14, 64, v6
    s_mov_b32 s56, 0
    s_cmp_eq_u32 s64, 32
    s_cbranch_scc1 L_KMP_END
    s_waitcnt vmcnt(4)
L_KMP_CHK:
    ds_write_b128 v7, v[16:19] offset:0
    ds_write_b128 v7, v[20:23] offset:1024
    ds_write_b128 v7, v[24:27] offset:8192
    ds_write_b128 v7, v[28:31] offset:9216
    v_fma_f32 v3, v16, v17, v18
    v_fma_f32 v5, v19, v20, v21
    v_fma_f32 v3, v22, v23, v3
    v_fma_f32 v3, v24, v25, v3
    v_fma_f32 v3, v26, v27, v3
    v_fma_f32 v3, v28, v29, v3
    v_fma_f32 v3, v30, v31, v3
    v_cmp_u_f32 vcc, v3, v5
    s_cbranch_vccz L_KMP_OK
    s_and_b32 s3, s56, 15
    s_cbranch_scc1 L_KMP_AGAIN
    s_mov_b64 s[96:97], 0
    v_cmp_eq_u32 vcc, v16, v10
    s_nop 0
    s_or_b64 s[96:97], s[96:97], vcc
    v_cmp_eq_u32 vcc, v17, v10
    s_nop 0
    s_or_b64 s[96:97], s[96:97], vcc
    v_cmp_eq_u32 vcc, v18, v10
    s_nop 0
    s_or_b64 s[96:97], s[96:97], vcc
    v_cmp_eq_u32 vcc, v19, v10
    s_nop 0
    s_or_b64 s[96:97], s[96:97], vcc
    v_cmp_eq_u32 vcc, v20, v10
    s_nop 0
    s_or_b64 s[96:97], s[96:97], vcc
    v_cmp_eq_u32 vcc, v21, v10
    s_nop 0
    s_or_b64 s[96:97], s[96:97], vcc
    v_cmp_eq_u32 vcc, v22, v10
    s_nop 0
    s_or_b64 s[96:97], s[96:97], vcc
    v_cmp_eq_u32 vcc, v23, v10
    s_nop 0
    s_or_b64 s[96:97], s[96:97], vcc
    v_cmp_eq_u32 vcc, v24, v10
    s_nop 0
    s_or_b64 s[96:97], s[96:97], vcc
    v_cmp_eq_u32 vcc, v25, v10
    s_nop 0
    s_or_b64 s[96:97], s[96:97], vcc
    v_cmp_eq_u32 vcc, v26, v10
    s_nop 0
    s_or_b64 s[96:97], s[96:97], vcc
    v_cmp_eq_u32 vcc, v27, v10
    s_nop 0
    s_or_b64 s[96:97], s[96:97], vcc
    v_cmp_eq_u32 vcc, v28, v10
    s_nop 0
    s_or_b64 s[96:97], s[96:97], vcc
    v_cmp_eq_u32 vcc, v29, v10
    s_nop 0
    s_or_b64 s[96:97], s[96:97], vcc
    v_cmp_eq_u32 vcc, v30, v10
    s_nop 0
    s_or_b64 s[96:97], s[96:97], vcc
    v_cmp_eq_u32 vcc, v31, v10
    s_nop 0
    s_or_b64 s[96:97], s[96:97], vcc
    s_cbranch_scc0 L_KMP_OK
L_KMP_AGAIN:
    s_sleep 4
    s_add_u32 s70, s65, 8192
    buffer_load_dwordx4 v[16:19], v4, s[48:51], s65 offen offset:0 sc1
    buffer_load_dwordx4 v[20:23], v4, s[48:51], s65 offen offset:1024 sc1
    buffer_load_dwordx4 v[24:27], v4, s[48:51], s70 offen offset:0 sc1
    buffer_load_dwordx4 v[28:31], v4, s[48:51], s70 offen offset:1024 sc1
    s_add_u32 s56, s56, 1
    s_cmp_gt_u32 s56, 60000
    s_cbranch_scc1 L_TIMEOUT_11
    s_waitcnt vmcnt(0)
    s_branch L_KMP_CHK
.p2align 5
L_KMP_OK:
    s_waitcnt lgkmcnt(0)
    s_barrier
    s_max_u32 s69, s64, 2
    s_sub_u32 s69, s69, 2
    s_cmp_lg_u32 s52, 0
    s_cbranch_scc1 L_KM_NF_37
    v_mov_b32 v3, s69
    s_mov_b64 exec, 1
    buffer_store_dword v3, v11, s[48:51], s67 offen sc1
    s_mov_b64 exec, -1
L_KM_NF_37:
    s_add_u32 s65, s65, 16384
    s_add_u32 s70, s65, 8192
    buffer_load_dwordx4 v[16:19], v4, s[48:51], s65 offen offset:0 sc1
    buffer_load_dwordx4 v[20:23], v4, s[48:51], s65 offen offset:1024 sc1
    buffer_load_dwordx4 v[24:27], v4, s[48:51], s70 offen offset:0 sc1
    buffer_load_dwordx4 v[28:31], v4, s[48:51], s70 offen offset:1024 sc1
    ds_read_b128 v[32:35], v6 offset:0
    ds_read_b128 v[36:39], v14 offset:0
    ds_read_b128 v[40:43], v6 offset:4096
    ds_read_b128 v[44:47], v14 offset:4096
    ds_read_b128 v[48:51], v6 offset:1024
    ds_read_b128 v[52:55], v14 offset:1024
    ds_read_b128 v[56:59], v6 offset:5120
    ds_read_b128 v[60:63], v14 offset:5120
    ds_read_b128 v[64:67], v6 offset:2048
    ds_read_b128 v[68:71], v14 offset:2048
    ds_read_b128 v[72:75], v6 offset:6144
    ds_read_b128 v[76:79], v14 offset:6144
    ds_read_b128 v[80:83], v6 offset:3072
    ds_read_b128 v[84:87], v14 offset:3072
    ds_read_b128 v[88:91], v6 offset:7168
    ds_read_b128 v[92:95], v14 offset:7168
    s_waitcnt lgkmcnt(15)
    v_mfma_f32_16x16x32_bf16 v[96:99], a[0:3], v[32:35], 0
    v_mfma_f32_16x16x32_bf16 v[100:103], a[64:67], v[32:35], 0
    v_mfma_f32_16x16x32_bf16 v[104:107], v[32:35], a[128:131], 0
    v_mfma_f32_16x16x32_bf16 v[108:111], v[32:35], a[192:195], 0
    s_waitcnt lgkmcnt(14)
    v_mfma_f32_16x16x32_bf16 v[96:99], a[4:7], v[36:39], v[96:99]
    v_mfma_f32_16x16x32_bf16 v[100:103], a[68:71], v[36:39], v[100:103]
    v_mfma_f32_16x16x32_bf16 v[104:107], v[36:39], a[132:135], v[104:107]
    v_mfma_f32_16x16x32_bf16 v[108:111], v[36:39], a[196:199], v[108:111]
    s_waitcnt lgkmcnt(13)
    v_mfma_f32_16x16x32_bf16 v[96:99], a[8:11], v[40:43], v[96:99]
    v_mfma_f32_16x16x32_bf16 v[100:103], a[72:75], v[40:43], v[100:103]
    v_mfma_f32_16x16x32_bf16 v[104:107], v[40:43], a[136:139], v[104:107]
    v_mfma_f32_16x16x32_bf16 v[108:111], v[40:43], a[200:203], v[108:111]
    s_waitcnt lgkmcnt(12)
    v_mfma_f32_16x16x32_bf16 v[96:99], a[12:15], v[44:47], v[96:99]
    v_mfma_f32_16x16x32_bf16 v[100:103], a[76:79], v[44:47], v[100:103]
    v_mfma_f32_16x16x32_bf16 v[104:107], v[44:47], a[140:143], v[104:107]
    v_mfma_f32_16x16x32_bf16 v[108:111], v[44:47], a[204:207], v[108:111]
    s_waitcnt lgkmcnt(11)
    v_mfma_f32_16x16x32_bf16 v[96:99], a[16:19], v[48:51], v[96:99]
    v_mfma_f32_16x16x32_bf16 v[100:103], a[80:83], v[48:51], v[100:103]
    v_mfma_f32_16x16x32_bf16 v[104:107], v[48:51], a[144:147], v[104:107]
    v_mfma_f32_16x16x32_bf16 v[108:111], v[48:51], a[208:211], v[108:111]
    s_waitcnt lgkmcnt(10)
    v_mfma_f32_16x16x32_bf16 v[96:99], a[20:23], v[52:55], v[96:99]
    v_mfma_f32_16x16x32_bf16 v[100:103], a[84:87], v[52:55], v[100:103]
    v_mfma_f32_16x16x32_bf16 v[104:107], v[52:55], a[148:151], v[104:107]
    v_mfma_f32_16x16x32_bf16 v[108:111], v[52:55], a[212:215], v[108:111]
    s_waitcnt lgkmcnt(9)
    v_mfma_f32_16x16x32_bf16 v[96:99], a[24:27], v[56:59], v[96:99]
    v_mfma_f32_16x16x32_bf16 v[100:103], a[88:91], v[56:59], v[100:103]
    v_mfma_f32_16x16x32_bf16 v[104:107], v[56:59], a[152:155], v[104:107]
    v_mfma_f32_16x16x32_bf16 v[108:111], v[56:59], a[216:219], v[108:111]
    s_waitcnt lgkmcnt(8)
    v_mfma_f32_16x16x32_bf16 v[96:99], a[28:31], v[60:63], v[96:99]
    v_mfma_f32_16x16x32_bf16 v[100:103], a[92:95], v[60:63], v[100:103]
    v_mfma_f32_16x16x32_bf16 v[104:107], v[60:63], a[156:159], v[104:107]
    v_mfma_f32_16x16x32_bf16 v[108:111], v[60:63], a[220:223], v[108:111]
    s_waitcnt lgkmcnt(7)
    v_mfma_f32_16x16x32_bf16 v[96:99], a[32:35], v[64:67], v[96:99]
    v_mfma_f32_16x16x32_bf16 v[100:103], a[96:99], v[64:67], v[100:103]
    v_mfma_f32_16x16x32_bf16 v[104:107], v[64:67], a[160:163], v[104:107]
    v_mfma_f32_16x16x32_bf16 v[108:111], v[64:67], a[224:227], v[108:111]
    s_waitcnt lgkmcnt(6)
    v_mfma_f32_16x16x32_bf16 v[96:99], a[36:39], v[68:71], v[96:99]
    v_mfma_f32_16x16x32_bf16 v[100:103], a[100:103], v[68:71], v[100:103]
    v_mfma_f32_16x16x32_bf16 v[104:107], v[68:71], a[164:167], v[104:107]
    v_mfma_f32_16x16x32_bf16 v[108:111], v[68:71], a[228:231], v[108:111]
    s_waitcnt lgkmcnt(5)
    v_mfma_f32_16x16x32_bf16 v[96:99], a[40:43], v[72:75], v[96:99]
    v_mfma_f32_16x16x32_bf16 v[100:103], a[104:107], v[72:75], v[100:103]
    v_mfma_f32_16x16x32_bf16 v[104:107], v[72:75], a[168:171], v[104:107]
    v_mfma_f32_16x16x32_bf16 v[108:111], v[72:75], a[232:235], v[108:111]
    s_waitcnt lgkmcnt(4)
    v_mfma_f32_16x16x32_bf16 v[96:99], a[44:47], v[76:79], v[96:99]
    v_mfma_f32_16x16x32_bf16 v[100:103], a[108:111], v[76:79], v[100:103]
    v_mfma_f32_16x16x32_bf16 v[104:107], v[76:79], a[172:175], v[104:107]
    v_mfma_f32_16x16x32_bf16 v[108:111], v[76:79], a[236:239], v[108:111]
    s_waitcnt lgkmcnt(3)
    v_mfma_f32_16x16x32_bf16 v[96:99], a[48:51], v[80:83], v[96:99]
    v_mfma_f32_16x16x32_bf16 v[100:103], a[112:115], v[80:83], v[100:103]
    v_mfma_f32_16x16x32_bf16 v[104:107], v[80:83], a[176:179], v[104:107]
    v_mfma_f32_16x16x32_bf16 v[108:111], v[80:83], a[240:243], v[108:111]
    s_waitcnt lgkmcnt(2)
    v_mfma_f32_16x16x32_bf16 v[96:99], a[52:55], v[84:87], v[96:99]
    v_mfma_f32_16x16x32_bf16 v[100:103], a[116:119], v[84:87], v[100:103]
    v_mfma_f32_16x16x32_bf16 v[104:107], v[84:87], a[180:183], v[104:107]
    v_mfma_f32_16x16x32_bf16 v[108:111], v[84:87], a[244:247], v[108:111]
    s_waitcnt lgkmcnt(1)
    v_mfma_f32_16x16x32_bf16 v[96:99], a[56:59], v[88:91], v[96:99]
    v_mfma_f32_16x16x32_bf16 v[100:103], a[120:123], v[88:91], v[100:103]
    v_mfma_f32_16x16x32_bf16 v[104:107], v[88:91], a[184:187], v[104:107]
    v_mfma_f32_16x16x32_bf16 v[108:111], v[88:91], a[248:251], v[108:111]
    s_waitcnt lgkmcnt(0)
    v_mfma_f32_16x16x32_bf16 v[96:99], a[60:63], v[92:95], v[96:99]
    v_mfma_f32_16x16x32_bf16 v[100:103], a[124:127], v[92:95], v[100:103]
    v_mfma_f32_16x16x32_bf16 v[104:107], v[92:95], a[188:191], v[104:107]
    v_mfma_f32_16x16x32_bf16 v[108:111], v[92:95], a[252:255], v[108:111]
    s_add_u32 s61, s66, 50331648
    s_add_u32 s62, s66, 8388608
    s_add_u32 s64, s64, 2
    s_add_u32 s66, s66, 262144
    s_xor_b32 s68, s68, 16384
    v_cvt_pk_bf16_f32 v128, v96, v97
    v_cvt_pk_bf16_f32 v129, v98, v99
    v_cvt_pk_bf16_f32 v130, v100, v101
    v_cvt_pk_bf16_f32 v131, v102, v103
    v_cvt_pk_bf16_f32 v132, v104, v105
    v_cvt_pk_bf16_f32 v133, v106, v107
    v_cvt_pk_bf16_f32 v134, v108, v109
    v_cvt_pk_bf16_f32 v135, v110, v111
    buffer_store_dwordx2 v[128:129], v141, s[48:51], s61 offen offset:0 sc1
    buffer_store_dwordx2 v[130:131], v141, s[48:51], s61 offen offset:256 sc1
    buffer_store_dwordx2 v[132:133], v142, s[48:51], s62 offen offset:0 sc1
    buffer_store_dwordx2 v[134:135], v142, s[48:51], s62 offen offset:128 sc1
    s_mov_b64 exec, -1
    s_branch L_KMP_LOOP
.p2align 5
L_KMP_END:
    s_waitcnt vmcnt(0)
    s_barrier
    s_cmp_lg_u32 s52, 0
    s_cbranch_scc1 L_KM_NF_38
    v_mov_b32 v3, s64
    s_mov_b64 exec, 1
    buffer_store_dword v3, v11, s[48:51], s67 offen sc1
    s_mov_b64 exec, -1
L_KM_NF_38:
    buffer_load_dwordx4 v[16:19], v4, s[48:51], s65 offen offset:0 sc1
    buffer_load_dwordx4 v[20:23], v4, s[48:51], s65 offen offset:1024 sc1
    s_waitcnt vmcnt(0)
L_KMS_LOOP:
    v_add_u32 v6, s68, v12
    v_add_u32 v7, s68, v13
    v_xor_b32 v14, 64, v6
    s_mov_b32 s56, 0
    s_cmp_eq_u32 s64, 64
    s_cbranch_scc1 L_KMS_END
    s_waitcnt vmcnt(4)
L_KMS_CHK:
    ds_write_b128 v7, v[16:19] offset:0
    ds_write_b128 v7, v[20:23] offset:1024
    v_fma_f32 v3, v16, v17, v18
    v_fma_f32 v5, v19, v20, v21
    v_fma_f32 v3, v22, v23, v3
    v_cmp_u_f32 vcc, v3, v5
    s_cbranch_vccz L_KMS_OK
    s_and_b32 s3, s56, 15
    s_cbranch_scc1 L_KMS_AGAIN
    s_mov_b64 s[96:97], 0
    v_cmp_eq_u32 vcc, v16, v10
    s_nop 0
    s_or_b64 s[96:97], s[96:97], vcc
    v_cmp_eq_u32 vcc, v17, v10
    s_nop 0
    s_or_b64 s[96:97], s[96:97], vcc
    v_cmp_eq_u32 vcc, v18, v10
    s_nop 0
    s_or_b64 s[96:97], s[96:97], vcc
    v_cmp_eq_u32 vcc, v19, v10
    s_nop 0
    s_or_b64 s[96:97], s[96:97], vcc
    v_cmp_eq_u32 vcc, v20, v10
    s_nop 0
    s_or_b64 s[96:97], s[96:97], vcc
    v_cmp_eq_u32 vcc, v21, v10
    s_nop 0
    s_or_b64 s[96:97], s[96:97], vcc
    v_cmp_eq_u32 vcc, v22, v10
    s_nop 0
    s_or_b64 s[96:97], s[96:97], vcc
    v_cmp_eq_u32 vcc, v23, v10
    s_nop 0
    s_or_b64 s[96:97], s[96:97], vcc
    s_cbranch_scc0 L_KMS_OK
L_KMS_AGAIN:
    buffer_load_dwordx4 v[16:19], v4, s[48:51], s65 offen offset:0 sc1
    buffer_load_dwordx4 v[20:23], v4, s[48:51], s65 offen offset:1024 sc1
    s_add_u32 s56, s56, 1
    s_cmp_gt_u32 s56, 60000
    s_cbranch_scc1 L_TIMEOUT_11
    s_waitcnt vmcnt(0)
    s_branch L_KMS_CHK
.p2align 5
L_KMS_OK:
    s_waitcnt lgkmcnt(0)
    s_barrier
    s_max_u32 s69, s64, 33
    s_sub_u32 s69, s69, 1
    s_cmp_lg_u32 s52, 0
    s_cbranch_scc1 L_KM_NF_39
    v_mov_b32 v3, s69
    s_mov_b64 exec, 1
    buffer_store_dword v3, v11, s[48:51], s67 offen sc1
    s_mov_b64 exec, -1
L_KM_NF_39:
    s_add_u32 s65, s65, 8192
    buffer_load_dwordx4 v[16:19], v4, s[48:51], s65 offen offset:0 sc1
    buffer_load_dwordx4 v[20:23], v4, s[48:51], s65 offen offset:1024 sc1
    ds_read_b128 v[32:35], v6 offset:0
    ds_read_b128 v[36:39], v14 offset:0
    ds_read_b128 v[40:43], v6 offset:4096
    ds_read_b128 v[44:47], v14 offset:4096
    ds_read_b128 v[48:51], v6 offset:1024
    ds_read_b128 v[52:55], v14 offset:1024
    ds_read_b128 v[56:59], v6 offset:5120
    ds_read_b128 v[60:63], v14 offset:5120
    ds_read_b128 v[64:67], v6 offset:2048
    ds_read_b128 v[68:71], v14 offset:2048
    ds_read_b128 v[72:75], v6 offset:6144
    ds_read_b128 v[76:79], v14 offset:6144
    ds_read_b128 v[80:83], v6 offset:3072
    ds_read_b128 v[84:87], v14 offset:3072
    ds_read_b128 v[88:91], v6 offset:7168
    ds_read_b128 v[92:95], v14 offset:7168
    s_waitcnt lgkmcnt(15)
    v_mfma_f32_16x16x32_bf16 v[96:99], a[0:3], v[32:35], 0
    v_mfma_f32_16x16x32_bf16 v[100:103], a[64:67], v[32:35], 0
    v_mfma_f32_16x16x32_bf16 v[104:107], v[32:35], a[128:131], 0
    v_mfma_f32_16x16x32_bf16 v[108:111], v[32:35], a[192:195], 0
    s_waitcnt lgkmcnt(14)
    v_mfma_f32_16x16x32_bf16 v[96:99], a[4:7], v[36:39], v[96:99]
    v_mfma_f32_16x16x32_bf16 v[100:103], a[68:71], v[36:39], v[100:103]
    v_mfma_f32_16x16x32_bf16 v[104:107], v[36:39], a[132:135], v[104:107]
    v_mfma_f32_16x16x32_bf16 v[108:111], v[36:39], a[196:199], v[108:111]
    s_waitcnt lgkmcnt(13)
    v_mfma_f32_16x16x32_bf16 v[96:99], a[8:11], v[40:43], v[96:99]
    v_mfma_f32_16x16x32_bf16 v[100:103], a[72:75], v[40:43], v[100:103]
    v_mfma_f32_16x16x32_bf16 v[104:107], v[40:43], a[136:139], v[104:107]
    v_mfma_f32_16x16x32_bf16 v[108:111], v[40:43], a[200:203], v[108:111]
    s_waitcnt lgkmcnt(12)
    v_mfma_f32_16x16x32_bf16 v[96:99], a[12:15], v[44:47], v[96:99]
    v_mfma_f32_16x16x32_bf16 v[100:103], a[76:79], v[44:47], v[100:103]
    v_mfma_f32_16x16x32_bf16 v[104:107], v[44:47], a[140:143], v[104:107]
    v_mfma_f32_16x16x32_bf16 v[108:111], v[44:47], a[204:207], v[108:111]
    s_waitcnt lgkmcnt(11)
    v_mfma_f32_16x16x32_bf16 v[96:99], a[16:19], v[48:51], v[96:99]
    v_mfma_f32_16x16x32_bf16 v[100:103], a[80:83], v[48:51], v[100:103]
    v_mfma_f32_16x16x32_bf16 v[104:107], v[48:51], a[144:147], v[104:107]
    v_mfma_f32_16x16x32_bf16 v[108:111], v[48:51], a[208:211], v[108:111]
    s_waitcnt lgkmcnt(10)
    v_mfma_f32_16x16x32_bf16 v[96:99], a[20:23], v[52:55], v[96:99]
    v_mfma_f32_16x16x32_bf16 v[100:103], a[84:87], v[52:55], v[100:103]
    v_mfma_f32_16x16x32_bf16 v[104:107], v[52:55], a[148:151], v[104:107]
    v_mfma_f32_16x16x32_bf16 v[108:111], v[52:55], a[212:215], v[108:111]
    s_waitcnt lgkmcnt(9)
    v_mfma_f32_16x16x32_bf16 v[96:99], a[24:27], v[56:59], v[96:99]
    v_mfma_f32_16x16x32_bf16 v[100:103], a[88:91], v[56:59], v[100:103]
    v_mfma_f32_16x16x32_bf16 v[104:107], v[56:59], a[152:155], v[104:107]
    v_mfma_f32_16x16x32_bf16 v[108:111], v[56:59], a[216:219], v[108:111]
    s_waitcnt lgkmcnt(8)
    v_mfma_f32_16x16x32_bf16 v[96:99], a[28:31], v[60:63], v[96:99]
    v_mfma_f32_16x16x32_bf16 v[100:103], a[92:95], v[60:63], v[100:103]
    v_mfma_f32_16x16x32_bf16 v[104:107], v[60:63], a[156:159], v[104:107]
    v_mfma_f32_16x16x32_bf16 v[108:111], v[60:63], a[220:223], v[108:111]
    s_waitcnt lgkmcnt(7)
    v_mfma_f32_16x16x32_bf16 v[96:99], a[32:35], v[64:67], v[96:99]
    v_mfma_f32_16x16x32_bf16 v[100:103], a[96:99], v[64:67], v[100:103]
    v_mfma_f32_16x16x32_bf16 v[104:107], v[64:67], a[160:163], v[104:107]
    v_mfma_f32_16x16x32_bf16 v[108:111], v[64:67], a[224:227], v[108:111]
    s_waitcnt lgkmcnt(6)
    v_mfma_f32_16x16x32_bf16 v[96:99], a[36:39], v[68:71], v[96:99]
    v_mfma_f32_16x16x32_bf16 v[100:103], a[100:103], v[68:71], v[100:103]
    v_mfma_f32_16x16x32_bf16 v[104:107], v[68:71], a[164:167], v[104:107]
    v_mfma_f32_16x16x32_bf16 v[108:111], v[68:71], a[228:231], v[108:111]
    s_waitcnt lgkmcnt(5)
    v_mfma_f32_16x16x32_bf16 v[96:99], a[40:43], v[72:75], v[96:99]
    v_mfma_f32_16x16x32_bf16 v[100:103], a[104:107], v[72:75], v[100:103]
    v_mfma_f32_16x16x32_bf16 v[104:107], v[72:75], a[168:171], v[104:107]
    v_mfma_f32_16x16x32_bf16 v[108:111], v[72:75], a[232:235], v[108:111]
    s_waitcnt lgkmcnt(4)
    v_mfma_f32_16x16x32_bf16 v[96:99], a[44:47], v[76:79], v[96:99]
    v_mfma_f32_16x16x32_bf16 v[100:103], a[108:111], v[76:79], v[100:103]
    v_mfma_f32_16x16x32_bf16 v[104:107], v[76:79], a[172:175], v[104:107]
    v_mfma_f32_16x16x32_bf16 v[108:111], v[76:79], a[236:239], v[108:111]
    s_waitcnt lgkmcnt(3)
    v_mfma_f32_16x16x32_bf16 v[96:99], a[48:51], v[80:83], v[96:99]
    v_mfma_f32_16x16x32_bf16 v[100:103], a[112:115], v[80:83], v[100:103]
    v_mfma_f32_16x16x32_bf16 v[104:107], v[80:83], a[176:179], v[104:107]
    v_mfma_f32_16x16x32_bf16 v[108:111], v[80:83], a[240:243], v[108:111]
    s_waitcnt lgkmcnt(2)
    v_mfma_f32_16x16x32_bf16 v[96:99], a[52:55], v[84:87], v[96:99]
    v_mfma_f32_16x16x32_bf16 v[100:103], a[116:119], v[84:87], v[100:103]
    v_mfma_f32_16x16x32_bf16 v[104:107], v[84:87], a[180:183], v[104:107]
    v_mfma_f32_16x16x32_bf16 v[108:111], v[84:87], a[244:247], v[108:111]
    s_waitcnt lgkmcnt(1)
    v_mfma_f32_16x16x32_bf16 v[96:99], a[56:59], v[88:91], v[96:99]
    v_mfma_f32_16x16x32_bf16 v[100:103], a[120:123], v[88:91], v[100:103]
    v_mfma_f32_16x16x32_bf16 v[104:107], v[88:91], a[184:187], v[104:107]
    v_mfma_f32_16x16x32_bf16 v[108:111], v[88:91], a[248:251], v[108:111]
    s_waitcnt lgkmcnt(0)
    v_mfma_f32_16x16x32_bf16 v[96:99], a[60:63], v[92:95], v[96:99]
    v_mfma_f32_16x16x32_bf16 v[100:103], a[124:127], v[92:95], v[100:103]
    v_mfma_f32_16x16x32_bf16 v[104:107], v[92:95], a[188:191], v[104:107]
    v_mfma_f32_16x16x32_bf16 v[108:111], v[92:95], a[252:255], v[108:111]
    s_add_u32 s61, s66, 50331648
    s_add_u32 s62, s66, 8388608
    s_add_u32 s64, s64, 1
    s_add_u32 s66, s66, 131072
    s_xor_b32 s68, s68, 16384
    v_cvt_pk_bf16_f32 v128, v96, v97
    v_cvt_pk_bf16_f32 v129, v98, v99
    v_cvt_pk_bf16_f32 v130, v100, v101
    v_cvt_pk_bf16_f32 v131, v102, v103
    v_cvt_pk_bf16_f32 v132, v104, v105
    v_cvt_pk_bf16_f32 v133, v106, v107
    v_cvt_pk_bf16_f32 v134, v108, v109
    v_cvt_pk_bf16_f32 v135, v110, v111
    s_mov_b64 exec, s[76:77]
    buffer_store_dwordx2 v[128:129], v8, s[48:51], s61 offen offset:0 sc1
    buffer_store_dwordx2 v[130:131], v8, s[48:51], s61 offen offset:256 sc1
    s_mov_b64 exec, 0xffffffff
    buffer_store_dwordx2 v[132:133], v9, s[48:51], s62 offen offset:0 sc1
    buffer_store_dwordx2 v[134:135], v9, s[48:51], s62 offen offset:128 sc1
    s_mov_b64 exec, -1
    s_branch L_KMS_LOOP
.p2align 5
L_KMS_END:
    s_waitcnt vmcnt(0)
    s_barrier
    s_cmp_lg_u32 s52, 0
    s_cbranch_scc1 L_KM_NF_40
    v_mov_b32 v3, s64
    s_mov_b64 exec, 1
    buffer_store_dword v3, v11, s[48:51], s67 offen sc1
    s_mov_b64 exec, -1
L_KM_NF_40:
    s_endpgm
.p2align 5
L_ROLE_INI:
    s_cmp_lg_u32 s52, 0
    s_cbranch_scc1 L_WD_41
    v_mov_b32 v3, 48
    s_mov_b32 s56, 0
L_poll_42:
    buffer_load_dword v2, v3, s[44:47], 0 offen sc1
    s_waitcnt vmcnt(0)
    v_readfirstlane_b32 s58, v2
    s_nop 0
    s_cmp_ge_u32 s58, 256
    s_cbranch_scc1 L_polled_43
    s_sleep 40
    s_add_u32 s56, s56, 1
    s_cmp_gt_u32 s56, 60000
    s_cbranch_scc1 L_TIMEOUT_1
    s_branch L_poll_42
.p2align 5
L_polled_43:
.p2align 5
L_WD_41:
    s_waitcnt vmcnt(0)
    s_barrier
    s_lshl_b32 s61, s53, 7
    s_add_u32 s61, s61, 0
    v_mov_b32 v3, 0
    s_mov_b32 s56, 0
L_poll_44:
    buffer_load_dword v2, v3, s[48:51], s61 offen sc1
    s_waitcnt vmcnt(0)
    v_readfirstlane_b32 s3, v2
    s_nop 0
    s_cmp_ge_u32 s3, 6
    s_cbranch_scc1 L_polled_45
    s_sleep 40
    s_add_u32 s56, s56, 1
    s_cmp_gt_u32 s56, 60000
    s_cbranch_scc1 L_TIMEOUT_2
    s_branch L_poll_44
.p2align 5
L_polled_45:
    v_lshlrev_b32 v1, 4, v0
    v_mov_b32 v8, 0x7f817f81
    v_mov_b32 v9, 0x7f817f81
    v_mov_b32 v10, 0x7f817f81
    v_mov_b32 v11, 0x7f817f81
    s_lshl_b32 s61, s53, 12
    s_and_b32 s3, s52, 1
    s_lshl_b32 s3, s3, 10
    s_add_u32 s61, s61, s3
    s_add_u32 s61, s61, 12582912
    s_cmp_lt_u32 s52, 2
    s_cselect_b32 s3, 41943040, 0
    s_add_u32 s61, s61, s3
    buffer_store_dwordx4 v[8:11], v1, s[48:51], s61 offen sc1
    s_add_u32 s61, s61, 131072
    buffer_store_dwordx4 v[8:11], v1, s[48:51], s61 offen sc1
    s_add_u32 s61, s61, 131072
    buffer_store_dwordx4 v[8:11], v1, s[48:51], s61 offen sc1
    s_add_u32 s61, s61, 131072
    buffer_store_dwordx4 v[8:11], v1, s[48:51], s61 offen sc1
    s_add_u32 s61, s61, 131072
    buffer_store_dwordx4 v[8:11], v1, s[48:51], s61 offen sc1
    s_add_u32 s61, s61, 131072
    buffer_store_dwordx4 v[8:11], v1, s[48:51], s61 offen sc1
    s_add_u32 s61, s61, 131072
    buffer_store_dwordx4 v[8:11], v1, s[48:51], s61 offen sc1
    s_add_u32 s61, s61, 131072
    buffer_store_dwordx4 v[8:11], v1, s[48:51], s61 offen sc1
    s_add_u32 s61, s61, 131072
    buffer_store_dwordx4 v[8:11], v1, s[48:51], s61 offen sc1
    s_add_u32 s61, s61, 131072
    buffer_store_dwordx4 v[8:11], v1, s[48:51], s61 offen sc1
    s_add_u32 s61, s61, 131072
    buffer_store_dwordx4 v[8:11], v1, s[48:51], s61 offen sc1
    s_add_u32 s61, s61, 131072
    buffer_store_dwordx4 v[8:11], v1, s[48:51], s61 offen sc1
    s_add_u32 s61, s61, 131072
    buffer_store_dwordx4 v[8:11], v1, s[48:51], s61 offen sc1
    s_add_u32 s61, s61, 131072
    buffer_store_dwordx4 v[8:11], v1, s[48:51], s61 offen sc1
    s_add_u32 s61, s61, 131072
    buffer_store_dwordx4 v[8:11], v1, s[48:51], s61 offen sc1
    s_add_u32 s61, s61, 131072
    buffer_store_dwordx4 v[8:11], v1, s[48:51], s61 offen sc1
    s_add_u32 s61, s61, 131072
    buffer_store_dwordx4 v[8:11], v1, s[48:51], s61 offen sc1
    s_add_u32 s61, s61, 131072
    buffer_store_dwordx4 v[8:11], v1, s[48:51], s61 offen sc1
    s_add_u32 s61, s61, 131072
    buffer_store_dwordx4 v[8:11], v1, s[48:51], s61 offen sc1
    s_add_u32 s61, s61, 131072
    buffer_store_dwordx4 v[8:11], v1, s[48:51], s61 offen sc1
    s_add_u32 s61, s61, 131072
    buffer_store_dwordx4 v[8:11], v1, s[48:51], s61 offen sc1
    s_add_u32 s61, s61, 131072
    buffer_store_dwordx4 v[8:11], v1, s[48:51], s61 offen sc1
    s_add_u32 s61, s61, 131072
    buffer_store_dwordx4 v[8:11], v1, s[48:51], s61 offen sc1
    s_add_u32 s61, s61, 131072
    buffer_store_dwordx4 v[8:11], v1, s[48:51], s61 offen sc1
    s_add_u32 s61, s61, 131072
    buffer_store_dwordx4 v[8:11], v1, s[48:51], s61 offen sc1
    s_add_u32 s61, s61, 131072
    buffer_store_dwordx4 v[8:11], v1, s[48:51], s61 offen sc1
    s_add_u32 s61, s61, 131072
    buffer_store_dwordx4 v[8:11], v1, s[48:51], s61 offen sc1
    s_add_u32 s61, s61, 131072
    buffer_store_dwordx4 v[8:11], v1, s[48:51], s61 offen sc1
    s_add_u32 s61, s61, 131072
    buffer_store_dwordx4 v[8:11], v1, s[48:51], s61 offen sc1
    s_add_u32 s61, s61, 131072
    buffer_store_dwordx4 v[8:11], v1, s[48:51], s61 offen sc1
    s_add_u32 s61, s61, 131072
    buffer_store_dwordx4 v[8:11], v1, s[48:51], s61 offen sc1
    s_add_u32 s61, s61, 131072
    buffer_store_dwordx4 v[8:11], v1, s[48:51], s61 offen sc1
    s_add_u32 s61, s61, 131072
    s_waitcnt vmcnt(0)
    s_barrier
    s_cmp_lg_u32 s52, 0
    s_cbranch_scc1 L_INI_END
    s_mov_b64 exec, 1
    v_mov_b32 v2, 184
    v_mov_b32 v3, 1
    buffer_atomic_add v3, v2, s[44:47], 0 offen
L_INI_END:
    s_endpgm
.p2align 5
L_TIMEOUT_0:
    s_mov_b64 exec, 1
    v_mov_b32 v1, 0
    v_mov_b32 v2, 0x1000
    ds_write_b32 v1, v2
    s_waitcnt lgkmcnt(0)
    v_mov_b32 v1, 64
    v_mov_b32 v2, 1
    buffer_atomic_add v2, v1, s[44:47], 0 offen
    s_endpgm
.p2align 5
L_TIMEOUT_1:
    s_mov_b64 exec, 1
    v_mov_b32 v1, 68
    v_mov_b32 v2, 1
    buffer_atomic_add v2, v1, s[44:47], 0 offen
    s_endpgm
.p2align 5
L_TIMEOUT_2:
    s_mov_b64 exec, 1
    v_mov_b32 v1, 72
    v_mov_b32 v2, 1
    buffer_atomic_add v2, v1, s[44:47], 0 offen
    s_endpgm
.p2align 5
L_TIMEOUT_3:
    s_mov_b64 exec, 1
    v_mov_b32 v1, 76
    v_mov_b32 v2, 1
    buffer_atomic_add v2, v1, s[44:47], 0 offen
    s_endpgm
.p2align 5
L_TIMEOUT_4:
    s_mov_b64 exec, 1
    v_mov_b32 v1, 80
    v_mov_b32 v2, 1
    buffer_atomic_add v2, v1, s[44:47], 0 offen
    s_endpgm
.p2align 5
L_TIMEOUT_5:
    s_mov_b64 exec, 1
    v_mov_b32 v1, 84
    v_mov_b32 v2, 1
    buffer_atomic_add v2, v1, s[44:47], 0 offen
    s_endpgm
.p2align 5
L_TIMEOUT_6:
    s_mov_b64 exec, 1
    v_mov_b32 v1, 88
    v_mov_b32 v2, 1
    buffer_atomic_add v2, v1, s[44:47], 0 offen
    s_endpgm
.p2align 5
L_TIMEOUT_7:
    s_mov_b64 exec, 1
    v_mov_b32 v1, 92
    v_mov_b32 v2, 1
    buffer_atomic_add v2, v1, s[44:47], 0 offen
    s_endpgm
.p2align 5
L_TIMEOUT_8:
    s_mov_b64 exec, 1
    v_mov_b32 v1, 96
    v_mov_b32 v2, 1
    buffer_atomic_add v2, v1, s[44:47], 0 offen
    s_endpgm
.p2align 5
L_TIMEOUT_9:
    s_mov_b64 exec, 1
    v_mov_b32 v1, 100
    v_mov_b32 v2, 1
    buffer_atomic_add v2, v1, s[44:47], 0 offen
    s_endpgm
.p2align 5
L_TIMEOUT_10:
    s_mov_b64 exec, 1
    v_mov_b32 v1, 104
    v_mov_b32 v2, 1
    buffer_atomic_add v2, v1, s[44:47], 0 offen
    s_endpgm
.p2align 5
L_TIMEOUT_11:
    s_mov_b64 exec, 1
    v_mov_b32 v1, 108
    v_mov_b32 v2, 1
    buffer_atomic_add v2, v1, s[44:47], 0 offen
    s_endpgm
.p2align 5
L_CODE_END:

.section .rodata,"a"
.p2align 6
.amdhsa_kernel gated_mix__memory_aug_recurrent_mem_tr__sliding_block__prompt_kernel
  .amdhsa_next_free_vgpr 512
  .amdhsa_next_free_sgpr 102
  .amdhsa_accum_offset 256
  .amdhsa_group_segment_fixed_size 0
  .amdhsa_kernarg_size 112
  .amdhsa_user_sgpr_count 2
  .amdhsa_user_sgpr_kernarg_segment_ptr 1
  .amdhsa_system_sgpr_workgroup_id_x 1
.end_amdhsa_kernel
```
